```python
import torch

def _softmax(x, axis=-1):
    return torch.softmax(x, dim=axis)
def _gelu(x):
    return torch.nn.functional.gelu(x, approximate="tanh")
def _silu(x):
    return torch.nn.functional.silu(x)
def _sigmoid(x):
    return torch.sigmoid(x)
def _layernorm(x, axis=-1, eps=1e-5):
    m = x.mean(dim=axis, keepdim=True)
    v = x.var(dim=axis, keepdim=True, unbiased=False)
    return (x - m) / torch.sqrt(v + eps)
def _scatter_add(tgt, idx, src, axis=0):
    return tgt.clone().index_add_(axis, idx, src)
def _segment_sum(src, seg, n):
    out = torch.zeros((n,) + src.shape[1:], dtype=src.dtype)
    return out.index_add_(0, seg, src)
def _pad(x, pw):
    flat = tuple(v for pair in reversed(pw) for v in pair)
    return torch.nn.functional.pad(x, flat)

kernel_name = 'recurrent_scan__mha_block__glu_gated_geglu__prompt'

def setup_inputs():

    _w = (lambda a: (lambda t: t.to(torch.bfloat16) if t.is_floating_point() else t)(torch.as_tensor(a)))
    def _A_setup():
        B, S, D, H = 1, 2048, 640, 32
        return {
            "x": _w((lambda *s: torch.randn(*s, dtype=torch.bfloat16) * 0.05)(B, S, D)),
            "wqkv": _w((lambda *s: torch.randn(*s, dtype=torch.bfloat16) * 0.2)(D, 3 * D)),
            "wo": _w((lambda *s: torch.randn(*s, dtype=torch.bfloat16) * 0.2)(D, D)),
        }
    _A_in = _A_setup()

    def _B_setup():
        B, S, Dm, Df = 1, 2048, 640, 1728
        return {
            "x": _w((lambda *s: torch.randn(*s, dtype=torch.bfloat16) * 0.05)(B, S, Dm)),
            "w_gate": _w((lambda *s: torch.randn(*s, dtype=torch.bfloat16) * 0.1)(Dm, Df) * (Dm ** -0.5)),
            "w_up": _w((lambda *s: torch.randn(*s, dtype=torch.bfloat16) * 0.1)(Dm, Df) * (Dm ** -0.5)),
            "w_down": _w((lambda *s: torch.randn(*s, dtype=torch.bfloat16) * 0.1)(Df, Dm) * (Df ** -0.5)),
        }
    _B_in = _B_setup()

    return {
        "A_x": _A_in["x"],
        "A_wqkv": _A_in["wqkv"],
        "A_wo": _A_in["wo"],
        "B_x": _B_in["x"],
        "B_w_gate": _B_in["w_gate"],
        "B_w_up": _B_in["w_up"],
        "B_w_down": _B_in["w_down"],
    }

def reference(A_x, A_wqkv, A_wo, B_x, B_w_gate, B_w_up, B_w_down):
    def _A_ref(x, wqkv, wo):
        B, S, D = x.shape
        H = 32
        Dh = D // H
        qkv = (lambda x, *d: x.permute(*d))((x @ wqkv).reshape(B, S, 3, H, Dh), 2, 0, 3, 1, 4)
        q, k, v = qkv[0], qkv[1], qkv[2]
        scores = torch.einsum("bhqd,bhkd->bhqk", q, k) * (Dh ** -0.5)
        p = _softmax(scores, axis=-1)
        o = torch.einsum("bhqk,bhkd->bhqd", p, v)
        return (lambda x, *d: x.permute(*d))(o, 0, 2, 1, 3).reshape(B, S, D) @ wo

    def _B_ref(x, w_gate, w_up, w_down):
        g = torch.einsum("bsd,df->bsf", x, w_gate)
        u = torch.einsum("bsd,df->bsf", x, w_up)
        h = _gelu(g) * u
        return torch.einsum("bsf,fd->bsd", h, w_down)

    x = A_x
    xn = _layernorm(x, axis=-1)
    s = _A_ref(xn, A_wqkv, A_wo)
    g = _silu(_B_ref(xn, B_w_gate, B_w_up, B_w_down))
    return x + s * g
```

```asm
; @launch grid=(256,1,1) block=(512,1,1) lds=163840
.amdgcn_target "amdgcn-amd-amdhsa--gfx950"
.text
.globl recurrent_scan__mha_block__glu_gated_geglu__prompt_kernel
.p2align 8
.type recurrent_scan__mha_block__glu_gated_geglu__prompt_kernel,@function
recurrent_scan__mha_block__glu_gated_geglu__prompt_kernel:

    s_cmp_ge_u32 s2, 256
    s_cbranch_scc1 recurrent_scan__mha_block__glu_gated_geglu__prompt_kernel_end
    s_load_dwordx4 s[4:7], s[0:1], 0
    s_load_dwordx2 s[44:45], s[0:1], 72
    s_load_dwordx2 s[42:43], s[0:1], 64
    s_mov_b32 s3, 0
    s_and_b32 s38, s2, 7
    s_lshr_b32 s39, s2, 3
    s_and_b32 s31, s38, 3
    s_lshl_b32 s31, s31, 2
    s_and_b32 s40, s39, 3
    s_add_u32 s31, s31, s40
    s_lshr_b32 s32, s38, 2
    s_lshl_b32 s32, s32, 3
    s_lshr_b32 s40, s39, 2
    s_add_u32 s32, s32, s40
    v_and_b32 v1, 63, v0
    v_lshrrev_b32 v2, 6, v0
    s_nop 0
    v_readfirstlane_b32 s48, v2
    s_and_b32 s28, s48, 3
    s_lshr_b32 s29, s28, 1
    s_and_b32 s30, s28, 1
    v_mov_b32 v132, 0
    v_mov_b32 v140, 0
    v_mov_b32 v133, 0
    v_mov_b32 v141, 0
    v_mov_b32 v134, 0
    v_mov_b32 v142, 0
    v_mov_b32 v135, 0
    v_mov_b32 v143, 0
    v_lshlrev_b32 v2, 4, v1
    v_lshrrev_b32 v3, 4, v1
    v_and_b32 v4, 15, v1
    v_mul_u32_u24 v3, 3840, v3
    v_lshl_add_u32 v3, v4, 4, v3
    s_lshl_b32 s38, s31, 7
    s_lshl_b32 s39, s32, 3
    s_add_u32 s38, s38, s39
    s_add_u32 s51, s38, s48
    s_mul_i32 s38, s51, 1280
    s_mul_i32 s39, s31, 40
    s_mul_i32 s40, s48, 5
    s_add_u32 s39, s39, s40
    s_mul_i32 s39, s39, 3840
    s_lshl_b32 s40, s32, 8
    s_add_u32 s39, s39, s40
    s_waitcnt lgkmcnt(0)
    s_mov_b32 s8, s4
    s_mov_b32 s9, s5
    s_mov_b32 s10, 0x280000
    s_mov_b32 s11, 0x20000
    s_mov_b32 s12, s6
    s_mov_b32 s13, s7
    s_mov_b32 s14, 0x258000
    s_mov_b32 s15, 0x20000
    buffer_load_dwordx4 v[128:131], v2, s[8:11], s38 offen
    buffer_load_dwordx4 v[136:139], v3, s[12:15], s39 offen
    s_mov_b64 exec, 0xffff
    buffer_load_dwordx4 v[132:135], v2, s[8:11], s38 offen offset:1024
    s_add_u32 s39, s39, 15360
    buffer_load_dwordx4 v[140:143], v3, s[12:15], s39 offen
    s_mov_b64 exec, -1
    s_getpc_b64 s[90:91]
recurrent_scan__mha_block__glu_gated_geglu__prompt_kernel_pcref:
    s_sub_u32 s90, s90, recurrent_scan__mha_block__glu_gated_geglu__prompt_kernel_pcref-recurrent_scan__mha_block__glu_gated_geglu__prompt_kernel
    s_subb_u32 s91, s91, 0
    s_lshr_b32 s38, s2, 3
    s_lshl_b32 s38, s38, 3
    s_add_u32 s38, s38, s48
    s_lshl_b32 s38, s38, 8
    v_lshlrev_b32 v4, 7, v1
    v_add_u32 v4, s38, v4
    v_min_u32 v4, recurrent_scan__mha_block__glu_gated_geglu__prompt_kernel_end-recurrent_scan__mha_block__glu_gated_geglu__prompt_kernel, v4
    v_mov_b32 v5, s91
    v_add_co_u32 v6, vcc, s90, v4
    s_nop 1
    v_addc_co_u32 v7, vcc, 0, v5, vcc
    s_mov_b64 exec, 3
    global_load_dword v37, v[6:7], off
    s_mov_b64 exec, -1
    s_or_b32 s38, s31, s32
    s_or_b32 s38, s38, s48
    s_cmp_eq_u32 s38, 0
    s_cbranch_scc0 recurrent_scan__mha_block__glu_gated_geglu__prompt_kernel_notag
    s_memrealtime s[54:55]
    s_waitcnt lgkmcnt(0)
    s_or_b32 s54, s54, 1
    v_mov_b32 v5, 0
    v_mov_b32 v6, s54
    s_mov_b64 exec, 1
    global_store_dword v5, v6, s[42:43] sc0 sc1
    s_mov_b64 exec, -1
    s_waitcnt vmcnt(0)
recurrent_scan__mha_block__glu_gated_geglu__prompt_kernel_notag:
    s_cmp_ge_u32 s48, 4
    s_cbranch_scc1 recurrent_scan__mha_block__glu_gated_geglu__prompt_kernel_G
    s_and_b32 s38, s2, 7
    s_lshr_b32 s39, s2, 3
    s_and_b32 s76, s38, 1
    s_lshl_b32 s76, s76, 2
    s_and_b32 s40, s39, 3
    s_add_u32 s76, s76, s40
    s_lshr_b32 s77, s38, 1
    s_mul_i32 s77, s77, 7
    s_lshr_b32 s40, s39, 2
    s_add_u32 s77, s77, s40
    s_cmp_ge_u32 s40, 7
    s_cselect_b32 s77, 27, s77
    s_load_dwordx4 s[80:83], s[0:1], 32
    s_mov_b32 s86, 0
    s_mov_b32 s87, 0
    v_mov_b32 v7, 0
    v_mov_b32 v12, 0
    v_mov_b32 v13, 0
    v_mov_b32 v14, 0
    v_mov_b32 v15, 0
    s_cmp_ge_u32 s32, 15
    s_cbranch_scc1 recurrent_scan__mha_block__glu_gated_geglu__prompt_kernel_L_helper
    v_lshrrev_b32 v2, 3, v1
    v_and_b32 v3, 7, v1
    v_lshrrev_b32 v4, 4, v1
    v_add_u32 v5, 0, v4
    v_xor_b32 v5, v5, v3
    v_lshlrev_b32 v5, 4, v5
    v_mul_u32_u24 v6, 1280, v2
    v_add_u32 v5, v5, v6
    v_add_u32 v20, 0, v5
    v_add_u32 v5, 4, v4
    v_xor_b32 v5, v5, v3
    v_lshlrev_b32 v5, 4, v5
    v_mul_u32_u24 v6, 1280, v2
    v_add_u32 v5, v5, v6
    v_add_u32 v21, 9216, v5
    v_add_u32 v5, 0, v4
    v_xor_b32 v5, v5, v3
    v_lshlrev_b32 v5, 4, v5
    v_mul_u32_u24 v6, 1280, v2
    v_add_u32 v5, v5, v6
    v_add_u32 v22, 18432, v5
    v_add_u32 v5, 4, v4
    v_xor_b32 v5, v5, v3
    v_lshlrev_b32 v5, 4, v5
    v_mul_u32_u24 v6, 1280, v2
    v_add_u32 v5, v5, v6
    v_add_u32 v23, 27648, v5
    v_and_b32 v5, 1, v4
    v_lshlrev_b32 v5, 2, v5
    v_xor_b32 v5, v5, v3
    v_lshlrev_b32 v5, 4, v5
    v_mul_u32_u24 v6, 3840, v2
    v_add_u32 v5, v5, v6
    v_add_u32 v24, 0, v5
    v_add_u32 v25, 29696, v5
    v_add_u32 v26, 59392, v5
    v_add_u32 v27, 89088, v5
    s_lshl_b32 s33, s28, 12
    s_lshl_b32 s38, s31, 7
    s_lshl_b32 s39, s28, 5
    s_add_u32 s38, s38, s39
    s_mul_i32 s35, s38, 1280
    s_mul_i32 s36, s30, 122880
    s_lshl_b32 s38, s32, 8
    s_add_u32 s36, s36, s38
    s_lshl_b32 s38, s29, 7
    s_add_u32 s36, s36, s38
    s_and_b32 s38, s32, 7
    s_and_b32 s39, s31, 3
    s_mul_i32 s39, s39, 3
    s_add_u32 s57, s38, s39
    s_cmp_ge_u32 s57, 10
    s_cselect_b32 s38, 10, 0
    s_sub_u32 s57, s57, s38
    s_lshl_b32 s38, s57, 7
    s_add_u32 s35, s35, s38
    s_mul_i32 s38, s57, 245760
    s_add_u32 s36, s36, s38
    s_mov_b32 m0, s33
    s_nop 0
    buffer_load_dwordx4 v20, s[8:11], s35 offen offset:0 lds
    buffer_load_dwordx4 v21, s[8:11], s35 offen offset:1024 lds
    buffer_load_dwordx4 v22, s[8:11], s35 offen offset:2048 lds
    buffer_load_dwordx4 v23, s[8:11], s35 offen offset:3072 lds
    s_add_u32 m0, s33, 16384
    s_add_u32 s35, s35, 128
    buffer_load_dwordx4 v24, s[12:15], s36 offen offset:0 lds
    buffer_load_dwordx4 v25, s[12:15], s36 offen offset:1024 lds
    buffer_load_dwordx4 v26, s[12:15], s36 offen offset:2048 lds
    buffer_load_dwordx4 v27, s[12:15], s36 offen offset:3072 lds
    s_add_u32 s36, s36, 245760
    s_add_u32 s57, s57, 1
    s_cmp_eq_u32 s57, 10
    s_cselect_b32 s38, 1280, 0
    s_cselect_b32 s39, 2457600, 0
    s_cselect_b32 s57, 0, s57
    s_sub_u32 s35, s35, s38
    s_sub_u32 s36, s36, s39
    s_add_u32 s33, s33, 32768
    s_cmp_ge_u32 s33, 163840
    s_cselect_b32 s38, 163840, 0
    s_sub_u32 s33, s33, s38
    s_mov_b32 m0, s33
    s_nop 0
    buffer_load_dwordx4 v20, s[8:11], s35 offen offset:0 lds
    buffer_load_dwordx4 v21, s[8:11], s35 offen offset:1024 lds
    buffer_load_dwordx4 v22, s[8:11], s35 offen offset:2048 lds
    buffer_load_dwordx4 v23, s[8:11], s35 offen offset:3072 lds
    s_add_u32 m0, s33, 16384
    s_add_u32 s35, s35, 128
    buffer_load_dwordx4 v24, s[12:15], s36 offen offset:0 lds
    buffer_load_dwordx4 v25, s[12:15], s36 offen offset:1024 lds
    buffer_load_dwordx4 v26, s[12:15], s36 offen offset:2048 lds
    buffer_load_dwordx4 v27, s[12:15], s36 offen offset:3072 lds
    s_add_u32 s36, s36, 245760
    s_add_u32 s57, s57, 1
    s_cmp_eq_u32 s57, 10
    s_cselect_b32 s38, 1280, 0
    s_cselect_b32 s39, 2457600, 0
    s_cselect_b32 s57, 0, s57
    s_sub_u32 s35, s35, s38
    s_sub_u32 s36, s36, s39
    s_add_u32 s33, s33, 32768
    s_cmp_ge_u32 s33, 163840
    s_cselect_b32 s38, 163840, 0
    s_sub_u32 s33, s33, s38
    s_waitcnt vmcnt(16)
    v_lshlrev_b32 v144, 16, v128
    v_and_b32 v145, 0xffff0000, v128
    v_lshlrev_b32 v146, 16, v129
    v_and_b32 v147, 0xffff0000, v129
    v_lshlrev_b32 v148, 16, v130
    v_and_b32 v149, 0xffff0000, v130
    v_lshlrev_b32 v150, 16, v131
    v_and_b32 v151, 0xffff0000, v131
    v_lshlrev_b32 v152, 16, v132
    v_and_b32 v153, 0xffff0000, v132
    v_lshlrev_b32 v154, 16, v133
    v_and_b32 v155, 0xffff0000, v133
    v_lshlrev_b32 v156, 16, v134
    v_and_b32 v157, 0xffff0000, v134
    v_lshlrev_b32 v158, 16, v135
    v_and_b32 v159, 0xffff0000, v135
    v_add_f32 v160, v144, v145
    v_mul_f32 v161, v144, v144
    v_fmac_f32 v161, v145, v145
    v_add_f32 v160, v160, v146
    v_fmac_f32 v161, v146, v146
    v_add_f32 v160, v160, v147
    v_fmac_f32 v161, v147, v147
    v_add_f32 v160, v160, v148
    v_fmac_f32 v161, v148, v148
    v_add_f32 v160, v160, v149
    v_fmac_f32 v161, v149, v149
    v_add_f32 v160, v160, v150
    v_fmac_f32 v161, v150, v150
    v_add_f32 v160, v160, v151
    v_fmac_f32 v161, v151, v151
    v_add_f32 v160, v160, v152
    v_fmac_f32 v161, v152, v152
    v_add_f32 v160, v160, v153
    v_fmac_f32 v161, v153, v153
    v_add_f32 v160, v160, v154
    v_fmac_f32 v161, v154, v154
    v_add_f32 v160, v160, v155
    v_fmac_f32 v161, v155, v155
    v_add_f32 v160, v160, v156
    v_fmac_f32 v161, v156, v156
    v_add_f32 v160, v160, v157
    v_fmac_f32 v161, v157, v157
    v_add_f32 v160, v160, v158
    v_fmac_f32 v161, v158, v158
    v_add_f32 v160, v160, v159
    v_fmac_f32 v161, v159, v159
    v_lshlrev_b32 v164, 16, v136
    v_and_b32 v165, 0xffff0000, v136
    v_add_f32_dpp v160, v160, v160 row_ror:8 row_mask:0xf bank_mask:0xf
    v_add_f32_dpp v161, v161, v161 row_ror:8 row_mask:0xf bank_mask:0xf
    v_lshlrev_b32 v162, 16, v140
    v_and_b32 v163, 0xffff0000, v140
    v_add_f32 v164, v164, v162
    v_add_f32_dpp v160, v160, v160 row_ror:4 row_mask:0xf bank_mask:0xf
    v_add_f32_dpp v161, v161, v161 row_ror:4 row_mask:0xf bank_mask:0xf
    v_add_f32 v165, v165, v163
    v_lshlrev_b32 v166, 16, v137
    v_and_b32 v167, 0xffff0000, v137
    v_add_f32_dpp v160, v160, v160 row_ror:2 row_mask:0xf bank_mask:0xf
    v_add_f32_dpp v161, v161, v161 row_ror:2 row_mask:0xf bank_mask:0xf
    v_lshlrev_b32 v162, 16, v141
    v_and_b32 v163, 0xffff0000, v141
    v_add_f32 v166, v166, v162
    v_add_f32_dpp v160, v160, v160 row_ror:1 row_mask:0xf bank_mask:0xf
    v_add_f32_dpp v161, v161, v161 row_ror:1 row_mask:0xf bank_mask:0xf
    v_add_f32 v167, v167, v163
    v_lshlrev_b32 v168, 16, v138
    v_and_b32 v169, 0xffff0000, v138
    v_lshlrev_b32 v162, 16, v142
    v_and_b32 v163, 0xffff0000, v142
    v_add_f32 v168, v168, v162
    v_add_f32 v169, v169, v163
    v_lshlrev_b32 v170, 16, v139
    v_and_b32 v171, 0xffff0000, v139
    v_lshlrev_b32 v162, 16, v143
    v_and_b32 v163, 0xffff0000, v143
    v_add_f32 v170, v170, v162
    v_add_f32 v171, v171, v163
    v_mov_b32 v162, v160
    v_mov_b32 v163, v160
    s_nop 1
    v_permlane16_swap_b32 v162, v163
    s_nop 1
    v_add_f32 v160, v162, v163
    v_mov_b32 v162, v161
    v_mov_b32 v163, v161
    s_nop 1
    v_permlane16_swap_b32 v162, v163
    s_nop 1
    v_add_f32 v161, v162, v163
    v_mov_b32 v162, v160
    v_mov_b32 v163, v160
    s_nop 1
    v_permlane32_swap_b32 v162, v163
    s_nop 1
    v_add_f32 v160, v162, v163
    v_mov_b32 v162, v161
    v_mov_b32 v163, v161
    s_nop 1
    v_permlane32_swap_b32 v162, v163
    s_nop 1
    v_add_f32 v161, v162, v163
    v_mul_f32 v160, 0x3acccccd, v160
    v_mul_f32 v161, 0x3acccccd, v161
    v_fma_f32 v161, -v160, v160, v161
    v_max_f32 v161, 0, v161
    v_add_f32 v161, 0x3727c5ac, v161
    v_rsq_f32 v162, v161
    s_nop 0
    v_mul_f32 v163, v160, v162
    v_sub_f32 v163, 0, v163
    v_fma_f32 v144, v144, v162, v163
    v_fma_f32 v145, v145, v162, v163
    v_fma_f32 v146, v146, v162, v163
    v_fma_f32 v147, v147, v162, v163
    v_fma_f32 v148, v148, v162, v163
    v_fma_f32 v149, v149, v162, v163
    v_fma_f32 v150, v150, v162, v163
    v_fma_f32 v151, v151, v162, v163
    v_fma_f32 v152, v152, v162, v163
    v_fma_f32 v153, v153, v162, v163
    v_fma_f32 v154, v154, v162, v163
    v_fma_f32 v155, v155, v162, v163
    v_fma_f32 v156, v156, v162, v163
    v_fma_f32 v157, v157, v162, v163
    v_fma_f32 v158, v158, v162, v163
    v_fma_f32 v159, v159, v162, v163
    v_cvt_pk_bf16_f32 v128, v144, v145
    v_cvt_pk_bf16_f32 v129, v146, v147
    v_cvt_pk_bf16_f32 v130, v148, v149
    v_cvt_pk_bf16_f32 v131, v150, v151
    v_cvt_pk_bf16_f32 v132, v152, v153
    v_cvt_pk_bf16_f32 v133, v154, v155
    v_cvt_pk_bf16_f32 v134, v156, v157
    v_cvt_pk_bf16_f32 v135, v158, v159
    s_add_u32 s52, s44, 0x1850000
    s_addc_u32 s53, s45, 0
    s_mov_b32 s54, 0x4000
    s_mov_b32 s55, 0x20000
    s_mul_i32 s38, s48, 1296
    s_add_u32 s38, s38, 147456
    v_lshlrev_b32 v5, 4, v1
    v_add_u32 v5, s38, v5
    ds_write_b128 v5, v[128:131]
    s_mov_b64 exec, 0xffff
    ds_write_b128 v5, v[132:135] offset:1024
    s_mov_b64 exec, 1
    s_lshl_b32 s38, s51, 3
    v_mov_b32 v6, 0
    buffer_store_dwordx2 v[162:163], v6, s[52:55], s38 offen sc0 sc1
    s_mov_b64 exec, -1
    v_lshrrev_b32 v5, 4, v1
    s_lshl_b32 s38, s48, 2
    v_add_u32 v5, s38, v5
    v_lshlrev_b32 v5, 9, v5
    v_and_b32 v6, 15, v1
    v_lshl_add_u32 v5, v6, 5, v5
    v_add_u32 v5, 131072, v5
    ds_write_b128 v5, v[164:167]
    ds_write_b128 v5, v[168:171] offset:16
    s_waitcnt vmcnt(9) lgkmcnt(0)
    s_barrier
    s_mov_b32 m0, s33
    s_nop 0
    buffer_load_dwordx4 v20, s[8:11], s35 offen offset:0 lds
    buffer_load_dwordx4 v21, s[8:11], s35 offen offset:1024 lds
    buffer_load_dwordx4 v22, s[8:11], s35 offen offset:2048 lds
    buffer_load_dwordx4 v23, s[8:11], s35 offen offset:3072 lds
    s_add_u32 m0, s33, 16384
    s_add_u32 s35, s35, 128
    buffer_load_dwordx4 v24, s[12:15], s36 offen offset:0 lds
    buffer_load_dwordx4 v25, s[12:15], s36 offen offset:1024 lds
    buffer_load_dwordx4 v26, s[12:15], s36 offen offset:2048 lds
    buffer_load_dwordx4 v27, s[12:15], s36 offen offset:3072 lds
    s_add_u32 s36, s36, 245760
    s_add_u32 s57, s57, 1
    s_cmp_eq_u32 s57, 10
    s_cselect_b32 s38, 1280, 0
    s_cselect_b32 s39, 2457600, 0
    s_cselect_b32 s57, 0, s57
    s_sub_u32 s35, s35, s38
    s_sub_u32 s36, s36, s39
    s_add_u32 s33, s33, 32768
    s_cmp_ge_u32 s33, 163840
    s_cselect_b32 s38, 163840, 0
    s_sub_u32 s33, s33, s38
    s_add_u32 s24, s44, 0x10c0000
    s_addc_u32 s25, s45, 0
    s_mov_b32 s26, 0x280000
    s_mov_b32 s27, 0x20000
    v_and_b32 v2, 7, v1
    v_lshrrev_b32 v3, 3, v1
    s_mul_i32 s38, s28, 24
    v_add_u32 v3, s38, v3
    v_mul_u32_u24 v4, 1296, v2
    v_lshl_add_u32 v4, v3, 4, v4
    v_add_u32 v4, 147456, v4
    ds_read_b128 v[144:147], v4 offset:0
    ds_read_b128 v[148:151], v4 offset:128
    ds_read_b128 v[152:155], v4 offset:256
    s_lshl_b32 s38, s31, 7
    s_lshl_b32 s39, s32, 3
    s_add_u32 s38, s38, s39
    s_lshr_b32 s39, s38, 5
    s_mul_i32 s39, s39, 40960
    s_and_b32 s38, s38, 31
    s_lshl_b32 s38, s38, 4
    s_add_u32 s38, s38, s39
    v_add_u32 v5, 0, v3
    v_lshrrev_b32 v6, 1, v5
    v_lshlrev_b32 v6, 10, v6
    v_and_b32 v7, 1, v5
    v_lshl_add_u32 v6, v7, 9, v6
    v_lshl_add_u32 v156, v2, 4, v6
    v_cmp_gt_u32 vcc, 80, v5
    v_mov_b32 v7, 0x7fffffff
    s_nop 0
    v_cndmask_b32 v156, v7, v156, vcc
    v_add_u32 v5, 8, v3
    v_lshrrev_b32 v6, 1, v5
    v_lshlrev_b32 v6, 10, v6
    v_and_b32 v7, 1, v5
    v_lshl_add_u32 v6, v7, 9, v6
    v_lshl_add_u32 v157, v2, 4, v6
    v_cmp_gt_u32 vcc, 80, v5
    v_mov_b32 v7, 0x7fffffff
    s_nop 0
    v_cndmask_b32 v157, v7, v157, vcc
    v_add_u32 v5, 16, v3
    v_lshrrev_b32 v6, 1, v5
    v_lshlrev_b32 v6, 10, v6
    v_and_b32 v7, 1, v5
    v_lshl_add_u32 v6, v7, 9, v6
    v_lshl_add_u32 v158, v2, 4, v6
    v_cmp_gt_u32 vcc, 80, v5
    v_mov_b32 v7, 0x7fffffff
    s_nop 0
    v_cndmask_b32 v158, v7, v158, vcc
    s_waitcnt lgkmcnt(0)
    buffer_store_dwordx4 v[144:147], v156, s[24:27], s38 offen sc0 sc1
    buffer_store_dwordx4 v[148:151], v157, s[24:27], s38 offen sc0 sc1
    buffer_store_dwordx4 v[152:155], v158, s[24:27], s38 offen sc0 sc1
    v_lshrrev_b32 v5, 4, v1
    v_lshlrev_b32 v5, 12, v5
    v_and_b32 v6, 15, v1
    v_lshl_add_u32 v5, v6, 3, v5
    s_lshl_b32 s38, s28, 7
    s_add_u32 s38, s38, 131072
    v_add_u32 v5, s38, v5
    ds_read_b64 v[128:129], v5 offset:0
    ds_read_b64 v[130:131], v5 offset:512
    ds_read_b64 v[132:133], v5 offset:1024
    ds_read_b64 v[134:135], v5 offset:1536
    ds_read_b64 v[136:137], v5 offset:2048
    ds_read_b64 v[138:139], v5 offset:2560
    ds_read_b64 v[140:141], v5 offset:3072
    ds_read_b64 v[142:143], v5 offset:3584
    s_waitcnt lgkmcnt(0)
    v_add_f32 v128, v128, v130
    v_add_f32 v129, v129, v131
    v_add_f32 v132, v132, v134
    v_add_f32 v133, v133, v135
    v_add_f32 v136, v136, v138
    v_add_f32 v137, v137, v139
    v_add_f32 v140, v140, v142
    v_add_f32 v141, v141, v143
    v_add_f32 v128, v128, v132
    v_add_f32 v129, v129, v133
    v_add_f32 v136, v136, v140
    v_add_f32 v137, v137, v141
    v_add_f32 v128, v128, v136
    v_add_f32 v129, v129, v137
    v_mov_b32 v130, v128
    v_mov_b32 v131, v128
    s_nop 1
    v_permlane16_swap_b32 v130, v131
    s_nop 1
    v_add_f32 v128, v130, v131
    v_mov_b32 v130, v129
    v_mov_b32 v131, v129
    s_nop 1
    v_permlane16_swap_b32 v130, v131
    s_nop 1
    v_add_f32 v129, v130, v131
    v_mov_b32 v130, v128
    v_mov_b32 v131, v128
    s_nop 1
    v_permlane32_swap_b32 v130, v131
    s_nop 1
    v_add_f32 v128, v130, v131
    v_mov_b32 v130, v129
    v_mov_b32 v131, v129
    s_nop 1
    v_permlane32_swap_b32 v130, v131
    s_nop 1
    v_add_f32 v129, v130, v131
    s_add_u32 s52, s44, 0x1854000
    s_addc_u32 s53, s45, 0
    s_mov_b32 s54, 0x1e000
    s_mov_b32 s55, 0x20000
    s_lshl_b32 s38, s32, 4
    s_add_u32 s38, s38, s31
    s_lshl_b32 s38, s38, 9
    s_lshl_b32 s39, s28, 7
    s_add_u32 s38, s38, s39
    v_lshlrev_b32 v6, 3, v6
    s_mov_b64 exec, 0xffff
    buffer_store_dwordx2 v[128:129], v6, s[52:55], s38 offen sc0 sc1
    s_mov_b64 exec, -1
    v_mov_b32 v45, 0
    global_load_dword v44, v45, s[42:43] sc0 sc1
    s_waitcnt vmcnt(14) lgkmcnt(0)
    s_barrier
    s_mov_b32 m0, s33
    s_nop 0
    buffer_load_dwordx4 v20, s[8:11], s35 offen offset:0 lds
    buffer_load_dwordx4 v21, s[8:11], s35 offen offset:1024 lds
    buffer_load_dwordx4 v22, s[8:11], s35 offen offset:2048 lds
    buffer_load_dwordx4 v23, s[8:11], s35 offen offset:3072 lds
    s_add_u32 m0, s33, 16384
    s_add_u32 s35, s35, 128
    buffer_load_dwordx4 v24, s[12:15], s36 offen offset:0 lds
    buffer_load_dwordx4 v25, s[12:15], s36 offen offset:1024 lds
    buffer_load_dwordx4 v26, s[12:15], s36 offen offset:2048 lds
    buffer_load_dwordx4 v27, s[12:15], s36 offen offset:3072 lds
    s_add_u32 s36, s36, 245760
    s_add_u32 s57, s57, 1
    s_cmp_eq_u32 s57, 10
    s_cselect_b32 s38, 1280, 0
    s_cselect_b32 s39, 2457600, 0
    s_cselect_b32 s57, 0, s57
    s_sub_u32 s35, s35, s38
    s_sub_u32 s36, s36, s39
    s_add_u32 s33, s33, 32768
    s_cmp_ge_u32 s33, 163840
    s_cselect_b32 s38, 163840, 0
    s_sub_u32 s33, s33, s38
    s_mov_b32 m0, s33
    s_nop 0
    buffer_load_dwordx4 v20, s[8:11], s35 offen offset:0 lds
    buffer_load_dwordx4 v21, s[8:11], s35 offen offset:1024 lds
    buffer_load_dwordx4 v22, s[8:11], s35 offen offset:2048 lds
    buffer_load_dwordx4 v23, s[8:11], s35 offen offset:3072 lds
    s_add_u32 m0, s33, 16384
    s_add_u32 s35, s35, 128
    buffer_load_dwordx4 v24, s[12:15], s36 offen offset:0 lds
    buffer_load_dwordx4 v25, s[12:15], s36 offen offset:1024 lds
    buffer_load_dwordx4 v26, s[12:15], s36 offen offset:2048 lds
    buffer_load_dwordx4 v27, s[12:15], s36 offen offset:3072 lds
    s_add_u32 s36, s36, 245760
    s_add_u32 s57, s57, 1
    s_cmp_eq_u32 s57, 10
    s_cselect_b32 s38, 1280, 0
    s_cselect_b32 s39, 2457600, 0
    s_cselect_b32 s57, 0, s57
    s_sub_u32 s35, s35, s38
    s_sub_u32 s36, s36, s39
    s_add_u32 s33, s33, 32768
    s_cmp_ge_u32 s33, 163840
    s_cselect_b32 s38, 163840, 0
    s_sub_u32 s33, s33, s38
    s_waitcnt vmcnt(18)
    s_barrier
    s_mov_b32 m0, s33
    s_nop 0
    buffer_load_dwordx4 v20, s[8:11], s35 offen offset:0 lds
    buffer_load_dwordx4 v21, s[8:11], s35 offen offset:1024 lds
    buffer_load_dwordx4 v22, s[8:11], s35 offen offset:2048 lds
    buffer_load_dwordx4 v23, s[8:11], s35 offen offset:3072 lds
    s_add_u32 m0, s33, 16384
    s_add_u32 s35, s35, 128
    buffer_load_dwordx4 v24, s[12:15], s36 offen offset:0 lds
    buffer_load_dwordx4 v25, s[12:15], s36 offen offset:1024 lds
    buffer_load_dwordx4 v26, s[12:15], s36 offen offset:2048 lds
    buffer_load_dwordx4 v27, s[12:15], s36 offen offset:3072 lds
    s_add_u32 s36, s36, 245760
    s_add_u32 s57, s57, 1
    s_cmp_eq_u32 s57, 10
    s_cselect_b32 s38, 1280, 0
    s_cselect_b32 s39, 2457600, 0
    s_cselect_b32 s57, 0, s57
    s_sub_u32 s35, s35, s38
    s_sub_u32 s36, s36, s39
    s_add_u32 s33, s33, 32768
    s_cmp_ge_u32 s33, 163840
    s_cselect_b32 s38, 163840, 0
    s_sub_u32 s33, s33, s38
    s_waitcnt vmcnt(16)
    s_barrier
    v_readfirstlane_b32 s3, v44
    s_cmp_lg_u32 s3, 0
    s_cbranch_scc1 recurrent_scan__mha_block__glu_gated_geglu__prompt_kernel_havetag
    v_mov_b32 v5, 0
    s_mov_b32 s40, 0
recurrent_scan__mha_block__glu_gated_geglu__prompt_kernel_tag_1:
    global_load_dword v6, v5, s[42:43] sc0 sc1
    s_waitcnt vmcnt(0)
    v_readfirstlane_b32 s3, v6
    s_cmp_lg_u32 s3, 0
    s_cbranch_scc1 recurrent_scan__mha_block__glu_gated_geglu__prompt_kernel_tag_1_ok
    s_sleep 2
    s_add_u32 s40, s40, 1
    s_cmp_lt_u32 s40, 32768
    s_cbranch_scc1 recurrent_scan__mha_block__glu_gated_geglu__prompt_kernel_tag_1
recurrent_scan__mha_block__glu_gated_geglu__prompt_kernel_tag_1_ok:
recurrent_scan__mha_block__glu_gated_geglu__prompt_kernel_havetag:
    s_cmp_eq_u32 s28, 0
    s_cbranch_scc0 recurrent_scan__mha_block__glu_gated_geglu__prompt_kernel_nfl
    s_lshl_b32 s38, s31, 4
    s_add_u32 s38, s38, s32
    s_add_u32 s52, s44, 0x1848000
    s_addc_u32 s53, s45, 0
    s_mov_b32 s54, 0x8000
    s_mov_b32 s55, 0x20000
    s_lshl_b32 s38, s38, 7
    v_mov_b32 v5, s38
    v_mov_b32 v6, s3
    s_mov_b64 exec, 1
    buffer_store_dword v6, v5, s[52:55], 0 offen sc0 sc1
    s_mov_b64 exec, -1
recurrent_scan__mha_block__glu_gated_geglu__prompt_kernel_nfl:
    s_mov_b32 m0, s33
    s_nop 0
    buffer_load_dwordx4 v20, s[8:11], s35 offen offset:0 lds
    buffer_load_dwordx4 v21, s[8:11], s35 offen offset:1024 lds
    buffer_load_dwordx4 v22, s[8:11], s35 offen offset:2048 lds
    buffer_load_dwordx4 v23, s[8:11], s35 offen offset:3072 lds
    s_add_u32 m0, s33, 16384
    s_add_u32 s35, s35, 128
    buffer_load_dwordx4 v24, s[12:15], s36 offen offset:0 lds
    buffer_load_dwordx4 v25, s[12:15], s36 offen offset:1024 lds
    buffer_load_dwordx4 v26, s[12:15], s36 offen offset:2048 lds
    buffer_load_dwordx4 v27, s[12:15], s36 offen offset:3072 lds
    s_add_u32 s36, s36, 245760
    s_add_u32 s57, s57, 1
    s_cmp_eq_u32 s57, 10
    s_cselect_b32 s38, 1280, 0
    s_cselect_b32 s39, 2457600, 0
    s_cselect_b32 s57, 0, s57
    s_sub_u32 s35, s35, s38
    s_sub_u32 s36, s36, s39
    s_add_u32 s33, s33, 32768
    s_cmp_ge_u32 s33, 163840
    s_cselect_b32 s38, 163840, 0
    s_sub_u32 s33, s33, s38
    s_waitcnt vmcnt(16)
    s_barrier
    s_mov_b32 m0, s33
    s_nop 0
    buffer_load_dwordx4 v20, s[8:11], s35 offen offset:0 lds
    buffer_load_dwordx4 v21, s[8:11], s35 offen offset:1024 lds
    buffer_load_dwordx4 v22, s[8:11], s35 offen offset:2048 lds
    buffer_load_dwordx4 v23, s[8:11], s35 offen offset:3072 lds
    s_add_u32 m0, s33, 16384
    s_add_u32 s35, s35, 128
    buffer_load_dwordx4 v24, s[12:15], s36 offen offset:0 lds
    buffer_load_dwordx4 v25, s[12:15], s36 offen offset:1024 lds
    buffer_load_dwordx4 v26, s[12:15], s36 offen offset:2048 lds
    buffer_load_dwordx4 v27, s[12:15], s36 offen offset:3072 lds
    s_add_u32 s36, s36, 245760
    s_add_u32 s57, s57, 1
    s_cmp_eq_u32 s57, 10
    s_cselect_b32 s38, 1280, 0
    s_cselect_b32 s39, 2457600, 0
    s_cselect_b32 s57, 0, s57
    s_sub_u32 s35, s35, s38
    s_sub_u32 s36, s36, s39
    s_add_u32 s33, s33, 32768
    s_cmp_ge_u32 s33, 163840
    s_cselect_b32 s38, 163840, 0
    s_sub_u32 s33, s33, s38
    s_waitcnt vmcnt(16)
    s_barrier
    v_and_b32 v2, 15, v1
    s_lshl_b32 s38, s31, 4
    v_add_u32 v3, s38, v2
    v_lshlrev_b32 v4, 4, v2
    v_add_u32 v4, s32, v4
    v_and_b32 v2, 16, v1
    v_cmp_eq_u32 vcc, 0, v2
    s_nop 1
    v_cndmask_b32 v3, v4, v3, vcc
    v_lshlrev_b32 v46, 7, v3
    s_add_u32 s52, s44, 0x1848000
    s_addc_u32 s53, s45, 0
    s_mov_b32 s54, 0x8000
    s_mov_b32 s55, 0x20000
    buffer_load_dword v47, v46, s[52:55], 0 offen sc0 sc1
    v_and_b32 v49, 31, v1
    s_lshl_b32 s38, s76, 5
    v_add_u32 v49, s38, v49
    v_lshlrev_b32 v49, 7, v49
    buffer_load_dword v48, v49, s[52:55], 0 offen sc0 sc1
    s_mov_b32 m0, s33
    s_nop 0
    buffer_load_dwordx4 v20, s[8:11], s35 offen offset:0 lds
    buffer_load_dwordx4 v21, s[8:11], s35 offen offset:1024 lds
    buffer_load_dwordx4 v22, s[8:11], s35 offen offset:2048 lds
    buffer_load_dwordx4 v23, s[8:11], s35 offen offset:3072 lds
    s_add_u32 m0, s33, 16384
    s_add_u32 s35, s35, 128
    buffer_load_dwordx4 v24, s[12:15], s36 offen offset:0 lds
    buffer_load_dwordx4 v25, s[12:15], s36 offen offset:1024 lds
    buffer_load_dwordx4 v26, s[12:15], s36 offen offset:2048 lds
    buffer_load_dwordx4 v27, s[12:15], s36 offen offset:3072 lds
    s_add_u32 s36, s36, 245760
    s_add_u32 s57, s57, 1
    s_cmp_eq_u32 s57, 10
    s_cselect_b32 s38, 1280, 0
    s_cselect_b32 s39, 2457600, 0
    s_cselect_b32 s57, 0, s57
    s_sub_u32 s35, s35, s38
    s_sub_u32 s36, s36, s39
    s_add_u32 s33, s33, 32768
    s_cmp_ge_u32 s33, 163840
    s_cselect_b32 s38, 163840, 0
    s_sub_u32 s33, s33, s38
    s_waitcnt vmcnt(18)
    s_barrier
    s_mov_b32 m0, s33
    s_nop 0
    buffer_load_dwordx4 v20, s[8:11], s35 offen offset:0 lds
    buffer_load_dwordx4 v21, s[8:11], s35 offen offset:1024 lds
    buffer_load_dwordx4 v22, s[8:11], s35 offen offset:2048 lds
    buffer_load_dwordx4 v23, s[8:11], s35 offen offset:3072 lds
    s_add_u32 m0, s33, 16384
    s_add_u32 s35, s35, 128
    buffer_load_dwordx4 v24, s[12:15], s36 offen offset:0 lds
    buffer_load_dwordx4 v25, s[12:15], s36 offen offset:1024 lds
    buffer_load_dwordx4 v26, s[12:15], s36 offen offset:2048 lds
    buffer_load_dwordx4 v27, s[12:15], s36 offen offset:3072 lds
    s_add_u32 s36, s36, 245760
    s_add_u32 s57, s57, 1
    s_cmp_eq_u32 s57, 10
    s_cselect_b32 s38, 1280, 0
    s_cselect_b32 s39, 2457600, 0
    s_cselect_b32 s57, 0, s57
    s_sub_u32 s35, s35, s38
    s_sub_u32 s36, s36, s39
    s_add_u32 s33, s33, 32768
    s_cmp_ge_u32 s33, 163840
    s_cselect_b32 s38, 163840, 0
    s_sub_u32 s33, s33, s38
    s_waitcnt vmcnt(16)
    s_barrier
    v_cmp_ne_u32 vcc, s3, v47
    s_nop 1
    s_cmp_eq_u64 vcc, 0
    s_cbranch_scc1 recurrent_scan__mha_block__glu_gated_geglu__prompt_kernel_qflags
    s_mov_b32 s40, 0
recurrent_scan__mha_block__glu_gated_geglu__prompt_kernel_qpoll_2:
    buffer_load_dword v47, v46, s[52:55], 0 offen sc0 sc1
    s_waitcnt vmcnt(0)
    v_cmp_ne_u32 vcc, s3, v47
    s_nop 1
    s_cmp_eq_u64 vcc, 0
    s_cbranch_scc1 recurrent_scan__mha_block__glu_gated_geglu__prompt_kernel_qpoll_2_ok
    s_sleep 4
    s_add_u32 s40, s40, 1
    s_cmp_lt_u32 s40, 32768
    s_cbranch_scc1 recurrent_scan__mha_block__glu_gated_geglu__prompt_kernel_qpoll_2
recurrent_scan__mha_block__glu_gated_geglu__prompt_kernel_qpoll_2_ok:
recurrent_scan__mha_block__glu_gated_geglu__prompt_kernel_qflags:
    s_add_u32 s52, s44, 0x1850000
    s_addc_u32 s53, s45, 0
    s_mov_b32 s54, 0x4000
    s_mov_b32 s55, 0x20000
    s_add_u32 s24, s44, 0x1854000
    s_addc_u32 s25, s45, 0
    s_mov_b32 s26, 0x1e000
    s_mov_b32 s27, 0x20000
    v_and_b32 v2, 31, v1
    v_lshlrev_b32 v3, 3, v2
    s_lshl_b32 s38, s31, 7
    s_lshl_b32 s39, s28, 5
    s_add_u32 s38, s38, s39
    s_lshl_b32 s38, s38, 3
    buffer_load_dwordx2 v[128:129], v3, s[52:55], s38 offen sc0 sc1
    v_lshrrev_b32 v4, 3, v1
    v_lshlrev_b32 v4, 9, v4
    v_and_b32 v5, 7, v1
    v_lshl_add_u32 v4, v5, 4, v4
    s_lshl_b32 s38, s32, 13
    s_lshl_b32 s39, s28, 7
    s_add_u32 s38, s38, s39
    buffer_load_dwordx4 v[132:135], v4, s[24:27], s38 offen sc0 sc1
    s_add_u32 s38, s38, 4096
    buffer_load_dwordx4 v[136:139], v4, s[24:27], s38 offen sc0 sc1
    s_waitcnt lgkmcnt(0)
    v_mul_u32_u24 v52, 9363, v1
    v_lshrrev_b32 v52, 16, v52
    v_mul_u32_u24 v53, 7, v52
    v_sub_u32 v53, v1, v53
    v_mul_u32_u24 v52, 3456, v52
    v_lshl_add_u32 v52, v53, 7, v52
    s_lshr_b32 s38, s2, 3
    s_mul_i32 s38, s38, 20
    s_mul_i32 s39, s30, 10
    s_add_u32 s38, s38, s39
    s_mul_i32 s38, s38, 3456
    s_and_b32 s39, s2, 7
    s_lshr_b32 s39, s39, 1
    s_mul_i32 s39, s39, 896
    s_add_u32 s38, s38, s39
    s_cmp_eq_u32 s29, 0
    s_cselect_b32 s84, s80, s82
    s_cselect_b32 s85, s81, s83
    s_mov_b32 s88, s84
    s_mov_b32 s89, s85
    s_mov_b32 s90, 0x21c000
    s_mov_b32 s91, 0x20000
    buffer_load_dword v50, v52, s[88:91], s38 offen
    s_add_u32 s38, s38, 31104
    s_mov_b64 exec, 0x7f
    buffer_load_dword v51, v52, s[88:91], s38 offen
    s_mov_b64 exec, -1
    s_waitcnt vmcnt(13)
    s_barrier
    s_waitcnt vmcnt(5)
    s_barrier
    s_waitcnt vmcnt(2)
    v_add_f32 v132, v132, v136
    v_add_f32 v133, v133, v137
    v_add_f32 v134, v134, v138
    v_add_f32 v135, v135, v139
    s_nop 1
    v_add_f32_dpp v132, v132, v132 row_ror:8 row_mask:0xf bank_mask:0xf
    v_add_f32_dpp v133, v133, v133 row_ror:8 row_mask:0xf bank_mask:0xf
    v_add_f32_dpp v134, v134, v134 row_ror:8 row_mask:0xf bank_mask:0xf
    v_add_f32_dpp v135, v135, v135 row_ror:8 row_mask:0xf bank_mask:0xf
    v_mov_b32 v140, v132
    v_mov_b32 v141, v132
    s_nop 1
    v_permlane16_swap_b32 v140, v141
    s_nop 1
    v_add_f32 v132, v140, v141
    v_mov_b32 v140, v133
    v_mov_b32 v141, v133
    s_nop 1
    v_permlane16_swap_b32 v140, v141
    s_nop 1
    v_add_f32 v133, v140, v141
    v_mov_b32 v140, v134
    v_mov_b32 v141, v134
    s_nop 1
    v_permlane16_swap_b32 v140, v141
    s_nop 1
    v_add_f32 v134, v140, v141
    v_mov_b32 v140, v135
    v_mov_b32 v141, v135
    s_nop 1
    v_permlane16_swap_b32 v140, v141
    s_nop 1
    v_add_f32 v135, v140, v141
    v_mov_b32 v140, v132
    v_mov_b32 v141, v132
    s_nop 1
    v_permlane32_swap_b32 v140, v141
    s_nop 1
    v_add_f32 v132, v140, v141
    v_mov_b32 v140, v133
    v_mov_b32 v141, v133
    s_nop 1
    v_permlane32_swap_b32 v140, v141
    s_nop 1
    v_add_f32 v133, v140, v141
    v_mov_b32 v140, v134
    v_mov_b32 v141, v134
    s_nop 1
    v_permlane32_swap_b32 v140, v141
    s_nop 1
    v_add_f32 v134, v140, v141
    v_mov_b32 v140, v135
    v_mov_b32 v141, v135
    s_nop 1
    v_permlane32_swap_b32 v140, v141
    s_nop 1
    v_add_f32 v135, v140, v141
    s_lshl_b32 s38, s28, 7
    s_add_u32 s38, s38, 32768
    v_lshl_add_u32 v3, v2, 2, s38
    ds_write_b32 v3, v128
    ds_write_b32 v3, v129 offset:512
    v_lshl_add_u32 v5, v5, 4, s38
    s_mov_b64 exec, 0xff
    ds_write_b128 v5, v[132:135] offset:1024
    s_mov_b64 exec, -1
    s_waitcnt lgkmcnt(0)
    s_barrier
    s_branch recurrent_scan__mha_block__glu_gated_geglu__prompt_kernel_L_gu
recurrent_scan__mha_block__glu_gated_geglu__prompt_kernel_L_helper:
    s_waitcnt vmcnt(0)
    v_lshlrev_b32 v144, 16, v128
    v_and_b32 v145, 0xffff0000, v128
    v_lshlrev_b32 v146, 16, v129
    v_and_b32 v147, 0xffff0000, v129
    v_lshlrev_b32 v148, 16, v130
    v_and_b32 v149, 0xffff0000, v130
    v_lshlrev_b32 v150, 16, v131
    v_and_b32 v151, 0xffff0000, v131
    v_lshlrev_b32 v152, 16, v132
    v_and_b32 v153, 0xffff0000, v132
    v_lshlrev_b32 v154, 16, v133
    v_and_b32 v155, 0xffff0000, v133
    v_lshlrev_b32 v156, 16, v134
    v_and_b32 v157, 0xffff0000, v134
    v_lshlrev_b32 v158, 16, v135
    v_and_b32 v159, 0xffff0000, v135
    v_add_f32 v160, v144, v145
    v_mul_f32 v161, v144, v144
    v_fmac_f32 v161, v145, v145
    v_add_f32 v160, v160, v146
    v_fmac_f32 v161, v146, v146
    v_add_f32 v160, v160, v147
    v_fmac_f32 v161, v147, v147
    v_add_f32 v160, v160, v148
    v_fmac_f32 v161, v148, v148
    v_add_f32 v160, v160, v149
    v_fmac_f32 v161, v149, v149
    v_add_f32 v160, v160, v150
    v_fmac_f32 v161, v150, v150
    v_add_f32 v160, v160, v151
    v_fmac_f32 v161, v151, v151
    v_add_f32 v160, v160, v152
    v_fmac_f32 v161, v152, v152
    v_add_f32 v160, v160, v153
    v_fmac_f32 v161, v153, v153
    v_add_f32 v160, v160, v154
    v_fmac_f32 v161, v154, v154
    v_add_f32 v160, v160, v155
    v_fmac_f32 v161, v155, v155
    v_add_f32 v160, v160, v156
    v_fmac_f32 v161, v156, v156
    v_add_f32 v160, v160, v157
    v_fmac_f32 v161, v157, v157
    v_add_f32 v160, v160, v158
    v_fmac_f32 v161, v158, v158
    v_add_f32 v160, v160, v159
    v_fmac_f32 v161, v159, v159
    v_lshlrev_b32 v164, 16, v136
    v_and_b32 v165, 0xffff0000, v136
    v_add_f32_dpp v160, v160, v160 row_ror:8 row_mask:0xf bank_mask:0xf
    v_add_f32_dpp v161, v161, v161 row_ror:8 row_mask:0xf bank_mask:0xf
    v_lshlrev_b32 v162, 16, v140
    v_and_b32 v163, 0xffff0000, v140
    v_add_f32 v164, v164, v162
    v_add_f32_dpp v160, v160, v160 row_ror:4 row_mask:0xf bank_mask:0xf
    v_add_f32_dpp v161, v161, v161 row_ror:4 row_mask:0xf bank_mask:0xf
    v_add_f32 v165, v165, v163
    v_lshlrev_b32 v166, 16, v137
    v_and_b32 v167, 0xffff0000, v137
    v_add_f32_dpp v160, v160, v160 row_ror:2 row_mask:0xf bank_mask:0xf
    v_add_f32_dpp v161, v161, v161 row_ror:2 row_mask:0xf bank_mask:0xf
    v_lshlrev_b32 v162, 16, v141
    v_and_b32 v163, 0xffff0000, v141
    v_add_f32 v166, v166, v162
    v_add_f32_dpp v160, v160, v160 row_ror:1 row_mask:0xf bank_mask:0xf
    v_add_f32_dpp v161, v161, v161 row_ror:1 row_mask:0xf bank_mask:0xf
    v_add_f32 v167, v167, v163
    v_lshlrev_b32 v168, 16, v138
    v_and_b32 v169, 0xffff0000, v138
    v_lshlrev_b32 v162, 16, v142
    v_and_b32 v163, 0xffff0000, v142
    v_add_f32 v168, v168, v162
    v_add_f32 v169, v169, v163
    v_lshlrev_b32 v170, 16, v139
    v_and_b32 v171, 0xffff0000, v139
    v_lshlrev_b32 v162, 16, v143
    v_and_b32 v163, 0xffff0000, v143
    v_add_f32 v170, v170, v162
    v_add_f32 v171, v171, v163
    v_mov_b32 v162, v160
    v_mov_b32 v163, v160
    s_nop 1
    v_permlane16_swap_b32 v162, v163
    s_nop 1
    v_add_f32 v160, v162, v163
    v_mov_b32 v162, v161
    v_mov_b32 v163, v161
    s_nop 1
    v_permlane16_swap_b32 v162, v163
    s_nop 1
    v_add_f32 v161, v162, v163
    v_mov_b32 v162, v160
    v_mov_b32 v163, v160
    s_nop 1
    v_permlane32_swap_b32 v162, v163
    s_nop 1
    v_add_f32 v160, v162, v163
    v_mov_b32 v162, v161
    v_mov_b32 v163, v161
    s_nop 1
    v_permlane32_swap_b32 v162, v163
    s_nop 1
    v_add_f32 v161, v162, v163
    v_mul_f32 v160, 0x3acccccd, v160
    v_mul_f32 v161, 0x3acccccd, v161
    v_fma_f32 v161, -v160, v160, v161
    v_max_f32 v161, 0, v161
    v_add_f32 v161, 0x3727c5ac, v161
    v_rsq_f32 v162, v161
    s_nop 0
    v_mul_f32 v163, v160, v162
    v_sub_f32 v163, 0, v163
    v_fma_f32 v144, v144, v162, v163
    v_fma_f32 v145, v145, v162, v163
    v_fma_f32 v146, v146, v162, v163
    v_fma_f32 v147, v147, v162, v163
    v_fma_f32 v148, v148, v162, v163
    v_fma_f32 v149, v149, v162, v163
    v_fma_f32 v150, v150, v162, v163
    v_fma_f32 v151, v151, v162, v163
    v_fma_f32 v152, v152, v162, v163
    v_fma_f32 v153, v153, v162, v163
    v_fma_f32 v154, v154, v162, v163
    v_fma_f32 v155, v155, v162, v163
    v_fma_f32 v156, v156, v162, v163
    v_fma_f32 v157, v157, v162, v163
    v_fma_f32 v158, v158, v162, v163
    v_fma_f32 v159, v159, v162, v163
    v_cvt_pk_bf16_f32 v128, v144, v145
    v_cvt_pk_bf16_f32 v129, v146, v147
    v_cvt_pk_bf16_f32 v130, v148, v149
    v_cvt_pk_bf16_f32 v131, v150, v151
    v_cvt_pk_bf16_f32 v132, v152, v153
    v_cvt_pk_bf16_f32 v133, v154, v155
    v_cvt_pk_bf16_f32 v134, v156, v157
    v_cvt_pk_bf16_f32 v135, v158, v159
    s_add_u32 s52, s44, 0x1850000
    s_addc_u32 s53, s45, 0
    s_mov_b32 s54, 0x4000
    s_mov_b32 s55, 0x20000
    s_mul_i32 s38, s48, 1296
    s_add_u32 s38, s38, 147456
    v_lshlrev_b32 v5, 4, v1
    v_add_u32 v5, s38, v5
    ds_write_b128 v5, v[128:131]
    s_mov_b64 exec, 0xffff
    ds_write_b128 v5, v[132:135] offset:1024
    s_mov_b64 exec, 1
    s_lshl_b32 s38, s51, 3
    v_mov_b32 v6, 0
    buffer_store_dwordx2 v[162:163], v6, s[52:55], s38 offen sc0 sc1
    s_mov_b64 exec, -1
    s_waitcnt vmcnt(0) lgkmcnt(0)
    s_barrier
    s_add_u32 s24, s44, 0x10c0000
    s_addc_u32 s25, s45, 0
    s_mov_b32 s26, 0x280000
    s_mov_b32 s27, 0x20000
    v_and_b32 v2, 7, v1
    v_lshrrev_b32 v3, 3, v1
    s_mul_i32 s38, s28, 24
    v_add_u32 v3, s38, v3
    v_mul_u32_u24 v4, 1296, v2
    v_lshl_add_u32 v4, v3, 4, v4
    v_add_u32 v4, 147456, v4
    ds_read_b128 v[144:147], v4 offset:0
    ds_read_b128 v[148:151], v4 offset:128
    ds_read_b128 v[152:155], v4 offset:256
    s_lshl_b32 s38, s31, 7
    s_lshl_b32 s39, s32, 3
    s_add_u32 s38, s38, s39
    s_lshr_b32 s39, s38, 5
    s_mul_i32 s39, s39, 40960
    s_and_b32 s38, s38, 31
    s_lshl_b32 s38, s38, 4
    s_add_u32 s38, s38, s39
    v_add_u32 v5, 0, v3
    v_lshrrev_b32 v6, 1, v5
    v_lshlrev_b32 v6, 10, v6
    v_and_b32 v7, 1, v5
    v_lshl_add_u32 v6, v7, 9, v6
    v_lshl_add_u32 v156, v2, 4, v6
    v_cmp_gt_u32 vcc, 80, v5
    v_mov_b32 v7, 0x7fffffff
    s_nop 0
    v_cndmask_b32 v156, v7, v156, vcc
    v_add_u32 v5, 8, v3
    v_lshrrev_b32 v6, 1, v5
    v_lshlrev_b32 v6, 10, v6
    v_and_b32 v7, 1, v5
    v_lshl_add_u32 v6, v7, 9, v6
    v_lshl_add_u32 v157, v2, 4, v6
    v_cmp_gt_u32 vcc, 80, v5
    v_mov_b32 v7, 0x7fffffff
    s_nop 0
    v_cndmask_b32 v157, v7, v157, vcc
    v_add_u32 v5, 16, v3
    v_lshrrev_b32 v6, 1, v5
    v_lshlrev_b32 v6, 10, v6
    v_and_b32 v7, 1, v5
    v_lshl_add_u32 v6, v7, 9, v6
    v_lshl_add_u32 v158, v2, 4, v6
    v_cmp_gt_u32 vcc, 80, v5
    v_mov_b32 v7, 0x7fffffff
    s_nop 0
    v_cndmask_b32 v158, v7, v158, vcc
    s_waitcnt lgkmcnt(0)
    buffer_store_dwordx4 v[144:147], v156, s[24:27], s38 offen sc0 sc1
    buffer_store_dwordx4 v[148:151], v157, s[24:27], s38 offen sc0 sc1
    buffer_store_dwordx4 v[152:155], v158, s[24:27], s38 offen sc0 sc1
    s_waitcnt vmcnt(0)
    s_barrier
    v_mov_b32 v5, 0
    s_mov_b32 s40, 0
recurrent_scan__mha_block__glu_gated_geglu__prompt_kernel_tag_3:
    global_load_dword v6, v5, s[42:43] sc0 sc1
    s_waitcnt vmcnt(0)
    v_readfirstlane_b32 s3, v6
    s_cmp_lg_u32 s3, 0
    s_cbranch_scc1 recurrent_scan__mha_block__glu_gated_geglu__prompt_kernel_tag_3_ok
    s_sleep 2
    s_add_u32 s40, s40, 1
    s_cmp_lt_u32 s40, 32768
    s_cbranch_scc1 recurrent_scan__mha_block__glu_gated_geglu__prompt_kernel_tag_3
recurrent_scan__mha_block__glu_gated_geglu__prompt_kernel_tag_3_ok:
    v_mov_b32 v48, 0
    v_and_b32 v49, 31, v1
    s_lshl_b32 s38, s76, 5
    v_add_u32 v49, s38, v49
    v_lshlrev_b32 v49, 7, v49
    s_waitcnt lgkmcnt(0)
    s_cmp_eq_u32 s28, 0
    s_cbranch_scc0 recurrent_scan__mha_block__glu_gated_geglu__prompt_kernel_L_gu0
    s_lshl_b32 s38, s31, 4
    s_add_u32 s38, s38, s32
    s_add_u32 s52, s44, 0x1848000
    s_addc_u32 s53, s45, 0
    s_mov_b32 s54, 0x8000
    s_mov_b32 s55, 0x20000
    s_lshl_b32 s38, s38, 7
    v_mov_b32 v5, s38
    v_mov_b32 v6, s3
    s_mov_b64 exec, 1
    buffer_store_dword v6, v5, s[52:55], 0 offen sc0 sc1
    s_mov_b64 exec, -1
    s_branch recurrent_scan__mha_block__glu_gated_geglu__prompt_kernel_L_gu0
recurrent_scan__mha_block__glu_gated_geglu__prompt_kernel_L_gu:
    s_barrier
recurrent_scan__mha_block__glu_gated_geglu__prompt_kernel_L_gu0:
    v_lshlrev_b32 v3, 2, v1
    v_add_u32 v3, 147456, v3
    v_mov_b32 v4, 0
    s_cmp_eq_u32 s28, 0
    s_cbranch_scc0 recurrent_scan__mha_block__glu_gated_geglu__prompt_kernel_noinit
    ds_write_b32 v3, v4
    s_waitcnt lgkmcnt(0)
recurrent_scan__mha_block__glu_gated_geglu__prompt_kernel_noinit:
    s_barrier
    s_setprio 1
    s_mov_b32 s31, s76
    s_mov_b32 s32, s77
    s_cmp_ge_u32 s32, 27
    s_cbranch_scc1 recurrent_scan__mha_block__glu_gated_geglu__prompt_kernel_L_nogu
    v_lshrrev_b32 v2, 3, v1
    v_and_b32 v3, 7, v1
    v_bfe_u32 v5, v1, 4, 1
    v_lshlrev_b32 v5, 2, v5
    v_xor_b32 v5, v5, v3
    v_lshlrev_b32 v5, 4, v5
    v_mul_u32_u24 v6, 3456, v2
    v_add_u32 v5, v5, v6
    v_add_u32 v12, 0, v5
    v_add_u32 v13, 26624, v5
    v_add_u32 v14, 53248, v5
    v_add_u32 v15, 79872, v5
    v_lshlrev_b32 v7, 4, v1
    s_lshl_b32 s38, s31, 3
    s_lshl_b32 s39, s28, 1
    s_add_u32 s38, s38, s39
    s_mul_i32 s35, s38, 40960
    s_mul_i32 s36, s30, 110592
    s_lshl_b32 s38, s32, 7
    s_add_u32 s36, s36, s38
    s_cmp_ge_u32 s28, 2
    s_cselect_b32 s4, s82, s80
    s_cselect_b32 s5, s83, s81
    s_mov_b32 s12, s4
    s_mov_b32 s13, s5
    s_mov_b32 s14, 0x21c000
    s_mov_b32 s15, 0x20000
    s_add_u32 s8, s44, 0x10c0000
    s_addc_u32 s9, s45, 0
    s_mov_b32 s10, 0x280000
    s_mov_b32 s11, 0x20000
    s_mov_b32 s34, 0
    s_mov_b32 s86, 0
    s_cmp_eq_u32 s86, 1
    s_cbranch_scc1 recurrent_scan__mha_block__glu_gated_geglu__prompt_kernel_L_xnok
    v_cmp_ne_u32 vcc, s3, v48
    s_nop 1
    s_cmp_eq_u64 vcc, 0
    s_cbranch_scc1 recurrent_scan__mha_block__glu_gated_geglu__prompt_kernel_L_xn0
    s_add_u32 s52, s44, 0x1848000
    s_addc_u32 s53, s45, 0
    s_mov_b32 s54, 0x8000
    s_mov_b32 s55, 0x20000
    s_mov_b32 s40, 0
recurrent_scan__mha_block__glu_gated_geglu__prompt_kernel_lxpoll_4:
    buffer_load_dword v48, v49, s[52:55], 0 offen sc0 sc1
    s_waitcnt vmcnt(0)
    v_cmp_ne_u32 vcc, s3, v48
    s_nop 1
    s_cmp_eq_u64 vcc, 0
    s_cbranch_scc1 recurrent_scan__mha_block__glu_gated_geglu__prompt_kernel_lxpoll_4_ok
    s_sleep 4
    s_add_u32 s40, s40, 1
    s_cmp_lt_u32 s40, 32768
    s_cbranch_scc1 recurrent_scan__mha_block__glu_gated_geglu__prompt_kernel_lxpoll_4
recurrent_scan__mha_block__glu_gated_geglu__prompt_kernel_lxpoll_4_ok:
recurrent_scan__mha_block__glu_gated_geglu__prompt_kernel_L_xn0:
    s_lshl_b32 s38, s28, 13
    s_add_u32 s38, s38, s34
    s_mov_b32 m0, s38
    s_add_u32 s37, s35, 40960
    buffer_load_dwordx4 v7, s[8:11], s35 offen offset:0 lds
    buffer_load_dwordx4 v7, s[8:11], s35 offen offset:1024 lds
    buffer_load_dwordx4 v7, s[8:11], s35 offen offset:2048 lds
    buffer_load_dwordx4 v7, s[8:11], s35 offen offset:3072 lds
    s_add_u32 m0, s38, 4096
    s_add_u32 s35, s35, 4096
    buffer_load_dwordx4 v7, s[8:11], s37 offen offset:0 lds
    buffer_load_dwordx4 v7, s[8:11], s37 offen offset:1024 lds
    buffer_load_dwordx4 v7, s[8:11], s37 offen offset:2048 lds
    buffer_load_dwordx4 v7, s[8:11], s37 offen offset:3072 lds
    s_lshl_b32 s38, s28, 12
    s_add_u32 s38, s38, s34
    s_add_u32 m0, s38, 32768
    s_nop 0
    buffer_load_dwordx4 v12, s[12:15], s36 offen offset:0 lds
    buffer_load_dwordx4 v13, s[12:15], s36 offen offset:1024 lds
    buffer_load_dwordx4 v14, s[12:15], s36 offen offset:2048 lds
    buffer_load_dwordx4 v15, s[12:15], s36 offen offset:3072 lds
    s_add_u32 s36, s36, 221184
    s_add_u32 s34, s34, 49152
    s_cmp_eq_u32 s34, 147456
    s_cselect_b32 s34, 0, s34
recurrent_scan__mha_block__glu_gated_geglu__prompt_kernel_L_xnok:
    v_mov_b32 v8, 147536
    s_lshl_b32 s38, s28, 2
    s_add_u32 s38, s38, 147520
    v_mov_b32 v9, s38
    s_lshl_b32 s38, s28, 13
    s_add_u32 s38, s38, s34
    s_mov_b32 m0, s38
    s_add_u32 s37, s35, 40960
    buffer_load_dwordx4 v7, s[8:11], s35 offen offset:0 lds
    buffer_load_dwordx4 v7, s[8:11], s35 offen offset:1024 lds
    buffer_load_dwordx4 v7, s[8:11], s35 offen offset:2048 lds
    buffer_load_dwordx4 v7, s[8:11], s35 offen offset:3072 lds
    s_add_u32 m0, s38, 4096
    s_add_u32 s35, s35, 4096
    buffer_load_dwordx4 v7, s[8:11], s37 offen offset:0 lds
    buffer_load_dwordx4 v7, s[8:11], s37 offen offset:1024 lds
    buffer_load_dwordx4 v7, s[8:11], s37 offen offset:2048 lds
    buffer_load_dwordx4 v7, s[8:11], s37 offen offset:3072 lds
    s_lshl_b32 s38, s28, 12
    s_add_u32 s38, s38, s34
    s_add_u32 m0, s38, 32768
    s_nop 0
    buffer_load_dwordx4 v12, s[12:15], s36 offen offset:0 lds
    buffer_load_dwordx4 v13, s[12:15], s36 offen offset:1024 lds
    buffer_load_dwordx4 v14, s[12:15], s36 offen offset:2048 lds
    buffer_load_dwordx4 v15, s[12:15], s36 offen offset:3072 lds
    s_add_u32 s36, s36, 221184
    s_add_u32 s34, s34, 49152
    s_cmp_eq_u32 s34, 147456
    s_cselect_b32 s34, 0, s34
    s_lshl_b32 s38, s28, 13
    s_add_u32 s38, s38, s34
    s_mov_b32 m0, s38
    s_add_u32 s37, s35, 40960
    buffer_load_dwordx4 v7, s[8:11], s35 offen offset:0 lds
    buffer_load_dwordx4 v7, s[8:11], s35 offen offset:1024 lds
    buffer_load_dwordx4 v7, s[8:11], s35 offen offset:2048 lds
    buffer_load_dwordx4 v7, s[8:11], s35 offen offset:3072 lds
    s_add_u32 m0, s38, 4096
    s_add_u32 s35, s35, 4096
    buffer_load_dwordx4 v7, s[8:11], s37 offen offset:0 lds
    buffer_load_dwordx4 v7, s[8:11], s37 offen offset:1024 lds
    buffer_load_dwordx4 v7, s[8:11], s37 offen offset:2048 lds
    buffer_load_dwordx4 v7, s[8:11], s37 offen offset:3072 lds
    s_lshl_b32 s38, s28, 12
    s_add_u32 s38, s38, s34
    s_add_u32 m0, s38, 32768
    s_nop 0
    buffer_load_dwordx4 v12, s[12:15], s36 offen offset:0 lds
    buffer_load_dwordx4 v13, s[12:15], s36 offen offset:1024 lds
    buffer_load_dwordx4 v14, s[12:15], s36 offen offset:2048 lds
    buffer_load_dwordx4 v15, s[12:15], s36 offen offset:3072 lds
    s_add_u32 s36, s36, 221184
    s_add_u32 s34, s34, 49152
    s_cmp_eq_u32 s34, 147456
    s_cselect_b32 s34, 0, s34
    s_waitcnt vmcnt(24)
    v_mov_b32 v10, 1
    ds_write_b32 v9, v10
    s_waitcnt vmcnt(12)
    v_mov_b32 v10, 2
    ds_write_b32 v9, v10
    s_waitcnt vmcnt(0)
    v_mov_b32 v10, 3
    ds_write_b32 v9, v10
recurrent_scan__mha_block__glu_gated_geglu__prompt_kernel_L_nogu:
    s_and_b32 s88, s2, 7
    s_lshl_b32 s88, s88, 2
    s_lshr_b32 s58, s2, 3
    s_and_b32 s58, s58, 3
    s_add_u32 s88, s88, s58
    s_lshr_b32 s89, s2, 5
    s_and_b32 s90, s28, 1
    s_lshr_b32 s91, s28, 1
    s_mov_b32 s94, -1
    s_mov_b32 s95, 0
    s_mov_b32 s96, 0xfffff
    s_mov_b32 s97, 0xfffff
    s_mov_b32 s98, 0
    s_mov_b32 s99, -1
    v_lshlrev_b32 v176, 3, v1
    v_and_b32 v179, 31, v1
    v_lshrrev_b32 v180, 5, v1
    v_mul_u32_u24 v180, 320, v180
    v_lshl_add_u32 v178, v179, 4, v180
    v_mov_b32 v181, 0x3f803f80
    v_cmp_eq_u32 vcc, 20, v179
    v_mov_b32 v180, 0
    s_nop 0
    v_cndmask_b32 v180, v180, v181, vcc
    v_mov_b32 v192, v180
    v_mov_b32 v196, v180
    v_mov_b32 v193, v180
    v_mov_b32 v197, v180
    v_mov_b32 v194, v180
    v_mov_b32 v198, v180
    v_mov_b32 v195, v180
    v_mov_b32 v199, v180
    v_mov_b32 v144, v181
    v_mov_b32 v145, 0
    v_mov_b32 v204, v180
    v_mov_b32 v208, v180
    v_mov_b32 v205, v180
    v_mov_b32 v209, v180
    v_mov_b32 v206, v180
    v_mov_b32 v210, v180
    v_mov_b32 v207, v180
    v_mov_b32 v211, v180
    v_mov_b32 v146, v181
    v_mov_b32 v147, 0
    v_mov_b32 v216, v180
    v_mov_b32 v220, v180
    v_mov_b32 v217, v180
    v_mov_b32 v221, v180
    v_mov_b32 v218, v180
    v_mov_b32 v222, v180
    v_mov_b32 v219, v180
    v_mov_b32 v223, v180
    v_mov_b32 v148, v181
    v_mov_b32 v149, 0
    v_mov_b32 v228, v180
    v_mov_b32 v232, v180
    v_mov_b32 v229, v180
    v_mov_b32 v233, v180
    v_mov_b32 v230, v180
    v_mov_b32 v234, v180
    v_mov_b32 v231, v180
    v_mov_b32 v235, v180
    v_mov_b32 v150, v181
    v_mov_b32 v151, 0
    v_mov_b32 v32, 0
    v_mov_b32 v33, 0
    v_mov_b32 v34, 0
    v_mov_b32 v35, 0
    v_mov_b32 v36, 0
    v_mov_b32 v37, 0
    v_mov_b32 v38, 0
    v_mov_b32 v39, 0
    v_mov_b32 v40, 0
    v_mov_b32 v41, 0
    v_mov_b32 v42, 0
    v_mov_b32 v43, 0
    v_mov_b32 v44, 0
    v_mov_b32 v45, 0
    v_mov_b32 v46, 0
    v_mov_b32 v47, 0
    s_mov_b32 s76, s44
    s_mov_b32 s77, s45
    s_mov_b32 s78, 0x280000
    s_mov_b32 s79, 0x20000
    s_add_u32 s80, s44, 0x280000
    s_addc_u32 s81, s45, 0
    s_mov_b32 s82, 0x500000
    s_mov_b32 s83, 0x20000
    s_add_u32 s84, s44, 0xe40000
    s_addc_u32 s85, s45, 0
    s_mov_b32 s86, 0x280000
    s_mov_b32 s87, 0x20000
    s_lshl_b32 s58, s88, 6
    s_lshl_b32 s59, s89, 3
    s_add_u32 s58, s58, s59
    s_lshl_b32 s59, s90, 2
    s_add_u32 s58, s58, s59
    s_mul_i32 s56, s58, 1280
    s_lshl_b32 s58, s88, 6
    s_lshl_b32 s59, s91, 5
    s_add_u32 s58, s58, s59
    s_mul_i32 s92, s58, 2560
    s_mov_b32 s57, s92
    s_add_u32 s50, s92, 79360
    v_mov_b32 v10, 147504
    s_cmp_eq_u32 s28, 0
    s_cbranch_scc0 recurrent_scan__mha_block__glu_gated_geglu__prompt_kernel_kvw_5_w
    s_add_u32 s52, s44, 0x1872000
    s_addc_u32 s53, s45, 0
    s_mov_b32 s54, 0x8000
    s_mov_b32 s55, 0x20000
    s_mul_i32 s38, s88, 20
    v_lshrrev_b32 v2, 4, v1
    v_and_b32 v3, 1, v2
    v_mul_u32_u24 v3, 19, v3
    v_lshrrev_b32 v4, 1, v2
    v_mul_u32_u24 v4, 640, v4
    v_add_u32 v3, v3, v4
    v_add_u32 v3, s38, v3
    v_add_u32 v3, 640, v3
    v_lshrrev_b32 v3, 7, v3
    v_and_b32 v2, 15, v1
    v_lshl_add_u32 v3, v2, 4, v3
    v_lshlrev_b32 v8, 7, v3
    v_bfe_u32 v3, v1, 1, 1
    v_mul_u32_u24 v3, 19, v3
    v_add_u32 v3, s38, v3
    v_lshrrev_b32 v3, 7, v3
    v_and_b32 v2, 1, v1
    s_lshl_b32 s38, s89, 1
    v_add_u32 v2, s38, v2
    v_lshl_add_u32 v3, v2, 4, v3
    v_lshlrev_b32 v9, 7, v3
    s_mov_b32 s40, 0
recurrent_scan__mha_block__glu_gated_geglu__prompt_kernel_kvpoll_6:
    buffer_load_dword v12, v8, s[52:55], 0 offen sc0 sc1
    s_mov_b64 exec, 15
    buffer_load_dword v13, v9, s[52:55], 0 offen sc0 sc1
    s_mov_b64 exec, -1
    s_waitcnt vmcnt(0)
    v_xor_b32 v12, s3, v12
    v_xor_b32 v13, s3, v13
    s_mov_b64 exec, 15
    v_or_b32 v12, v12, v13
    s_mov_b64 exec, -1
    v_cmp_ne_u32 vcc, 0, v12
    s_nop 1
    s_cmp_eq_u64 vcc, 0
    s_cbranch_scc1 recurrent_scan__mha_block__glu_gated_geglu__prompt_kernel_kvpoll_6_ok
    s_sleep 4
    s_add_u32 s40, s40, 1
    s_cmp_lt_u32 s40, 32768
    s_cbranch_scc1 recurrent_scan__mha_block__glu_gated_geglu__prompt_kernel_kvpoll_6
recurrent_scan__mha_block__glu_gated_geglu__prompt_kernel_kvpoll_6_ok:
    v_mov_b32 v11, 1
    ds_write_b32 v10, v11
    s_branch recurrent_scan__mha_block__glu_gated_geglu__prompt_kernel_kvw_5_x
recurrent_scan__mha_block__glu_gated_geglu__prompt_kernel_kvw_5_w:
    s_mov_b32 s40, 0
recurrent_scan__mha_block__glu_gated_geglu__prompt_kernel_kvw_5_l:
    ds_read_b32 v11, v10
    s_add_u32 s40, s40, 1
    s_cmp_ge_u32 s40, 0x100000
    s_cbranch_scc1 recurrent_scan__mha_block__glu_gated_geglu__prompt_kernel_kvw_5_x
    s_waitcnt lgkmcnt(0)
    v_readfirstlane_b32 s38, v11
    s_cmp_eq_u32 s38, 1
    s_cbranch_scc1 recurrent_scan__mha_block__glu_gated_geglu__prompt_kernel_kvw_5_x
    s_sleep 2
    s_branch recurrent_scan__mha_block__glu_gated_geglu__prompt_kernel_kvw_5_l
recurrent_scan__mha_block__glu_gated_geglu__prompt_kernel_kvw_5_x:
    s_waitcnt lgkmcnt(0)
    s_add_u32 s58, s56, 0
    buffer_load_dwordx2 v[16:17], v176, s[76:79], s58 offen
    buffer_load_dwordx2 v[18:19], v176, s[76:79], s58 offen offset:512
    s_add_u32 s58, s56, 1280
    buffer_load_dwordx2 v[20:21], v176, s[76:79], s58 offen
    buffer_load_dwordx2 v[22:23], v176, s[76:79], s58 offen offset:512
    s_add_u32 s58, s56, 2560
    buffer_load_dwordx2 v[24:25], v176, s[76:79], s58 offen
    buffer_load_dwordx2 v[26:27], v176, s[76:79], s58 offen offset:512
    s_add_u32 s58, s56, 3840
    buffer_load_dwordx2 v[28:29], v176, s[76:79], s58 offen
    buffer_load_dwordx2 v[30:31], v176, s[76:79], s58 offen offset:512
    s_mov_b64 exec, s[94:95]
    s_add_u32 s58, s56, 0
    buffer_load_dwordx2 v[32:33], v176, s[76:79], s58 offen offset:1024
    s_add_u32 s58, s56, 1280
    buffer_load_dwordx2 v[34:35], v176, s[76:79], s58 offen offset:1024
    s_add_u32 s58, s56, 2560
    buffer_load_dwordx2 v[36:37], v176, s[76:79], s58 offen offset:1024
    s_add_u32 s58, s56, 3840
    buffer_load_dwordx2 v[38:39], v176, s[76:79], s58 offen offset:1024
    s_mov_b64 exec, -1
    buffer_load_dwordx2 v[188:189], v176, s[80:83], s92 offen
    buffer_load_dwordx2 v[190:191], v176, s[80:83], s92 offen offset:512
    s_mov_b64 exec, s[94:95]
    buffer_load_dwordx2 v[144:145], v176, s[80:83], s92 offen offset:1024
    s_mov_b64 exec, s[96:97]
    buffer_load_dwordx4 v[192:195], v178, s[80:83], s92 offen offset:1280
    buffer_load_dwordx4 v[196:199], v178, s[80:83], s92 offen offset:1920
    s_mov_b64 exec, -1
    s_add_u32 s92, s92, 2560
    s_min_u32 s92, s92, s50
    buffer_load_dwordx2 v[200:201], v176, s[80:83], s92 offen
    buffer_load_dwordx2 v[202:203], v176, s[80:83], s92 offen offset:512
    s_mov_b64 exec, s[94:95]
    buffer_load_dwordx2 v[146:147], v176, s[80:83], s92 offen offset:1024
    s_mov_b64 exec, s[96:97]
    buffer_load_dwordx4 v[204:207], v178, s[80:83], s92 offen offset:1280
    buffer_load_dwordx4 v[208:211], v178, s[80:83], s92 offen offset:1920
    s_mov_b64 exec, -1
    s_add_u32 s92, s92, 2560
    s_min_u32 s92, s92, s50
    buffer_load_dwordx2 v[212:213], v176, s[80:83], s92 offen
    buffer_load_dwordx2 v[214:215], v176, s[80:83], s92 offen offset:512
    s_mov_b64 exec, s[94:95]
    buffer_load_dwordx2 v[148:149], v176, s[80:83], s92 offen offset:1024
    s_mov_b64 exec, s[96:97]
    buffer_load_dwordx4 v[216:219], v178, s[80:83], s92 offen offset:1280
    buffer_load_dwordx4 v[220:223], v178, s[80:83], s92 offen offset:1920
    s_mov_b64 exec, -1
    s_add_u32 s92, s92, 2560
    s_min_u32 s92, s92, s50
    s_and_b32 s38, s2, 7
    s_lshl_b32 s38, s38, 2
    s_lshr_b32 s39, s2, 3
    s_and_b32 s39, s39, 3
    s_add_u32 s38, s38, s39
    s_mul_i32 s38, s38, 163840
    s_lshr_b32 s39, s2, 5
    s_mul_i32 s39, s39, 20480
    s_add_u32 s38, s38, s39
    s_mul_i32 s39, s28, 5120
    s_add_u32 s38, s38, s39
    v_lshlrev_b32 v2, 7, v1
    s_mov_b32 exec_lo, -1
    s_mov_b32 exec_hi, 0xff
    buffer_load_dword v8, v2, s[80:83], s38 offen
    s_mov_b64 exec, -1
    s_waitcnt vmcnt(6)
    v_mfma_f32_32x32x16_bf16 v[80:95], v[188:191], v[16:19], 0
    v_mfma_f32_32x32x16_bf16 v[96:111], v[188:191], v[20:23], 0
    v_mfma_f32_32x32x16_bf16 v[112:127], v[188:191], v[24:27], 0
    v_mfma_f32_32x32x16_bf16 v[128:143], v[188:191], v[28:31], 0
    v_mfma_f32_32x32x8bf16_1k v[80:95], v[144:145], v[32:33], v[80:95]
    v_mfma_f32_32x32x8bf16_1k v[96:111], v[144:145], v[34:35], v[96:111]
    v_mfma_f32_32x32x8bf16_1k v[112:127], v[144:145], v[36:37], v[112:127]
    v_mfma_f32_32x32x8bf16_1k v[128:143], v[144:145], v[38:39], v[128:143]
    s_nop 15
    v_max3_f32 v152, v80, v81, v82
    v_max3_f32 v152, v152, v83, v84
    v_max3_f32 v152, v152, v85, v86
    v_max3_f32 v152, v152, v87, v88
    v_max3_f32 v152, v152, v89, v90
    v_max3_f32 v152, v152, v91, v92
    v_max3_f32 v152, v152, v93, v94
    v_max3_f32 v152, v152, v95, v95
    v_max3_f32 v153, v96, v97, v98
    v_max3_f32 v153, v153, v99, v100
    v_max3_f32 v153, v153, v101, v102
    v_max3_f32 v153, v153, v103, v104
    v_max3_f32 v153, v153, v105, v106
    v_max3_f32 v153, v153, v107, v108
    v_max3_f32 v153, v153, v109, v110
    v_max3_f32 v153, v153, v111, v111
    v_max3_f32 v154, v112, v113, v114
    v_max3_f32 v154, v154, v115, v116
    v_max3_f32 v154, v154, v117, v118
    v_max3_f32 v154, v154, v119, v120
    v_max3_f32 v154, v154, v121, v122
    v_max3_f32 v154, v154, v123, v124
    v_max3_f32 v154, v154, v125, v126
    v_max3_f32 v154, v154, v127, v127
    v_max3_f32 v155, v128, v129, v130
    v_max3_f32 v155, v155, v131, v132
    v_max3_f32 v155, v155, v133, v134
    v_max3_f32 v155, v155, v135, v136
    v_max3_f32 v155, v155, v137, v138
    v_max3_f32 v155, v155, v139, v140
    v_max3_f32 v155, v155, v141, v142
    v_max3_f32 v155, v155, v143, v143
    v_mfma_f32_32x32x16_bf16 v[80:95], v[200:203], v[16:19], 0
    v_mfma_f32_32x32x16_bf16 v[96:111], v[200:203], v[20:23], 0
    v_mfma_f32_32x32x16_bf16 v[112:127], v[200:203], v[24:27], 0
    v_mfma_f32_32x32x16_bf16 v[128:143], v[200:203], v[28:31], 0
    v_mfma_f32_32x32x8bf16_1k v[80:95], v[146:147], v[32:33], v[80:95]
    v_mfma_f32_32x32x8bf16_1k v[96:111], v[146:147], v[34:35], v[96:111]
    v_mfma_f32_32x32x8bf16_1k v[112:127], v[146:147], v[36:37], v[112:127]
    v_mfma_f32_32x32x8bf16_1k v[128:143], v[146:147], v[38:39], v[128:143]
    s_nop 15
    v_max3_f32 v152, v152, v80, v81
    v_max3_f32 v152, v152, v82, v83
    v_max3_f32 v152, v152, v84, v85
    v_max3_f32 v152, v152, v86, v87
    v_max3_f32 v152, v152, v88, v89
    v_max3_f32 v152, v152, v90, v91
    v_max3_f32 v152, v152, v92, v93
    v_max3_f32 v152, v152, v94, v95
    v_max3_f32 v153, v153, v96, v97
    v_max3_f32 v153, v153, v98, v99
    v_max3_f32 v153, v153, v100, v101
    v_max3_f32 v153, v153, v102, v103
    v_max3_f32 v153, v153, v104, v105
    v_max3_f32 v153, v153, v106, v107
    v_max3_f32 v153, v153, v108, v109
    v_max3_f32 v153, v153, v110, v111
    v_max3_f32 v154, v154, v112, v113
    v_max3_f32 v154, v154, v114, v115
    v_max3_f32 v154, v154, v116, v117
    v_max3_f32 v154, v154, v118, v119
    v_max3_f32 v154, v154, v120, v121
    v_max3_f32 v154, v154, v122, v123
    v_max3_f32 v154, v154, v124, v125
    v_max3_f32 v154, v154, v126, v127
    v_max3_f32 v155, v155, v128, v129
    v_max3_f32 v155, v155, v130, v131
    v_max3_f32 v155, v155, v132, v133
    v_max3_f32 v155, v155, v134, v135
    v_max3_f32 v155, v155, v136, v137
    v_max3_f32 v155, v155, v138, v139
    v_max3_f32 v155, v155, v140, v141
    v_max3_f32 v155, v155, v142, v143
    v_mov_b32 v179, v152
    v_mov_b32 v180, v179
    v_mov_b32 v181, v179
    s_nop 1
    v_permlane32_swap_b32 v180, v181
    s_nop 1
    v_max_f32 v179, v180, v181
    v_add_f32 v179, 0x42b40000, v179
    v_sub_f32 v179, 0, v179
    v_cvt_pk_bf16_f32 v180, v179, v179
    v_lshlrev_b32 v180, 16, v180
    v_sub_f32 v181, v179, v180
    v_cvt_pk_bf16_f32 v181, v179, v181
    v_and_b32 v179, 0xffff0000, v181
    v_add_f32 v179, v179, v180
    v_sub_f32 v182, 0, v179
    s_mov_b64 exec, s[98:99]
    v_mov_b32 v32, v181
    s_mov_b64 exec, -1
    v_mov_b32 v179, v153
    v_mov_b32 v180, v179
    v_mov_b32 v181, v179
    s_nop 1
    v_permlane32_swap_b32 v180, v181
    s_nop 1
    v_max_f32 v179, v180, v181
    v_add_f32 v179, 0x42b40000, v179
    v_sub_f32 v179, 0, v179
    v_cvt_pk_bf16_f32 v180, v179, v179
    v_lshlrev_b32 v180, 16, v180
    v_sub_f32 v181, v179, v180
    v_cvt_pk_bf16_f32 v181, v179, v181
    v_and_b32 v179, 0xffff0000, v181
    v_add_f32 v179, v179, v180
    v_sub_f32 v183, 0, v179
    s_mov_b64 exec, s[98:99]
    v_mov_b32 v34, v181
    s_mov_b64 exec, -1
    v_mov_b32 v179, v154
    v_mov_b32 v180, v179
    v_mov_b32 v181, v179
    s_nop 1
    v_permlane32_swap_b32 v180, v181
    s_nop 1
    v_max_f32 v179, v180, v181
    v_add_f32 v179, 0x42b40000, v179
    v_sub_f32 v179, 0, v179
    v_cvt_pk_bf16_f32 v180, v179, v179
    v_lshlrev_b32 v180, 16, v180
    v_sub_f32 v181, v179, v180
    v_cvt_pk_bf16_f32 v181, v179, v181
    v_and_b32 v179, 0xffff0000, v181
    v_add_f32 v179, v179, v180
    v_sub_f32 v184, 0, v179
    s_mov_b64 exec, s[98:99]
    v_mov_b32 v36, v181
    s_mov_b64 exec, -1
    v_mov_b32 v179, v155
    v_mov_b32 v180, v179
    v_mov_b32 v181, v179
    s_nop 1
    v_permlane32_swap_b32 v180, v181
    s_nop 1
    v_max_f32 v179, v180, v181
    v_add_f32 v179, 0x42b40000, v179
    v_sub_f32 v179, 0, v179
    v_cvt_pk_bf16_f32 v180, v179, v179
    v_lshlrev_b32 v180, 16, v180
    v_sub_f32 v181, v179, v180
    v_cvt_pk_bf16_f32 v181, v179, v181
    v_and_b32 v179, 0xffff0000, v181
    v_add_f32 v179, v179, v180
    v_sub_f32 v185, 0, v179
    s_mov_b64 exec, s[98:99]
    v_mov_b32 v38, v181
    s_mov_b64 exec, -1
    v_mov_b32 v80, 0
    v_mov_b32 v81, 0
    v_mov_b32 v82, 0
    v_mov_b32 v83, 0
    v_mov_b32 v84, 0
    v_mov_b32 v85, 0
    v_mov_b32 v86, 0
    v_mov_b32 v87, 0
    v_mov_b32 v88, 0
    v_mov_b32 v89, 0
    v_mov_b32 v90, 0
    v_mov_b32 v91, 0
    v_mov_b32 v92, 0
    v_mov_b32 v93, 0
    v_mov_b32 v94, 0
    v_mov_b32 v95, 0
    v_mov_b32 v96, 0
    v_mov_b32 v97, 0
    v_mov_b32 v98, 0
    v_mov_b32 v99, 0
    v_mov_b32 v100, 0
    v_mov_b32 v101, 0
    v_mov_b32 v102, 0
    v_mov_b32 v103, 0
    v_mov_b32 v104, 0
    v_mov_b32 v105, 0
    v_mov_b32 v106, 0
    v_mov_b32 v107, 0
    v_mov_b32 v108, 0
    v_mov_b32 v109, 0
    v_mov_b32 v110, 0
    v_mov_b32 v111, 0
    v_mov_b32 v112, 0
    v_mov_b32 v113, 0
    v_mov_b32 v114, 0
    v_mov_b32 v115, 0
    v_mov_b32 v116, 0
    v_mov_b32 v117, 0
    v_mov_b32 v118, 0
    v_mov_b32 v119, 0
    v_mov_b32 v120, 0
    v_mov_b32 v121, 0
    v_mov_b32 v122, 0
    v_mov_b32 v123, 0
    v_mov_b32 v124, 0
    v_mov_b32 v125, 0
    v_mov_b32 v126, 0
    v_mov_b32 v127, 0
    v_mov_b32 v128, 0
    v_mov_b32 v129, 0
    v_mov_b32 v130, 0
    v_mov_b32 v131, 0
    v_mov_b32 v132, 0
    v_mov_b32 v133, 0
    v_mov_b32 v134, 0
    v_mov_b32 v135, 0
    v_mov_b32 v136, 0
    v_mov_b32 v137, 0
    v_mov_b32 v138, 0
    v_mov_b32 v139, 0
    v_mov_b32 v140, 0
    v_mov_b32 v141, 0
    v_mov_b32 v142, 0
    v_mov_b32 v143, 0
    v_mfma_f32_32x32x16_bf16 v[48:63], v[188:191], v[16:19], 0
    v_mfma_f32_32x32x8bf16_1k v[48:63], v[144:145], v[32:33], v[48:63]
recurrent_scan__mha_block__glu_gated_geglu__prompt_kernel_attn:
    s_setprio 1
    s_nop 7
    s_mov_b32 s93, 8
    .p2align 6
recurrent_scan__mha_block__glu_gated_geglu__prompt_kernel_at_loop:
    v_mfma_f32_32x32x16_bf16 v[64:79], v[188:191], v[20:23], 0
    v_exp_f32 v48, v48
    v_exp_f32 v49, v49
    v_exp_f32 v50, v50
    v_exp_f32 v51, v51
    v_cvt_pk_bf16_f32 v40, v48, v49
    v_cvt_pk_bf16_f32 v41, v50, v51
    v_mfma_f32_32x32x8bf16_1k v[64:79], v[144:145], v[34:35], v[64:79]
    v_exp_f32 v52, v52
    v_exp_f32 v53, v53
    v_exp_f32 v54, v54
    v_exp_f32 v55, v55
    v_cvt_pk_bf16_f32 v42, v52, v53
    v_cvt_pk_bf16_f32 v43, v54, v55
    v_mfma_f32_32x32x16_bf16 v[128:143], v[232:235], v[44:47], v[128:143]
    v_exp_f32 v56, v56
    v_exp_f32 v57, v57
    v_exp_f32 v58, v58
    v_exp_f32 v59, v59
    v_cvt_pk_bf16_f32 v44, v56, v57
    v_cvt_pk_bf16_f32 v45, v58, v59
    v_mfma_f32_32x32x16_bf16 v[80:95], v[192:195], v[40:43], v[80:95]
    v_exp_f32 v60, v60
    v_exp_f32 v61, v61
    v_exp_f32 v62, v62
    v_exp_f32 v63, v63
    v_cvt_pk_bf16_f32 v46, v60, v61
    v_cvt_pk_bf16_f32 v47, v62, v63
    v_mfma_f32_32x32x16_bf16 v[48:63], v[188:191], v[24:27], 0
    buffer_load_dwordx2 v[224:225], v176, s[80:83], s92 offen
    buffer_load_dwordx2 v[226:227], v176, s[80:83], s92 offen offset:512
    s_mov_b64 exec, s[94:95]
    buffer_load_dwordx2 v[150:151], v176, s[80:83], s92 offen offset:1024
    s_mov_b64 exec, s[96:97]
    buffer_load_dwordx4 v[228:231], v178, s[80:83], s92 offen offset:1280
    buffer_load_dwordx4 v[232:235], v178, s[80:83], s92 offen offset:1920
    s_mov_b64 exec, -1
    s_add_u32 s92, s92, 2560
    s_min_u32 s92, s92, s50
    v_exp_f32 v64, v64
    v_exp_f32 v65, v65
    v_exp_f32 v66, v66
    v_exp_f32 v67, v67
    v_cvt_pk_bf16_f32 v40, v64, v65
    v_cvt_pk_bf16_f32 v41, v66, v67
    v_mfma_f32_32x32x8bf16_1k v[48:63], v[144:145], v[36:37], v[48:63]
    v_exp_f32 v68, v68
    v_exp_f32 v69, v69
    v_exp_f32 v70, v70
    v_exp_f32 v71, v71
    v_cvt_pk_bf16_f32 v42, v68, v69
    v_cvt_pk_bf16_f32 v43, v70, v71
    v_mfma_f32_32x32x16_bf16 v[80:95], v[196:199], v[44:47], v[80:95]
    v_exp_f32 v72, v72
    v_exp_f32 v73, v73
    v_exp_f32 v74, v74
    v_exp_f32 v75, v75
    v_cvt_pk_bf16_f32 v44, v72, v73
    v_cvt_pk_bf16_f32 v45, v74, v75
    v_mfma_f32_32x32x16_bf16 v[96:111], v[192:195], v[40:43], v[96:111]
    v_exp_f32 v76, v76
    v_exp_f32 v77, v77
    v_exp_f32 v78, v78
    v_exp_f32 v79, v79
    v_cvt_pk_bf16_f32 v46, v76, v77
    v_cvt_pk_bf16_f32 v47, v78, v79
    v_mfma_f32_32x32x16_bf16 v[64:79], v[188:191], v[28:31], 0
    v_exp_f32 v48, v48
    v_exp_f32 v49, v49
    v_exp_f32 v50, v50
    v_exp_f32 v51, v51
    v_cvt_pk_bf16_f32 v40, v48, v49
    v_cvt_pk_bf16_f32 v41, v50, v51
    v_mfma_f32_32x32x8bf16_1k v[64:79], v[144:145], v[38:39], v[64:79]
    v_exp_f32 v52, v52
    v_exp_f32 v53, v53
    v_exp_f32 v54, v54
    v_exp_f32 v55, v55
    v_cvt_pk_bf16_f32 v42, v52, v53
    v_cvt_pk_bf16_f32 v43, v54, v55
    v_mfma_f32_32x32x16_bf16 v[96:111], v[196:199], v[44:47], v[96:111]
    v_exp_f32 v56, v56
    v_exp_f32 v57, v57
    v_exp_f32 v58, v58
    v_exp_f32 v59, v59
    v_cvt_pk_bf16_f32 v44, v56, v57
    v_cvt_pk_bf16_f32 v45, v58, v59
    v_mfma_f32_32x32x16_bf16 v[112:127], v[192:195], v[40:43], v[112:127]
    v_exp_f32 v60, v60
    v_exp_f32 v61, v61
    v_exp_f32 v62, v62
    v_exp_f32 v63, v63
    v_cvt_pk_bf16_f32 v46, v60, v61
    v_cvt_pk_bf16_f32 v47, v62, v63
    s_waitcnt vmcnt(10)
    v_mfma_f32_32x32x16_bf16 v[48:63], v[200:203], v[16:19], 0
    v_exp_f32 v64, v64
    v_exp_f32 v65, v65
    v_exp_f32 v66, v66
    v_exp_f32 v67, v67
    v_cvt_pk_bf16_f32 v40, v64, v65
    v_cvt_pk_bf16_f32 v41, v66, v67
    v_mfma_f32_32x32x8bf16_1k v[48:63], v[146:147], v[32:33], v[48:63]
    v_exp_f32 v68, v68
    v_exp_f32 v69, v69
    v_exp_f32 v70, v70
    v_exp_f32 v71, v71
    v_cvt_pk_bf16_f32 v42, v68, v69
    v_cvt_pk_bf16_f32 v43, v70, v71
    v_mfma_f32_32x32x16_bf16 v[112:127], v[196:199], v[44:47], v[112:127]
    v_exp_f32 v72, v72
    v_exp_f32 v73, v73
    v_exp_f32 v74, v74
    v_exp_f32 v75, v75
    v_cvt_pk_bf16_f32 v44, v72, v73
    v_cvt_pk_bf16_f32 v45, v74, v75
    v_mfma_f32_32x32x16_bf16 v[128:143], v[192:195], v[40:43], v[128:143]
    v_exp_f32 v76, v76
    v_exp_f32 v77, v77
    v_exp_f32 v78, v78
    v_exp_f32 v79, v79
    v_cvt_pk_bf16_f32 v46, v76, v77
    v_cvt_pk_bf16_f32 v47, v78, v79
    v_mfma_f32_32x32x16_bf16 v[64:79], v[200:203], v[20:23], 0
    v_exp_f32 v48, v48
    v_exp_f32 v49, v49
    v_exp_f32 v50, v50
    v_exp_f32 v51, v51
    v_cvt_pk_bf16_f32 v40, v48, v49
    v_cvt_pk_bf16_f32 v41, v50, v51
    v_mfma_f32_32x32x8bf16_1k v[64:79], v[146:147], v[34:35], v[64:79]
    v_exp_f32 v52, v52
    v_exp_f32 v53, v53
    v_exp_f32 v54, v54
    v_exp_f32 v55, v55
    v_cvt_pk_bf16_f32 v42, v52, v53
    v_cvt_pk_bf16_f32 v43, v54, v55
    v_mfma_f32_32x32x16_bf16 v[128:143], v[196:199], v[44:47], v[128:143]
    v_exp_f32 v56, v56
    v_exp_f32 v57, v57
    v_exp_f32 v58, v58
    v_exp_f32 v59, v59
    v_cvt_pk_bf16_f32 v44, v56, v57
    v_cvt_pk_bf16_f32 v45, v58, v59
    v_mfma_f32_32x32x16_bf16 v[80:95], v[204:207], v[40:43], v[80:95]
    v_exp_f32 v60, v60
    v_exp_f32 v61, v61
    v_exp_f32 v62, v62
    v_exp_f32 v63, v63
    v_cvt_pk_bf16_f32 v46, v60, v61
    v_cvt_pk_bf16_f32 v47, v62, v63
    v_mfma_f32_32x32x16_bf16 v[48:63], v[200:203], v[24:27], 0
    buffer_load_dwordx2 v[188:189], v176, s[80:83], s92 offen
    buffer_load_dwordx2 v[190:191], v176, s[80:83], s92 offen offset:512
    s_mov_b64 exec, s[94:95]
    buffer_load_dwordx2 v[144:145], v176, s[80:83], s92 offen offset:1024
    s_mov_b64 exec, s[96:97]
    buffer_load_dwordx4 v[192:195], v178, s[80:83], s92 offen offset:1280
    buffer_load_dwordx4 v[196:199], v178, s[80:83], s92 offen offset:1920
    s_mov_b64 exec, -1
    s_add_u32 s92, s92, 2560
    s_min_u32 s92, s92, s50
    v_exp_f32 v64, v64
    v_exp_f32 v65, v65
    v_exp_f32 v66, v66
    v_exp_f32 v67, v67
    v_cvt_pk_bf16_f32 v40, v64, v65
    v_cvt_pk_bf16_f32 v41, v66, v67
    v_mfma_f32_32x32x8bf16_1k v[48:63], v[146:147], v[36:37], v[48:63]
    v_exp_f32 v68, v68
    v_exp_f32 v69, v69
    v_exp_f32 v70, v70
    v_exp_f32 v71, v71
    v_cvt_pk_bf16_f32 v42, v68, v69
    v_cvt_pk_bf16_f32 v43, v70, v71
    v_mfma_f32_32x32x16_bf16 v[80:95], v[208:211], v[44:47], v[80:95]
    v_exp_f32 v72, v72
    v_exp_f32 v73, v73
    v_exp_f32 v74, v74
    v_exp_f32 v75, v75
    v_cvt_pk_bf16_f32 v44, v72, v73
    v_cvt_pk_bf16_f32 v45, v74, v75
    v_mfma_f32_32x32x16_bf16 v[96:111], v[204:207], v[40:43], v[96:111]
    v_exp_f32 v76, v76
    v_exp_f32 v77, v77
    v_exp_f32 v78, v78
    v_exp_f32 v79, v79
    v_cvt_pk_bf16_f32 v46, v76, v77
    v_cvt_pk_bf16_f32 v47, v78, v79
    v_mfma_f32_32x32x16_bf16 v[64:79], v[200:203], v[28:31], 0
    v_exp_f32 v48, v48
    v_exp_f32 v49, v49
    v_exp_f32 v50, v50
    v_exp_f32 v51, v51
    v_cvt_pk_bf16_f32 v40, v48, v49
    v_cvt_pk_bf16_f32 v41, v50, v51
    v_mfma_f32_32x32x8bf16_1k v[64:79], v[146:147], v[38:39], v[64:79]
    v_exp_f32 v52, v52
    v_exp_f32 v53, v53
    v_exp_f32 v54, v54
    v_exp_f32 v55, v55
    v_cvt_pk_bf16_f32 v42, v52, v53
    v_cvt_pk_bf16_f32 v43, v54, v55
    v_mfma_f32_32x32x16_bf16 v[96:111], v[208:211], v[44:47], v[96:111]
    v_exp_f32 v56, v56
    v_exp_f32 v57, v57
    v_exp_f32 v58, v58
    v_exp_f32 v59, v59
    v_cvt_pk_bf16_f32 v44, v56, v57
    v_cvt_pk_bf16_f32 v45, v58, v59
    v_mfma_f32_32x32x16_bf16 v[112:127], v[204:207], v[40:43], v[112:127]
    v_exp_f32 v60, v60
    v_exp_f32 v61, v61
    v_exp_f32 v62, v62
    v_exp_f32 v63, v63
    v_cvt_pk_bf16_f32 v46, v60, v61
    v_cvt_pk_bf16_f32 v47, v62, v63
    s_waitcnt vmcnt(10)
    v_mfma_f32_32x32x16_bf16 v[48:63], v[212:215], v[16:19], 0
    v_exp_f32 v64, v64
    v_exp_f32 v65, v65
    v_exp_f32 v66, v66
    v_exp_f32 v67, v67
    v_cvt_pk_bf16_f32 v40, v64, v65
    v_cvt_pk_bf16_f32 v41, v66, v67
    v_mfma_f32_32x32x8bf16_1k v[48:63], v[148:149], v[32:33], v[48:63]
    v_exp_f32 v68, v68
    v_exp_f32 v69, v69
    v_exp_f32 v70, v70
    v_exp_f32 v71, v71
    v_cvt_pk_bf16_f32 v42, v68, v69
    v_cvt_pk_bf16_f32 v43, v70, v71
    v_mfma_f32_32x32x16_bf16 v[112:127], v[208:211], v[44:47], v[112:127]
    v_exp_f32 v72, v72
    v_exp_f32 v73, v73
    v_exp_f32 v74, v74
    v_exp_f32 v75, v75
    v_cvt_pk_bf16_f32 v44, v72, v73
    v_cvt_pk_bf16_f32 v45, v74, v75
    v_mfma_f32_32x32x16_bf16 v[128:143], v[204:207], v[40:43], v[128:143]
    v_exp_f32 v76, v76
    v_exp_f32 v77, v77
    v_exp_f32 v78, v78
    v_exp_f32 v79, v79
    v_cvt_pk_bf16_f32 v46, v76, v77
    v_cvt_pk_bf16_f32 v47, v78, v79
    v_mfma_f32_32x32x16_bf16 v[64:79], v[212:215], v[20:23], 0
    v_exp_f32 v48, v48
    v_exp_f32 v49, v49
    v_exp_f32 v50, v50
    v_exp_f32 v51, v51
    v_cvt_pk_bf16_f32 v40, v48, v49
    v_cvt_pk_bf16_f32 v41, v50, v51
    v_mfma_f32_32x32x8bf16_1k v[64:79], v[148:149], v[34:35], v[64:79]
    v_exp_f32 v52, v52
    v_exp_f32 v53, v53
    v_exp_f32 v54, v54
    v_exp_f32 v55, v55
    v_cvt_pk_bf16_f32 v42, v52, v53
    v_cvt_pk_bf16_f32 v43, v54, v55
    v_mfma_f32_32x32x16_bf16 v[128:143], v[208:211], v[44:47], v[128:143]
    v_exp_f32 v56, v56
    v_exp_f32 v57, v57
    v_exp_f32 v58, v58
    v_exp_f32 v59, v59
    v_cvt_pk_bf16_f32 v44, v56, v57
    v_cvt_pk_bf16_f32 v45, v58, v59
    v_mfma_f32_32x32x16_bf16 v[80:95], v[216:219], v[40:43], v[80:95]
    v_exp_f32 v60, v60
    v_exp_f32 v61, v61
    v_exp_f32 v62, v62
    v_exp_f32 v63, v63
    v_cvt_pk_bf16_f32 v46, v60, v61
    v_cvt_pk_bf16_f32 v47, v62, v63
    v_mfma_f32_32x32x16_bf16 v[48:63], v[212:215], v[24:27], 0
    buffer_load_dwordx2 v[200:201], v176, s[80:83], s92 offen
    buffer_load_dwordx2 v[202:203], v176, s[80:83], s92 offen offset:512
    s_mov_b64 exec, s[94:95]
    buffer_load_dwordx2 v[146:147], v176, s[80:83], s92 offen offset:1024
    s_mov_b64 exec, s[96:97]
    buffer_load_dwordx4 v[204:207], v178, s[80:83], s92 offen offset:1280
    buffer_load_dwordx4 v[208:211], v178, s[80:83], s92 offen offset:1920
    s_mov_b64 exec, -1
    s_add_u32 s92, s92, 2560
    s_min_u32 s92, s92, s50
    v_exp_f32 v64, v64
    v_exp_f32 v65, v65
    v_exp_f32 v66, v66
    v_exp_f32 v67, v67
    v_cvt_pk_bf16_f32 v40, v64, v65
    v_cvt_pk_bf16_f32 v41, v66, v67
    v_mfma_f32_32x32x8bf16_1k v[48:63], v[148:149], v[36:37], v[48:63]
    v_exp_f32 v68, v68
    v_exp_f32 v69, v69
    v_exp_f32 v70, v70
    v_exp_f32 v71, v71
    v_cvt_pk_bf16_f32 v42, v68, v69
    v_cvt_pk_bf16_f32 v43, v70, v71
    v_mfma_f32_32x32x16_bf16 v[80:95], v[220:223], v[44:47], v[80:95]
    v_exp_f32 v72, v72
    v_exp_f32 v73, v73
    v_exp_f32 v74, v74
    v_exp_f32 v75, v75
    v_cvt_pk_bf16_f32 v44, v72, v73
    v_cvt_pk_bf16_f32 v45, v74, v75
    v_mfma_f32_32x32x16_bf16 v[96:111], v[216:219], v[40:43], v[96:111]
    v_exp_f32 v76, v76
    v_exp_f32 v77, v77
    v_exp_f32 v78, v78
    v_exp_f32 v79, v79
    v_cvt_pk_bf16_f32 v46, v76, v77
    v_cvt_pk_bf16_f32 v47, v78, v79
    v_mfma_f32_32x32x16_bf16 v[64:79], v[212:215], v[28:31], 0
    v_exp_f32 v48, v48
    v_exp_f32 v49, v49
    v_exp_f32 v50, v50
    v_exp_f32 v51, v51
    v_cvt_pk_bf16_f32 v40, v48, v49
    v_cvt_pk_bf16_f32 v41, v50, v51
    v_mfma_f32_32x32x8bf16_1k v[64:79], v[148:149], v[38:39], v[64:79]
    v_exp_f32 v52, v52
    v_exp_f32 v53, v53
    v_exp_f32 v54, v54
    v_exp_f32 v55, v55
    v_cvt_pk_bf16_f32 v42, v52, v53
    v_cvt_pk_bf16_f32 v43, v54, v55
    v_mfma_f32_32x32x16_bf16 v[96:111], v[220:223], v[44:47], v[96:111]
    v_exp_f32 v56, v56
    v_exp_f32 v57, v57
    v_exp_f32 v58, v58
    v_exp_f32 v59, v59
    v_cvt_pk_bf16_f32 v44, v56, v57
    v_cvt_pk_bf16_f32 v45, v58, v59
    v_mfma_f32_32x32x16_bf16 v[112:127], v[216:219], v[40:43], v[112:127]
    v_exp_f32 v60, v60
    v_exp_f32 v61, v61
    v_exp_f32 v62, v62
    v_exp_f32 v63, v63
    v_cvt_pk_bf16_f32 v46, v60, v61
    v_cvt_pk_bf16_f32 v47, v62, v63
    s_waitcnt vmcnt(10)
    v_mfma_f32_32x32x16_bf16 v[48:63], v[224:227], v[16:19], 0
    v_exp_f32 v64, v64
    v_exp_f32 v65, v65
    v_exp_f32 v66, v66
    v_exp_f32 v67, v67
    v_cvt_pk_bf16_f32 v40, v64, v65
    v_cvt_pk_bf16_f32 v41, v66, v67
    v_mfma_f32_32x32x8bf16_1k v[48:63], v[150:151], v[32:33], v[48:63]
    v_exp_f32 v68, v68
    v_exp_f32 v69, v69
    v_exp_f32 v70, v70
    v_exp_f32 v71, v71
    v_cvt_pk_bf16_f32 v42, v68, v69
    v_cvt_pk_bf16_f32 v43, v70, v71
    v_mfma_f32_32x32x16_bf16 v[112:127], v[220:223], v[44:47], v[112:127]
    v_exp_f32 v72, v72
    v_exp_f32 v73, v73
    v_exp_f32 v74, v74
    v_exp_f32 v75, v75
    v_cvt_pk_bf16_f32 v44, v72, v73
    v_cvt_pk_bf16_f32 v45, v74, v75
    v_mfma_f32_32x32x16_bf16 v[128:143], v[216:219], v[40:43], v[128:143]
    v_exp_f32 v76, v76
    v_exp_f32 v77, v77
    v_exp_f32 v78, v78
    v_exp_f32 v79, v79
    v_cvt_pk_bf16_f32 v46, v76, v77
    v_cvt_pk_bf16_f32 v47, v78, v79
    v_mfma_f32_32x32x16_bf16 v[64:79], v[224:227], v[20:23], 0
    v_exp_f32 v48, v48
    v_exp_f32 v49, v49
    v_exp_f32 v50, v50
    v_exp_f32 v51, v51
    v_cvt_pk_bf16_f32 v40, v48, v49
    v_cvt_pk_bf16_f32 v41, v50, v51
    v_mfma_f32_32x32x8bf16_1k v[64:79], v[150:151], v[34:35], v[64:79]
    v_exp_f32 v52, v52
    v_exp_f32 v53, v53
    v_exp_f32 v54, v54
    v_exp_f32 v55, v55
    v_cvt_pk_bf16_f32 v42, v52, v53
    v_cvt_pk_bf16_f32 v43, v54, v55
    v_mfma_f32_32x32x16_bf16 v[128:143], v[220:223], v[44:47], v[128:143]
    v_exp_f32 v56, v56
    v_exp_f32 v57, v57
    v_exp_f32 v58, v58
    v_exp_f32 v59, v59
    v_cvt_pk_bf16_f32 v44, v56, v57
    v_cvt_pk_bf16_f32 v45, v58, v59
    v_mfma_f32_32x32x16_bf16 v[80:95], v[228:231], v[40:43], v[80:95]
    v_exp_f32 v60, v60
    v_exp_f32 v61, v61
    v_exp_f32 v62, v62
    v_exp_f32 v63, v63
    v_cvt_pk_bf16_f32 v46, v60, v61
    v_cvt_pk_bf16_f32 v47, v62, v63
    v_mfma_f32_32x32x16_bf16 v[48:63], v[224:227], v[24:27], 0
    buffer_load_dwordx2 v[212:213], v176, s[80:83], s92 offen
    buffer_load_dwordx2 v[214:215], v176, s[80:83], s92 offen offset:512
    s_mov_b64 exec, s[94:95]
    buffer_load_dwordx2 v[148:149], v176, s[80:83], s92 offen offset:1024
    s_mov_b64 exec, s[96:97]
    buffer_load_dwordx4 v[216:219], v178, s[80:83], s92 offen offset:1280
    buffer_load_dwordx4 v[220:223], v178, s[80:83], s92 offen offset:1920
    s_mov_b64 exec, -1
    s_add_u32 s92, s92, 2560
    s_min_u32 s92, s92, s50
    v_exp_f32 v64, v64
    v_exp_f32 v65, v65
    v_exp_f32 v66, v66
    v_exp_f32 v67, v67
    v_cvt_pk_bf16_f32 v40, v64, v65
    v_cvt_pk_bf16_f32 v41, v66, v67
    v_mfma_f32_32x32x8bf16_1k v[48:63], v[150:151], v[36:37], v[48:63]
    v_exp_f32 v68, v68
    v_exp_f32 v69, v69
    v_exp_f32 v70, v70
    v_exp_f32 v71, v71
    v_cvt_pk_bf16_f32 v42, v68, v69
    v_cvt_pk_bf16_f32 v43, v70, v71
    v_mfma_f32_32x32x16_bf16 v[80:95], v[232:235], v[44:47], v[80:95]
    v_exp_f32 v72, v72
    v_exp_f32 v73, v73
    v_exp_f32 v74, v74
    v_exp_f32 v75, v75
    v_cvt_pk_bf16_f32 v44, v72, v73
    v_cvt_pk_bf16_f32 v45, v74, v75
    v_mfma_f32_32x32x16_bf16 v[96:111], v[228:231], v[40:43], v[96:111]
    v_exp_f32 v76, v76
    v_exp_f32 v77, v77
    v_exp_f32 v78, v78
    v_exp_f32 v79, v79
    v_cvt_pk_bf16_f32 v46, v76, v77
    v_cvt_pk_bf16_f32 v47, v78, v79
    v_mfma_f32_32x32x16_bf16 v[64:79], v[224:227], v[28:31], 0
    v_exp_f32 v48, v48
    v_exp_f32 v49, v49
    v_exp_f32 v50, v50
    v_exp_f32 v51, v51
    v_cvt_pk_bf16_f32 v40, v48, v49
    v_cvt_pk_bf16_f32 v41, v50, v51
    v_mfma_f32_32x32x8bf16_1k v[64:79], v[150:151], v[38:39], v[64:79]
    v_exp_f32 v52, v52
    v_exp_f32 v53, v53
    v_exp_f32 v54, v54
    v_exp_f32 v55, v55
    v_cvt_pk_bf16_f32 v42, v52, v53
    v_cvt_pk_bf16_f32 v43, v54, v55
    v_mfma_f32_32x32x16_bf16 v[96:111], v[232:235], v[44:47], v[96:111]
    v_exp_f32 v56, v56
    v_exp_f32 v57, v57
    v_exp_f32 v58, v58
    v_exp_f32 v59, v59
    v_cvt_pk_bf16_f32 v44, v56, v57
    v_cvt_pk_bf16_f32 v45, v58, v59
    v_mfma_f32_32x32x16_bf16 v[112:127], v[228:231], v[40:43], v[112:127]
    v_exp_f32 v60, v60
    v_exp_f32 v61, v61
    v_exp_f32 v62, v62
    v_exp_f32 v63, v63
    v_cvt_pk_bf16_f32 v46, v60, v61
    v_cvt_pk_bf16_f32 v47, v62, v63
    s_waitcnt vmcnt(10)
    v_mfma_f32_32x32x16_bf16 v[48:63], v[188:191], v[16:19], 0
    v_exp_f32 v64, v64
    v_exp_f32 v65, v65
    v_exp_f32 v66, v66
    v_exp_f32 v67, v67
    v_cvt_pk_bf16_f32 v40, v64, v65
    v_cvt_pk_bf16_f32 v41, v66, v67
    v_mfma_f32_32x32x8bf16_1k v[48:63], v[144:145], v[32:33], v[48:63]
    v_exp_f32 v68, v68
    v_exp_f32 v69, v69
    v_exp_f32 v70, v70
    v_exp_f32 v71, v71
    v_cvt_pk_bf16_f32 v42, v68, v69
    v_cvt_pk_bf16_f32 v43, v70, v71
    v_mfma_f32_32x32x16_bf16 v[112:127], v[232:235], v[44:47], v[112:127]
    v_exp_f32 v72, v72
    v_exp_f32 v73, v73
    v_exp_f32 v74, v74
    v_exp_f32 v75, v75
    v_cvt_pk_bf16_f32 v44, v72, v73
    v_cvt_pk_bf16_f32 v45, v74, v75
    v_mfma_f32_32x32x16_bf16 v[128:143], v[228:231], v[40:43], v[128:143]
    v_exp_f32 v76, v76
    v_exp_f32 v77, v77
    v_exp_f32 v78, v78
    v_exp_f32 v79, v79
    v_cvt_pk_bf16_f32 v46, v76, v77
    v_cvt_pk_bf16_f32 v47, v78, v79
    s_sub_u32 s93, s93, 1
    s_cmp_lg_u32 s93, 0
    s_cbranch_scc1 recurrent_scan__mha_block__glu_gated_geglu__prompt_kernel_at_loop
    s_setprio 3
    s_nop 1
    v_mfma_f32_32x32x16_bf16 v[128:143], v[232:235], v[44:47], v[128:143]
recurrent_scan__mha_block__glu_gated_geglu__prompt_kernel_at_offs:
    s_mul_i32 s58, s28, 6656
    s_xor_b32 s59, s28, 2
    s_mul_i32 s59, s59, 6656
    s_add_u32 s58, s58, 120832
    s_add_u32 s59, s59, 120832
    v_lshlrev_b32 v160, 4, v1
    v_add_u32 v161, s59, v160
    v_add_u32 v160, s58, v160
    v_lshlrev_b32 v162, 2, v1
    v_add_u32 v163, s59, v162
    v_add_u32 v162, s58, v162
    v_lshlrev_b32 v16, 4, v1
    s_lshl_b32 s58, s88, 10
    v_add_u32 v16, s58, v16
    s_lshr_b32 s58, s88, 2
    s_add_u32 s58, s58, 32
    s_lshl_b32 s58, s58, 10
    s_and_b32 s59, s88, 1
    s_lshl_b32 s59, s59, 9
    s_add_u32 s58, s58, s59
    s_bfe_u32 s59, s88, 0x10001
    s_lshl_b32 s59, s59, 3
    s_add_u32 s58, s58, s59
    v_and_b32 v180, 31, v1
    v_lshlrev_b32 v180, 4, v180
    v_add_u32 v17, s58, v180
    v_mov_b32 v18, 0
    s_lshl_b32 s58, s89, 3
    s_lshl_b32 s59, s90, 2
    s_add_u32 s58, s58, s59
    s_mul_i32 s55, s58, 40960
    v_mov_b32 v180, v88
    v_mov_b32 v152, v88
    s_nop 1
    v_permlane32_swap_b32 v180, v152
    v_mov_b32 v180, v104
    v_mov_b32 v153, v104
    s_nop 1
    v_permlane32_swap_b32 v180, v153
    v_mov_b32 v180, v120
    v_mov_b32 v154, v120
    s_nop 1
    v_permlane32_swap_b32 v180, v154
    v_mov_b32 v180, v136
    v_mov_b32 v155, v136
    s_nop 1
    v_permlane32_swap_b32 v180, v155
    v_mul_f32 v156, 0, v80
    v_mul_f32 v157, 0, v96
    v_mul_f32 v158, 0, v112
    v_mul_f32 v159, 0, v128
    v_fmac_f32 v156, 0, v81
    v_fmac_f32 v157, 0, v97
    v_fmac_f32 v158, 0, v113
    v_fmac_f32 v159, 0, v129
    v_fmac_f32 v156, 0, v82
    v_fmac_f32 v157, 0, v98
    v_fmac_f32 v158, 0, v114
    v_fmac_f32 v159, 0, v130
    v_fmac_f32 v156, 0, v83
    v_fmac_f32 v157, 0, v99
    v_fmac_f32 v158, 0, v115
    v_fmac_f32 v159, 0, v131
    v_fmac_f32 v156, 0, v84
    v_fmac_f32 v157, 0, v100
    v_fmac_f32 v158, 0, v116
    v_fmac_f32 v159, 0, v132
    v_fmac_f32 v156, 0, v85
    v_fmac_f32 v157, 0, v101
    v_fmac_f32 v158, 0, v117
    v_fmac_f32 v159, 0, v133
    v_fmac_f32 v156, 0, v86
    v_fmac_f32 v157, 0, v102
    v_fmac_f32 v158, 0, v118
    v_fmac_f32 v159, 0, v134
    v_fmac_f32 v156, 0, v87
    v_fmac_f32 v157, 0, v103
    v_fmac_f32 v158, 0, v119
    v_fmac_f32 v159, 0, v135
    v_fmac_f32 v156, 0, v88
    v_fmac_f32 v157, 0, v104
    v_fmac_f32 v158, 0, v120
    v_fmac_f32 v159, 0, v136
    v_fmac_f32 v156, 0, v89
    v_fmac_f32 v157, 0, v105
    v_fmac_f32 v158, 0, v121
    v_fmac_f32 v159, 0, v137
    v_fmac_f32 v156, 0, v90
    v_fmac_f32 v157, 0, v106
    v_fmac_f32 v158, 0, v122
    v_fmac_f32 v159, 0, v138
    v_fmac_f32 v156, 0, v91
    v_fmac_f32 v157, 0, v107
    v_fmac_f32 v158, 0, v123
    v_fmac_f32 v159, 0, v139
    v_add_f32 v156, v156, v157
    v_add_f32 v158, v158, v159
    v_add_f32 v156, v156, v158
    v_min3_f32 v179, v152, v153, v154
    v_min_f32 v179, v179, v155
    v_max3_f32 v180, v152, v153, v154
    v_max_f32 v180, v180, v155
    v_cmp_u_f32 vcc, v156, v156
    s_mov_b64 s[100:101], vcc
    v_mov_b32 v181, 0x7b800000
    v_cmp_nlt_f32 vcc, v180, v181
    s_or_b64 s[100:101], s[100:101], vcc
    v_mov_b32 v181, 0x3800000
    v_cmp_ngt_f32 vcc, v179, v181
    s_or_b64 s[100:101], s[100:101], vcc
    s_cmp_eq_u64 s[100:101], 0
    s_cbranch_scc1 recurrent_scan__mha_block__glu_gated_geglu__prompt_kernel_at_fin
recurrent_scan__mha_block__glu_gated_geglu__prompt_kernel_at_slow:
    s_waitcnt vmcnt(0)
    v_mov_b32 v164, v16
    v_mov_b32 v165, v17
    v_mov_b32 v166, v18
    v_mov_b32 v32, 0
    v_mov_b32 v33, 0
    v_mov_b32 v34, 0
    v_mov_b32 v35, 0
    v_mov_b32 v36, 0
    v_mov_b32 v37, 0
    v_mov_b32 v38, 0
    v_mov_b32 v39, 0
    s_add_u32 s58, s56, 0
    buffer_load_dwordx2 v[16:17], v176, s[76:79], s58 offen
    buffer_load_dwordx2 v[18:19], v176, s[76:79], s58 offen offset:512
    s_add_u32 s58, s56, 1280
    buffer_load_dwordx2 v[20:21], v176, s[76:79], s58 offen
    buffer_load_dwordx2 v[22:23], v176, s[76:79], s58 offen offset:512
    s_add_u32 s58, s56, 2560
    buffer_load_dwordx2 v[24:25], v176, s[76:79], s58 offen
    buffer_load_dwordx2 v[26:27], v176, s[76:79], s58 offen offset:512
    s_add_u32 s58, s56, 3840
    buffer_load_dwordx2 v[28:29], v176, s[76:79], s58 offen
    buffer_load_dwordx2 v[30:31], v176, s[76:79], s58 offen offset:512
    s_mov_b64 exec, s[94:95]
    s_add_u32 s58, s56, 0
    buffer_load_dwordx2 v[32:33], v176, s[76:79], s58 offen offset:1024
    s_add_u32 s58, s56, 1280
    buffer_load_dwordx2 v[34:35], v176, s[76:79], s58 offen offset:1024
    s_add_u32 s58, s56, 2560
    buffer_load_dwordx2 v[36:37], v176, s[76:79], s58 offen offset:1024
    s_add_u32 s58, s56, 3840
    buffer_load_dwordx2 v[38:39], v176, s[76:79], s58 offen offset:1024
    s_mov_b64 exec, -1
    s_mov_b32 s92, s57
    v_mov_b32 v182, 0xff800000
    v_mov_b32 v80, 0
    v_mov_b32 v81, 0
    v_mov_b32 v82, 0
    v_mov_b32 v83, 0
    v_mov_b32 v84, 0
    v_mov_b32 v85, 0
    v_mov_b32 v86, 0
    v_mov_b32 v87, 0
    v_mov_b32 v88, 0
    v_mov_b32 v89, 0
    v_mov_b32 v90, 0
    v_mov_b32 v91, 0
    v_mov_b32 v92, 0
    v_mov_b32 v93, 0
    v_mov_b32 v94, 0
    v_mov_b32 v95, 0
    v_mov_b32 v183, 0xff800000
    v_mov_b32 v96, 0
    v_mov_b32 v97, 0
    v_mov_b32 v98, 0
    v_mov_b32 v99, 0
    v_mov_b32 v100, 0
    v_mov_b32 v101, 0
    v_mov_b32 v102, 0
    v_mov_b32 v103, 0
    v_mov_b32 v104, 0
    v_mov_b32 v105, 0
    v_mov_b32 v106, 0
    v_mov_b32 v107, 0
    v_mov_b32 v108, 0
    v_mov_b32 v109, 0
    v_mov_b32 v110, 0
    v_mov_b32 v111, 0
    v_mov_b32 v184, 0xff800000
    v_mov_b32 v112, 0
    v_mov_b32 v113, 0
    v_mov_b32 v114, 0
    v_mov_b32 v115, 0
    v_mov_b32 v116, 0
    v_mov_b32 v117, 0
    v_mov_b32 v118, 0
    v_mov_b32 v119, 0
    v_mov_b32 v120, 0
    v_mov_b32 v121, 0
    v_mov_b32 v122, 0
    v_mov_b32 v123, 0
    v_mov_b32 v124, 0
    v_mov_b32 v125, 0
    v_mov_b32 v126, 0
    v_mov_b32 v127, 0
    v_mov_b32 v185, 0xff800000
    v_mov_b32 v128, 0
    v_mov_b32 v129, 0
    v_mov_b32 v130, 0
    v_mov_b32 v131, 0
    v_mov_b32 v132, 0
    v_mov_b32 v133, 0
    v_mov_b32 v134, 0
    v_mov_b32 v135, 0
    v_mov_b32 v136, 0
    v_mov_b32 v137, 0
    v_mov_b32 v138, 0
    v_mov_b32 v139, 0
    v_mov_b32 v140, 0
    v_mov_b32 v141, 0
    v_mov_b32 v142, 0
    v_mov_b32 v143, 0
    s_mov_b32 s93, 32
recurrent_scan__mha_block__glu_gated_geglu__prompt_kernel_at_sloop:
    buffer_load_dwordx2 v[188:189], v176, s[80:83], s92 offen
    buffer_load_dwordx2 v[190:191], v176, s[80:83], s92 offen offset:512
    s_mov_b64 exec, s[94:95]
    buffer_load_dwordx2 v[144:145], v176, s[80:83], s92 offen offset:1024
    s_mov_b64 exec, s[96:97]
    buffer_load_dwordx4 v[192:195], v178, s[80:83], s92 offen offset:1280
    buffer_load_dwordx4 v[196:199], v178, s[80:83], s92 offen offset:1920
    s_mov_b64 exec, -1
    s_add_u32 s92, s92, 2560
    s_min_u32 s92, s92, s50
    s_waitcnt vmcnt(0)
    v_mfma_f32_32x32x16_bf16 v[48:63], v[188:191], v[16:19], 0
    v_mfma_f32_32x32x8bf16_1k v[48:63], v[144:145], v[32:33], v[48:63]
    s_nop 15
    s_nop 7
    v_max3_f32 v179, v48, v49, v50
    v_max3_f32 v179, v179, v51, v52
    v_max3_f32 v179, v179, v53, v54
    v_max3_f32 v179, v179, v55, v56
    v_max3_f32 v179, v179, v57, v58
    v_max3_f32 v179, v179, v59, v60
    v_max3_f32 v179, v179, v61, v62
    v_max3_f32 v179, v179, v63, v63
    v_mov_b32 v180, v179
    v_mov_b32 v181, v179
    s_nop 1
    v_permlane32_swap_b32 v180, v181
    s_nop 1
    v_max_f32 v179, v180, v181
    v_max_f32 v179, v179, v182
    v_sub_f32 v180, v182, v179
    v_exp_f32 v180, v180
    v_mov_b32 v182, v179
    v_sub_f32 v48, v48, v179
    v_sub_f32 v49, v49, v179
    v_sub_f32 v50, v50, v179
    v_sub_f32 v51, v51, v179
    v_sub_f32 v52, v52, v179
    v_sub_f32 v53, v53, v179
    v_sub_f32 v54, v54, v179
    v_sub_f32 v55, v55, v179
    v_sub_f32 v56, v56, v179
    v_sub_f32 v57, v57, v179
    v_sub_f32 v58, v58, v179
    v_sub_f32 v59, v59, v179
    v_sub_f32 v60, v60, v179
    v_sub_f32 v61, v61, v179
    v_sub_f32 v62, v62, v179
    v_sub_f32 v63, v63, v179
    v_mul_f32 v80, v80, v180
    v_mul_f32 v81, v81, v180
    v_mul_f32 v82, v82, v180
    v_mul_f32 v83, v83, v180
    v_mul_f32 v84, v84, v180
    v_mul_f32 v85, v85, v180
    v_mul_f32 v86, v86, v180
    v_mul_f32 v87, v87, v180
    v_mul_f32 v88, v88, v180
    v_mul_f32 v89, v89, v180
    v_mul_f32 v90, v90, v180
    v_mul_f32 v91, v91, v180
    v_mul_f32 v92, v92, v180
    v_mul_f32 v93, v93, v180
    v_mul_f32 v94, v94, v180
    v_mul_f32 v95, v95, v180
    v_exp_f32 v48, v48
    v_exp_f32 v49, v49
    v_exp_f32 v50, v50
    v_exp_f32 v51, v51
    v_exp_f32 v52, v52
    v_exp_f32 v53, v53
    v_exp_f32 v54, v54
    v_exp_f32 v55, v55
    v_exp_f32 v56, v56
    v_exp_f32 v57, v57
    v_exp_f32 v58, v58
    v_exp_f32 v59, v59
    v_exp_f32 v60, v60
    v_exp_f32 v61, v61
    v_exp_f32 v62, v62
    v_exp_f32 v63, v63
    s_nop 1
    v_cvt_pk_bf16_f32 v40, v48, v49
    v_cvt_pk_bf16_f32 v41, v50, v51
    v_cvt_pk_bf16_f32 v42, v52, v53
    v_cvt_pk_bf16_f32 v43, v54, v55
    v_cvt_pk_bf16_f32 v44, v56, v57
    v_cvt_pk_bf16_f32 v45, v58, v59
    v_cvt_pk_bf16_f32 v46, v60, v61
    v_cvt_pk_bf16_f32 v47, v62, v63
    s_nop 1
    v_mfma_f32_32x32x16_bf16 v[80:95], v[192:195], v[40:43], v[80:95]
    v_mfma_f32_32x32x16_bf16 v[80:95], v[196:199], v[44:47], v[80:95]
    s_nop 15
    s_nop 7
    v_mfma_f32_32x32x16_bf16 v[48:63], v[188:191], v[20:23], 0
    v_mfma_f32_32x32x8bf16_1k v[48:63], v[144:145], v[34:35], v[48:63]
    s_nop 15
    s_nop 7
    v_max3_f32 v179, v48, v49, v50
    v_max3_f32 v179, v179, v51, v52
    v_max3_f32 v179, v179, v53, v54
    v_max3_f32 v179, v179, v55, v56
    v_max3_f32 v179, v179, v57, v58
    v_max3_f32 v179, v179, v59, v60
    v_max3_f32 v179, v179, v61, v62
    v_max3_f32 v179, v179, v63, v63
    v_mov_b32 v180, v179
    v_mov_b32 v181, v179
    s_nop 1
    v_permlane32_swap_b32 v180, v181
    s_nop 1
    v_max_f32 v179, v180, v181
    v_max_f32 v179, v179, v183
    v_sub_f32 v180, v183, v179
    v_exp_f32 v180, v180
    v_mov_b32 v183, v179
    v_sub_f32 v48, v48, v179
    v_sub_f32 v49, v49, v179
    v_sub_f32 v50, v50, v179
    v_sub_f32 v51, v51, v179
    v_sub_f32 v52, v52, v179
    v_sub_f32 v53, v53, v179
    v_sub_f32 v54, v54, v179
    v_sub_f32 v55, v55, v179
    v_sub_f32 v56, v56, v179
    v_sub_f32 v57, v57, v179
    v_sub_f32 v58, v58, v179
    v_sub_f32 v59, v59, v179
    v_sub_f32 v60, v60, v179
    v_sub_f32 v61, v61, v179
    v_sub_f32 v62, v62, v179
    v_sub_f32 v63, v63, v179
    v_mul_f32 v96, v96, v180
    v_mul_f32 v97, v97, v180
    v_mul_f32 v98, v98, v180
    v_mul_f32 v99, v99, v180
    v_mul_f32 v100, v100, v180
    v_mul_f32 v101, v101, v180
    v_mul_f32 v102, v102, v180
    v_mul_f32 v103, v103, v180
    v_mul_f32 v104, v104, v180
    v_mul_f32 v105, v105, v180
    v_mul_f32 v106, v106, v180
    v_mul_f32 v107, v107, v180
    v_mul_f32 v108, v108, v180
    v_mul_f32 v109, v109, v180
    v_mul_f32 v110, v110, v180
    v_mul_f32 v111, v111, v180
    v_exp_f32 v48, v48
    v_exp_f32 v49, v49
    v_exp_f32 v50, v50
    v_exp_f32 v51, v51
    v_exp_f32 v52, v52
    v_exp_f32 v53, v53
    v_exp_f32 v54, v54
    v_exp_f32 v55, v55
    v_exp_f32 v56, v56
    v_exp_f32 v57, v57
    v_exp_f32 v58, v58
    v_exp_f32 v59, v59
    v_exp_f32 v60, v60
    v_exp_f32 v61, v61
    v_exp_f32 v62, v62
    v_exp_f32 v63, v63
    s_nop 1
    v_cvt_pk_bf16_f32 v40, v48, v49
    v_cvt_pk_bf16_f32 v41, v50, v51
    v_cvt_pk_bf16_f32 v42, v52, v53
    v_cvt_pk_bf16_f32 v43, v54, v55
    v_cvt_pk_bf16_f32 v44, v56, v57
    v_cvt_pk_bf16_f32 v45, v58, v59
    v_cvt_pk_bf16_f32 v46, v60, v61
    v_cvt_pk_bf16_f32 v47, v62, v63
    s_nop 1
    v_mfma_f32_32x32x16_bf16 v[96:111], v[192:195], v[40:43], v[96:111]
    v_mfma_f32_32x32x16_bf16 v[96:111], v[196:199], v[44:47], v[96:111]
    s_nop 15
    s_nop 7
    v_mfma_f32_32x32x16_bf16 v[48:63], v[188:191], v[24:27], 0
    v_mfma_f32_32x32x8bf16_1k v[48:63], v[144:145], v[36:37], v[48:63]
    s_nop 15
    s_nop 7
    v_max3_f32 v179, v48, v49, v50
    v_max3_f32 v179, v179, v51, v52
    v_max3_f32 v179, v179, v53, v54
    v_max3_f32 v179, v179, v55, v56
    v_max3_f32 v179, v179, v57, v58
    v_max3_f32 v179, v179, v59, v60
    v_max3_f32 v179, v179, v61, v62
    v_max3_f32 v179, v179, v63, v63
    v_mov_b32 v180, v179
    v_mov_b32 v181, v179
    s_nop 1
    v_permlane32_swap_b32 v180, v181
    s_nop 1
    v_max_f32 v179, v180, v181
    v_max_f32 v179, v179, v184
    v_sub_f32 v180, v184, v179
    v_exp_f32 v180, v180
    v_mov_b32 v184, v179
    v_sub_f32 v48, v48, v179
    v_sub_f32 v49, v49, v179
    v_sub_f32 v50, v50, v179
    v_sub_f32 v51, v51, v179
    v_sub_f32 v52, v52, v179
    v_sub_f32 v53, v53, v179
    v_sub_f32 v54, v54, v179
    v_sub_f32 v55, v55, v179
    v_sub_f32 v56, v56, v179
    v_sub_f32 v57, v57, v179
    v_sub_f32 v58, v58, v179
    v_sub_f32 v59, v59, v179
    v_sub_f32 v60, v60, v179
    v_sub_f32 v61, v61, v179
    v_sub_f32 v62, v62, v179
    v_sub_f32 v63, v63, v179
    v_mul_f32 v112, v112, v180
    v_mul_f32 v113, v113, v180
    v_mul_f32 v114, v114, v180
    v_mul_f32 v115, v115, v180
    v_mul_f32 v116, v116, v180
    v_mul_f32 v117, v117, v180
    v_mul_f32 v118, v118, v180
    v_mul_f32 v119, v119, v180
    v_mul_f32 v120, v120, v180
    v_mul_f32 v121, v121, v180
    v_mul_f32 v122, v122, v180
    v_mul_f32 v123, v123, v180
    v_mul_f32 v124, v124, v180
    v_mul_f32 v125, v125, v180
    v_mul_f32 v126, v126, v180
    v_mul_f32 v127, v127, v180
    v_exp_f32 v48, v48
    v_exp_f32 v49, v49
    v_exp_f32 v50, v50
    v_exp_f32 v51, v51
    v_exp_f32 v52, v52
    v_exp_f32 v53, v53
    v_exp_f32 v54, v54
    v_exp_f32 v55, v55
    v_exp_f32 v56, v56
    v_exp_f32 v57, v57
    v_exp_f32 v58, v58
    v_exp_f32 v59, v59
    v_exp_f32 v60, v60
    v_exp_f32 v61, v61
    v_exp_f32 v62, v62
    v_exp_f32 v63, v63
    s_nop 1
    v_cvt_pk_bf16_f32 v40, v48, v49
    v_cvt_pk_bf16_f32 v41, v50, v51
    v_cvt_pk_bf16_f32 v42, v52, v53
    v_cvt_pk_bf16_f32 v43, v54, v55
    v_cvt_pk_bf16_f32 v44, v56, v57
    v_cvt_pk_bf16_f32 v45, v58, v59
    v_cvt_pk_bf16_f32 v46, v60, v61
    v_cvt_pk_bf16_f32 v47, v62, v63
    s_nop 1
    v_mfma_f32_32x32x16_bf16 v[112:127], v[192:195], v[40:43], v[112:127]
    v_mfma_f32_32x32x16_bf16 v[112:127], v[196:199], v[44:47], v[112:127]
    s_nop 15
    s_nop 7
    v_mfma_f32_32x32x16_bf16 v[48:63], v[188:191], v[28:31], 0
    v_mfma_f32_32x32x8bf16_1k v[48:63], v[144:145], v[38:39], v[48:63]
    s_nop 15
    s_nop 7
    v_max3_f32 v179, v48, v49, v50
    v_max3_f32 v179, v179, v51, v52
    v_max3_f32 v179, v179, v53, v54
    v_max3_f32 v179, v179, v55, v56
    v_max3_f32 v179, v179, v57, v58
    v_max3_f32 v179, v179, v59, v60
    v_max3_f32 v179, v179, v61, v62
    v_max3_f32 v179, v179, v63, v63
    v_mov_b32 v180, v179
    v_mov_b32 v181, v179
    s_nop 1
    v_permlane32_swap_b32 v180, v181
    s_nop 1
    v_max_f32 v179, v180, v181
    v_max_f32 v179, v179, v185
    v_sub_f32 v180, v185, v179
    v_exp_f32 v180, v180
    v_mov_b32 v185, v179
    v_sub_f32 v48, v48, v179
    v_sub_f32 v49, v49, v179
    v_sub_f32 v50, v50, v179
    v_sub_f32 v51, v51, v179
    v_sub_f32 v52, v52, v179
    v_sub_f32 v53, v53, v179
    v_sub_f32 v54, v54, v179
    v_sub_f32 v55, v55, v179
    v_sub_f32 v56, v56, v179
    v_sub_f32 v57, v57, v179
    v_sub_f32 v58, v58, v179
    v_sub_f32 v59, v59, v179
    v_sub_f32 v60, v60, v179
    v_sub_f32 v61, v61, v179
    v_sub_f32 v62, v62, v179
    v_sub_f32 v63, v63, v179
    v_mul_f32 v128, v128, v180
    v_mul_f32 v129, v129, v180
    v_mul_f32 v130, v130, v180
    v_mul_f32 v131, v131, v180
    v_mul_f32 v132, v132, v180
    v_mul_f32 v133, v133, v180
    v_mul_f32 v134, v134, v180
    v_mul_f32 v135, v135, v180
    v_mul_f32 v136, v136, v180
    v_mul_f32 v137, v137, v180
    v_mul_f32 v138, v138, v180
    v_mul_f32 v139, v139, v180
    v_mul_f32 v140, v140, v180
    v_mul_f32 v141, v141, v180
    v_mul_f32 v142, v142, v180
    v_mul_f32 v143, v143, v180
    v_exp_f32 v48, v48
    v_exp_f32 v49, v49
    v_exp_f32 v50, v50
    v_exp_f32 v51, v51
    v_exp_f32 v52, v52
    v_exp_f32 v53, v53
    v_exp_f32 v54, v54
    v_exp_f32 v55, v55
    v_exp_f32 v56, v56
    v_exp_f32 v57, v57
    v_exp_f32 v58, v58
    v_exp_f32 v59, v59
    v_exp_f32 v60, v60
    v_exp_f32 v61, v61
    v_exp_f32 v62, v62
    v_exp_f32 v63, v63
    s_nop 1
    v_cvt_pk_bf16_f32 v40, v48, v49
    v_cvt_pk_bf16_f32 v41, v50, v51
    v_cvt_pk_bf16_f32 v42, v52, v53
    v_cvt_pk_bf16_f32 v43, v54, v55
    v_cvt_pk_bf16_f32 v44, v56, v57
    v_cvt_pk_bf16_f32 v45, v58, v59
    v_cvt_pk_bf16_f32 v46, v60, v61
    v_cvt_pk_bf16_f32 v47, v62, v63
    s_nop 1
    v_mfma_f32_32x32x16_bf16 v[128:143], v[192:195], v[40:43], v[128:143]
    v_mfma_f32_32x32x16_bf16 v[128:143], v[196:199], v[44:47], v[128:143]
    s_nop 15
    s_nop 7
    s_sub_u32 s93, s93, 1
    s_cmp_lg_u32 s93, 0
    s_cbranch_scc1 recurrent_scan__mha_block__glu_gated_geglu__prompt_kernel_at_sloop
    v_mov_b32 v16, v164
    v_mov_b32 v17, v165
    v_mov_b32 v18, v166
    v_mov_b32 v180, v88
    v_mov_b32 v152, v88
    s_nop 1
    v_permlane32_swap_b32 v180, v152
    v_mov_b32 v180, v104
    v_mov_b32 v153, v104
    s_nop 1
    v_permlane32_swap_b32 v180, v153
    v_mov_b32 v180, v120
    v_mov_b32 v154, v120
    s_nop 1
    v_permlane32_swap_b32 v180, v154
    v_mov_b32 v180, v136
    v_mov_b32 v155, v136
    s_nop 1
    v_permlane32_swap_b32 v180, v155
    s_nop 1
recurrent_scan__mha_block__glu_gated_geglu__prompt_kernel_at_fin:
    v_rcp_f32 v76, v152
    v_rcp_f32 v77, v153
    v_rcp_f32 v78, v154
    v_rcp_f32 v79, v155
    v_log_f32 v156, v152
    v_log_f32 v157, v153
    v_log_f32 v158, v154
    v_log_f32 v159, v155
    s_nop 0
    v_add_f32 v156, v156, v182
    v_add_f32 v157, v157, v183
    v_add_f32 v158, v158, v184
    v_add_f32 v159, v159, v185
    s_cmp_eq_u32 s91, 0
    s_cbranch_scc0 recurrent_scan__mha_block__glu_gated_geglu__prompt_kernel_at_kh1
    v_mul_f32 v112, v112, v78
    v_mul_f32 v113, v113, v78
    v_mul_f32 v114, v114, v78
    v_mul_f32 v115, v115, v78
    v_mul_f32 v116, v116, v78
    v_mul_f32 v117, v117, v78
    v_mul_f32 v118, v118, v78
    v_mul_f32 v119, v119, v78
    v_mul_f32 v120, v120, v78
    v_mul_f32 v121, v121, v78
    v_mul_f32 v122, v122, v78
    v_mul_f32 v123, v123, v78
    v_mul_f32 v128, v128, v79
    v_mul_f32 v129, v129, v79
    v_mul_f32 v130, v130, v79
    v_mul_f32 v131, v131, v79
    v_mul_f32 v132, v132, v79
    v_mul_f32 v133, v133, v79
    v_mul_f32 v134, v134, v79
    v_mul_f32 v135, v135, v79
    v_mul_f32 v136, v136, v79
    v_mul_f32 v137, v137, v79
    v_mul_f32 v138, v138, v79
    v_mul_f32 v139, v139, v79
    v_mov_b32 v179, 147488
    s_mov_b32 s59, 0
recurrent_scan__mha_block__glu_gated_geglu__prompt_kernel_at_gd_7:
    ds_read_b32 v180, v179
    s_add_u32 s59, s59, 1
    s_cmp_ge_u32 s59, 0x100000
    s_cbranch_scc1 recurrent_scan__mha_block__glu_gated_geglu__prompt_kernel_at_gd_7_x
    s_waitcnt lgkmcnt(0)
    v_readfirstlane_b32 s58, v180
    s_cmp_eq_u32 s58, 4
    s_cbranch_scc1 recurrent_scan__mha_block__glu_gated_geglu__prompt_kernel_at_gd_7_x
    s_sleep 8
    s_branch recurrent_scan__mha_block__glu_gated_geglu__prompt_kernel_at_gd_7
recurrent_scan__mha_block__glu_gated_geglu__prompt_kernel_at_gd_7_x:
    s_waitcnt lgkmcnt(0)
    ds_write_b128 v160, v[112:115] offset:0
    ds_write_b128 v160, v[116:119] offset:1024
    ds_write_b128 v160, v[120:123] offset:2048
    ds_write_b32 v162, v158 offset:3072
    ds_write_b128 v160, v[128:131] offset:3328
    ds_write_b128 v160, v[132:135] offset:4352
    ds_write_b128 v160, v[136:139] offset:5376
    ds_write_b32 v162, v159 offset:6400
    v_mul_f32 v80, v80, v76
    v_mul_f32 v81, v81, v76
    v_mul_f32 v82, v82, v76
    v_mul_f32 v83, v83, v76
    v_mul_f32 v84, v84, v76
    v_mul_f32 v85, v85, v76
    v_mul_f32 v86, v86, v76
    v_mul_f32 v87, v87, v76
    v_mul_f32 v88, v88, v76
    v_mul_f32 v89, v89, v76
    v_mul_f32 v90, v90, v76
    v_mul_f32 v91, v91, v76
    v_mul_f32 v96, v96, v77
    v_mul_f32 v97, v97, v77
    v_mul_f32 v98, v98, v77
    v_mul_f32 v99, v99, v77
    v_mul_f32 v100, v100, v77
    v_mul_f32 v101, v101, v77
    v_mul_f32 v102, v102, v77
    v_mul_f32 v103, v103, v77
    v_mul_f32 v104, v104, v77
    v_mul_f32 v105, v105, v77
    v_mul_f32 v106, v106, v77
    v_mul_f32 v107, v107, v77
    s_waitcnt lgkmcnt(0)
    s_lshl_b32 s58, s28, 2
    s_add_u32 s58, s58, 147472
    v_mov_b32 v179, s58
    v_mov_b32 v180, 1
    ds_write_b32 v179, v180
    v_xor_b32 v179, 8, v179
    s_mov_b32 s59, 0
recurrent_scan__mha_block__glu_gated_geglu__prompt_kernel_at_pf_8:
    ds_read_b32 v180, v179
    s_add_u32 s59, s59, 1
    s_cmp_ge_u32 s59, 0x100000
    s_cbranch_scc1 recurrent_scan__mha_block__glu_gated_geglu__prompt_kernel_at_pf_8_x
    s_waitcnt lgkmcnt(0)
    v_readfirstlane_b32 s58, v180
    s_cmp_eq_u32 s58, 1
    s_cbranch_scc1 recurrent_scan__mha_block__glu_gated_geglu__prompt_kernel_at_pf_8_x
    s_sleep 1
    s_branch recurrent_scan__mha_block__glu_gated_geglu__prompt_kernel_at_pf_8
recurrent_scan__mha_block__glu_gated_geglu__prompt_kernel_at_pf_8_x:
    s_waitcnt lgkmcnt(0)
    ds_read_b128 v[48:51], v161 offset:0
    ds_read_b128 v[52:55], v161 offset:1024
    ds_read_b128 v[56:59], v161 offset:2048
    ds_read_b32 v46, v163 offset:3072
    ds_read_b128 v[64:67], v161 offset:3328
    ds_read_b128 v[68:71], v161 offset:4352
    ds_read_b128 v[72:75], v161 offset:5376
    ds_read_b32 v47, v163 offset:6400
    s_waitcnt lgkmcnt(0)
    v_sub_f32 v168, v46, v156
    v_sub_f32 v169, v156, v46
    v_sub_f32 v170, v47, v157
    v_sub_f32 v171, v157, v47
    v_exp_f32 v168, v168
    v_exp_f32 v169, v169
    v_exp_f32 v170, v170
    v_exp_f32 v171, v171
    s_nop 0
    v_add_f32 v168, 1.0, v168
    v_add_f32 v169, 1.0, v169
    v_add_f32 v170, 1.0, v170
    v_add_f32 v171, 1.0, v171
    v_rcp_f32 v168, v168
    v_rcp_f32 v169, v169
    v_rcp_f32 v170, v170
    v_rcp_f32 v171, v171
    s_nop 0
    v_mul_f32 v80, v80, v168
    v_mul_f32 v81, v81, v168
    v_mul_f32 v82, v82, v168
    v_mul_f32 v83, v83, v168
    v_mul_f32 v84, v84, v168
    v_mul_f32 v85, v85, v168
    v_mul_f32 v86, v86, v168
    v_mul_f32 v87, v87, v168
    v_mul_f32 v88, v88, v168
    v_mul_f32 v89, v89, v168
    v_mul_f32 v90, v90, v168
    v_mul_f32 v91, v91, v168
    v_fmac_f32 v80, v48, v169
    v_fmac_f32 v81, v49, v169
    v_fmac_f32 v82, v50, v169
    v_fmac_f32 v83, v51, v169
    v_fmac_f32 v84, v52, v169
    v_fmac_f32 v85, v53, v169
    v_fmac_f32 v86, v54, v169
    v_fmac_f32 v87, v55, v169
    v_fmac_f32 v88, v56, v169
    v_fmac_f32 v89, v57, v169
    v_fmac_f32 v90, v58, v169
    v_fmac_f32 v91, v59, v169
    v_cvt_pk_bf16_f32 v80, v80, v81
    v_cvt_pk_bf16_f32 v81, v82, v83
    v_cvt_pk_bf16_f32 v82, v84, v85
    v_cvt_pk_bf16_f32 v83, v86, v87
    v_cvt_pk_bf16_f32 v84, v88, v89
    v_cvt_pk_bf16_f32 v85, v90, v91
    s_add_u32 s58, s55, 0
    buffer_store_dwordx4 v[80:83], v16, s[84:87], s58 offen sc0 sc1
    s_mov_b64 exec, s[94:95]
    buffer_store_dwordx2 v[84:85], v17, s[84:87], s58 offen sc0 sc1
    s_mov_b64 exec, -1
    v_mul_f32 v96, v96, v170
    v_mul_f32 v97, v97, v170
    v_mul_f32 v98, v98, v170
    v_mul_f32 v99, v99, v170
    v_mul_f32 v100, v100, v170
    v_mul_f32 v101, v101, v170
    v_mul_f32 v102, v102, v170
    v_mul_f32 v103, v103, v170
    v_mul_f32 v104, v104, v170
    v_mul_f32 v105, v105, v170
    v_mul_f32 v106, v106, v170
    v_mul_f32 v107, v107, v170
    v_fmac_f32 v96, v64, v171
    v_fmac_f32 v97, v65, v171
    v_fmac_f32 v98, v66, v171
    v_fmac_f32 v99, v67, v171
    v_fmac_f32 v100, v68, v171
    v_fmac_f32 v101, v69, v171
    v_fmac_f32 v102, v70, v171
    v_fmac_f32 v103, v71, v171
    v_fmac_f32 v104, v72, v171
    v_fmac_f32 v105, v73, v171
    v_fmac_f32 v106, v74, v171
    v_fmac_f32 v107, v75, v171
    v_cvt_pk_bf16_f32 v96, v96, v97
    v_cvt_pk_bf16_f32 v97, v98, v99
    v_cvt_pk_bf16_f32 v98, v100, v101
    v_cvt_pk_bf16_f32 v99, v102, v103
    v_cvt_pk_bf16_f32 v100, v104, v105
    v_cvt_pk_bf16_f32 v101, v106, v107
    s_add_u32 s58, s55, 40960
    buffer_store_dwordx4 v[96:99], v16, s[84:87], s58 offen sc0 sc1
    s_mov_b64 exec, s[94:95]
    buffer_store_dwordx2 v[100:101], v17, s[84:87], s58 offen sc0 sc1
    s_mov_b64 exec, -1
    s_branch recurrent_scan__mha_block__glu_gated_geglu__prompt_kernel_at_done
recurrent_scan__mha_block__glu_gated_geglu__prompt_kernel_at_kh1:
    v_mul_f32 v80, v80, v76
    v_mul_f32 v81, v81, v76
    v_mul_f32 v82, v82, v76
    v_mul_f32 v83, v83, v76
    v_mul_f32 v84, v84, v76
    v_mul_f32 v85, v85, v76
    v_mul_f32 v86, v86, v76
    v_mul_f32 v87, v87, v76
    v_mul_f32 v88, v88, v76
    v_mul_f32 v89, v89, v76
    v_mul_f32 v90, v90, v76
    v_mul_f32 v91, v91, v76
    v_mul_f32 v96, v96, v77
    v_mul_f32 v97, v97, v77
    v_mul_f32 v98, v98, v77
    v_mul_f32 v99, v99, v77
    v_mul_f32 v100, v100, v77
    v_mul_f32 v101, v101, v77
    v_mul_f32 v102, v102, v77
    v_mul_f32 v103, v103, v77
    v_mul_f32 v104, v104, v77
    v_mul_f32 v105, v105, v77
    v_mul_f32 v106, v106, v77
    v_mul_f32 v107, v107, v77
    v_mov_b32 v179, 147488
    s_mov_b32 s59, 0
recurrent_scan__mha_block__glu_gated_geglu__prompt_kernel_at_gd_9:
    ds_read_b32 v180, v179
    s_add_u32 s59, s59, 1
    s_cmp_ge_u32 s59, 0x100000
    s_cbranch_scc1 recurrent_scan__mha_block__glu_gated_geglu__prompt_kernel_at_gd_9_x
    s_waitcnt lgkmcnt(0)
    v_readfirstlane_b32 s58, v180
    s_cmp_eq_u32 s58, 4
    s_cbranch_scc1 recurrent_scan__mha_block__glu_gated_geglu__prompt_kernel_at_gd_9_x
    s_sleep 8
    s_branch recurrent_scan__mha_block__glu_gated_geglu__prompt_kernel_at_gd_9
recurrent_scan__mha_block__glu_gated_geglu__prompt_kernel_at_gd_9_x:
    s_waitcnt lgkmcnt(0)
    ds_write_b128 v160, v[80:83] offset:0
    ds_write_b128 v160, v[84:87] offset:1024
    ds_write_b128 v160, v[88:91] offset:2048
    ds_write_b32 v162, v156 offset:3072
    ds_write_b128 v160, v[96:99] offset:3328
    ds_write_b128 v160, v[100:103] offset:4352
    ds_write_b128 v160, v[104:107] offset:5376
    ds_write_b32 v162, v157 offset:6400
    v_mul_f32 v112, v112, v78
    v_mul_f32 v113, v113, v78
    v_mul_f32 v114, v114, v78
    v_mul_f32 v115, v115, v78
    v_mul_f32 v116, v116, v78
    v_mul_f32 v117, v117, v78
    v_mul_f32 v118, v118, v78
    v_mul_f32 v119, v119, v78
    v_mul_f32 v120, v120, v78
    v_mul_f32 v121, v121, v78
    v_mul_f32 v122, v122, v78
    v_mul_f32 v123, v123, v78
    v_mul_f32 v128, v128, v79
    v_mul_f32 v129, v129, v79
    v_mul_f32 v130, v130, v79
    v_mul_f32 v131, v131, v79
    v_mul_f32 v132, v132, v79
    v_mul_f32 v133, v133, v79
    v_mul_f32 v134, v134, v79
    v_mul_f32 v135, v135, v79
    v_mul_f32 v136, v136, v79
    v_mul_f32 v137, v137, v79
    v_mul_f32 v138, v138, v79
    v_mul_f32 v139, v139, v79
    s_waitcnt lgkmcnt(0)
    s_lshl_b32 s58, s28, 2
    s_add_u32 s58, s58, 147472
    v_mov_b32 v179, s58
    v_mov_b32 v180, 1
    ds_write_b32 v179, v180
    v_xor_b32 v179, 8, v179
    s_mov_b32 s59, 0
recurrent_scan__mha_block__glu_gated_geglu__prompt_kernel_at_pf_10:
    ds_read_b32 v180, v179
    s_add_u32 s59, s59, 1
    s_cmp_ge_u32 s59, 0x100000
    s_cbranch_scc1 recurrent_scan__mha_block__glu_gated_geglu__prompt_kernel_at_pf_10_x
    s_waitcnt lgkmcnt(0)
    v_readfirstlane_b32 s58, v180
    s_cmp_eq_u32 s58, 1
    s_cbranch_scc1 recurrent_scan__mha_block__glu_gated_geglu__prompt_kernel_at_pf_10_x
    s_sleep 1
    s_branch recurrent_scan__mha_block__glu_gated_geglu__prompt_kernel_at_pf_10
recurrent_scan__mha_block__glu_gated_geglu__prompt_kernel_at_pf_10_x:
    s_waitcnt lgkmcnt(0)
    ds_read_b128 v[48:51], v161 offset:0
    ds_read_b128 v[52:55], v161 offset:1024
    ds_read_b128 v[56:59], v161 offset:2048
    ds_read_b32 v46, v163 offset:3072
    ds_read_b128 v[64:67], v161 offset:3328
    ds_read_b128 v[68:71], v161 offset:4352
    ds_read_b128 v[72:75], v161 offset:5376
    ds_read_b32 v47, v163 offset:6400
    s_waitcnt lgkmcnt(0)
    v_sub_f32 v168, v46, v158
    v_sub_f32 v169, v158, v46
    v_sub_f32 v170, v47, v159
    v_sub_f32 v171, v159, v47
    v_exp_f32 v168, v168
    v_exp_f32 v169, v169
    v_exp_f32 v170, v170
    v_exp_f32 v171, v171
    s_nop 0
    v_add_f32 v168, 1.0, v168
    v_add_f32 v169, 1.0, v169
    v_add_f32 v170, 1.0, v170
    v_add_f32 v171, 1.0, v171
    v_rcp_f32 v168, v168
    v_rcp_f32 v169, v169
    v_rcp_f32 v170, v170
    v_rcp_f32 v171, v171
    s_nop 0
    v_mul_f32 v112, v112, v168
    v_mul_f32 v113, v113, v168
    v_mul_f32 v114, v114, v168
    v_mul_f32 v115, v115, v168
    v_mul_f32 v116, v116, v168
    v_mul_f32 v117, v117, v168
    v_mul_f32 v118, v118, v168
    v_mul_f32 v119, v119, v168
    v_mul_f32 v120, v120, v168
    v_mul_f32 v121, v121, v168
    v_mul_f32 v122, v122, v168
    v_mul_f32 v123, v123, v168
    v_fmac_f32 v112, v48, v169
    v_fmac_f32 v113, v49, v169
    v_fmac_f32 v114, v50, v169
    v_fmac_f32 v115, v51, v169
    v_fmac_f32 v116, v52, v169
    v_fmac_f32 v117, v53, v169
    v_fmac_f32 v118, v54, v169
    v_fmac_f32 v119, v55, v169
    v_fmac_f32 v120, v56, v169
    v_fmac_f32 v121, v57, v169
    v_fmac_f32 v122, v58, v169
    v_fmac_f32 v123, v59, v169
    v_cvt_pk_bf16_f32 v112, v112, v113
    v_cvt_pk_bf16_f32 v113, v114, v115
    v_cvt_pk_bf16_f32 v114, v116, v117
    v_cvt_pk_bf16_f32 v115, v118, v119
    v_cvt_pk_bf16_f32 v116, v120, v121
    v_cvt_pk_bf16_f32 v117, v122, v123
    s_add_u32 s58, s55, 81920
    buffer_store_dwordx4 v[112:115], v16, s[84:87], s58 offen sc0 sc1
    s_mov_b64 exec, s[94:95]
    buffer_store_dwordx2 v[116:117], v17, s[84:87], s58 offen sc0 sc1
    s_mov_b64 exec, -1
    v_mul_f32 v128, v128, v170
    v_mul_f32 v129, v129, v170
    v_mul_f32 v130, v130, v170
    v_mul_f32 v131, v131, v170
    v_mul_f32 v132, v132, v170
    v_mul_f32 v133, v133, v170
    v_mul_f32 v134, v134, v170
    v_mul_f32 v135, v135, v170
    v_mul_f32 v136, v136, v170
    v_mul_f32 v137, v137, v170
    v_mul_f32 v138, v138, v170
    v_mul_f32 v139, v139, v170
    v_fmac_f32 v128, v64, v171
    v_fmac_f32 v129, v65, v171
    v_fmac_f32 v130, v66, v171
    v_fmac_f32 v131, v67, v171
    v_fmac_f32 v132, v68, v171
    v_fmac_f32 v133, v69, v171
    v_fmac_f32 v134, v70, v171
    v_fmac_f32 v135, v71, v171
    v_fmac_f32 v136, v72, v171
    v_fmac_f32 v137, v73, v171
    v_fmac_f32 v138, v74, v171
    v_fmac_f32 v139, v75, v171
    v_cvt_pk_bf16_f32 v128, v128, v129
    v_cvt_pk_bf16_f32 v129, v130, v131
    v_cvt_pk_bf16_f32 v130, v132, v133
    v_cvt_pk_bf16_f32 v131, v134, v135
    v_cvt_pk_bf16_f32 v132, v136, v137
    v_cvt_pk_bf16_f32 v133, v138, v139
    s_add_u32 s58, s55, 122880
    buffer_store_dwordx4 v[128:131], v16, s[84:87], s58 offen sc0 sc1
    s_mov_b64 exec, s[94:95]
    buffer_store_dwordx2 v[132:133], v17, s[84:87], s58 offen sc0 sc1
    s_mov_b64 exec, -1
recurrent_scan__mha_block__glu_gated_geglu__prompt_kernel_at_done:
    s_waitcnt vmcnt(0)
    s_lshl_b32 s38, s89, 2
    s_lshl_b32 s39, s90, 1
    s_add_u32 s38, s38, s39
    s_add_u32 s38, s38, s91
    s_lshl_b32 s38, s38, 5
    s_add_u32 s38, s38, s88
    s_add_u32 s52, s44, 0x187a000
    s_addc_u32 s53, s45, 0
    s_mov_b32 s54, 0x20000
    s_mov_b32 s55, 0x20000
    s_lshl_b32 s38, s38, 7
    v_mov_b32 v5, s38
    v_mov_b32 v6, s3
    s_mov_b64 exec, 1
    buffer_store_dword v6, v5, s[52:55], 0 offen sc0 sc1
    s_mov_b64 exec, -1
    s_endpgm
recurrent_scan__mha_block__glu_gated_geglu__prompt_kernel_G:
    s_and_b32 s38, s2, 7
    s_lshr_b32 s39, s2, 3
    s_and_b32 s76, s38, 1
    s_lshl_b32 s76, s76, 2
    s_and_b32 s40, s39, 3
    s_add_u32 s76, s76, s40
    s_lshr_b32 s77, s38, 1
    s_mul_i32 s77, s77, 7
    s_lshr_b32 s40, s39, 2
    s_add_u32 s77, s77, s40
    s_cmp_ge_u32 s40, 7
    s_cselect_b32 s77, 27, s77
    s_load_dwordx4 s[80:83], s[0:1], 32
    s_load_dwordx2 s[84:85], s[0:1], 48
    s_load_dwordx2 s[86:87], s[0:1], 16
    s_load_dwordx2 s[88:89], s[0:1], 56
    s_cmp_ge_u32 s32, 15
    s_cbranch_scc1 recurrent_scan__mha_block__glu_gated_geglu__prompt_kernel_G_helper
    s_setprio 2
    v_and_b32 v2, 31, v1
    v_lshrrev_b32 v3, 5, v1
    v_bfe_u32 v4, v2, 1, 3
    s_lshl_b32 s38, s29, 13
    s_lshl_b32 s39, s30, 12
    s_add_u32 s38, s38, s39
    v_add_u32 v5, 0, v3
    v_xor_b32 v5, v5, v4
    v_lshlrev_b32 v5, 4, v5
    v_lshl_add_u32 v8, v2, 7, v5
    v_add_u32 v8, s38, v8
    v_xor_b32 v12, 0x1000, v8
    v_add_u32 v5, 2, v3
    v_xor_b32 v5, v5, v4
    v_lshlrev_b32 v5, 4, v5
    v_lshl_add_u32 v9, v2, 7, v5
    v_add_u32 v9, s38, v9
    v_xor_b32 v13, 0x1000, v9
    v_add_u32 v5, 4, v3
    v_xor_b32 v5, v5, v4
    v_lshlrev_b32 v5, 4, v5
    v_lshl_add_u32 v10, v2, 7, v5
    v_add_u32 v10, s38, v10
    v_xor_b32 v14, 0x1000, v10
    v_add_u32 v5, 6, v3
    v_xor_b32 v5, v5, v4
    v_lshlrev_b32 v5, 4, v5
    v_lshl_add_u32 v11, v2, 7, v5
    v_add_u32 v11, s38, v11
    v_xor_b32 v15, 0x1000, v11
    v_and_b32 v4, 15, v1
    v_lshrrev_b32 v3, 5, v1
    v_lshrrev_b32 v5, 2, v4
    v_lshl_add_u32 v5, v3, 3, v5
    v_lshlrev_b32 v5, 7, v5
    v_and_b32 v6, 3, v4
    v_lshl_add_u32 v5, v6, 3, v5
    v_bfe_u32 v6, v1, 4, 1
    v_lshl_add_u32 v5, v6, 5, v5
    v_bfe_u32 v6, v4, 3, 1
    v_lshl_add_u32 v5, v6, 6, v5
    s_lshl_b32 s38, s30, 13
    s_add_u32 s38, s38, 16384
    s_lshl_b32 s39, s29, 6
    v_xor_b32 v16, s39, v5
    v_xor_b32 v17, 64, v16
    v_add_u32 v16, s38, v16
    v_add_u32 v17, s38, v17
    v_mov_b32 v64, 0
    v_mov_b32 v65, 0
    v_mov_b32 v66, 0
    v_mov_b32 v67, 0
    v_mov_b32 v68, 0
    v_mov_b32 v69, 0
    v_mov_b32 v70, 0
    v_mov_b32 v71, 0
    v_mov_b32 v72, 0
    v_mov_b32 v73, 0
    v_mov_b32 v74, 0
    v_mov_b32 v75, 0
    v_mov_b32 v76, 0
    v_mov_b32 v77, 0
    v_mov_b32 v78, 0
    v_mov_b32 v79, 0
    v_mov_b32 v80, 0
    v_mov_b32 v81, 0
    v_mov_b32 v82, 0
    v_mov_b32 v83, 0
    v_mov_b32 v84, 0
    v_mov_b32 v85, 0
    v_mov_b32 v86, 0
    v_mov_b32 v87, 0
    v_mov_b32 v88, 0
    v_mov_b32 v89, 0
    v_mov_b32 v90, 0
    v_mov_b32 v91, 0
    v_mov_b32 v92, 0
    v_mov_b32 v93, 0
    v_mov_b32 v94, 0
    v_mov_b32 v95, 0
    v_mov_b32 v96, 0
    v_mov_b32 v97, 0
    v_mov_b32 v98, 0
    v_mov_b32 v99, 0
    v_mov_b32 v100, 0
    v_mov_b32 v101, 0
    v_mov_b32 v102, 0
    v_mov_b32 v103, 0
    v_mov_b32 v104, 0
    v_mov_b32 v105, 0
    v_mov_b32 v106, 0
    v_mov_b32 v107, 0
    v_mov_b32 v108, 0
    v_mov_b32 v109, 0
    v_mov_b32 v110, 0
    v_mov_b32 v111, 0
    v_mov_b32 v112, 0
    v_mov_b32 v113, 0
    v_mov_b32 v114, 0
    v_mov_b32 v115, 0
    v_mov_b32 v116, 0
    v_mov_b32 v117, 0
    v_mov_b32 v118, 0
    v_mov_b32 v119, 0
    v_mov_b32 v120, 0
    v_mov_b32 v121, 0
    v_mov_b32 v122, 0
    v_mov_b32 v123, 0
    v_mov_b32 v124, 0
    v_mov_b32 v125, 0
    v_mov_b32 v126, 0
    v_mov_b32 v127, 0
    s_waitcnt vmcnt(0)
    v_lshlrev_b32 v144, 16, v128
    v_and_b32 v145, 0xffff0000, v128
    v_lshlrev_b32 v146, 16, v129
    v_and_b32 v147, 0xffff0000, v129
    v_lshlrev_b32 v148, 16, v130
    v_and_b32 v149, 0xffff0000, v130
    v_lshlrev_b32 v150, 16, v131
    v_and_b32 v151, 0xffff0000, v131
    v_lshlrev_b32 v152, 16, v132
    v_and_b32 v153, 0xffff0000, v132
    v_lshlrev_b32 v154, 16, v133
    v_and_b32 v155, 0xffff0000, v133
    v_lshlrev_b32 v156, 16, v134
    v_and_b32 v157, 0xffff0000, v134
    v_lshlrev_b32 v158, 16, v135
    v_and_b32 v159, 0xffff0000, v135
    v_add_f32 v160, v144, v145
    v_mul_f32 v161, v144, v144
    v_fmac_f32 v161, v145, v145
    v_add_f32 v160, v160, v146
    v_fmac_f32 v161, v146, v146
    v_add_f32 v160, v160, v147
    v_fmac_f32 v161, v147, v147
    v_add_f32 v160, v160, v148
    v_fmac_f32 v161, v148, v148
    v_add_f32 v160, v160, v149
    v_fmac_f32 v161, v149, v149
    v_add_f32 v160, v160, v150
    v_fmac_f32 v161, v150, v150
    v_add_f32 v160, v160, v151
    v_fmac_f32 v161, v151, v151
    v_add_f32 v160, v160, v152
    v_fmac_f32 v161, v152, v152
    v_add_f32 v160, v160, v153
    v_fmac_f32 v161, v153, v153
    v_add_f32 v160, v160, v154
    v_fmac_f32 v161, v154, v154
    v_add_f32 v160, v160, v155
    v_fmac_f32 v161, v155, v155
    v_add_f32 v160, v160, v156
    v_fmac_f32 v161, v156, v156
    v_add_f32 v160, v160, v157
    v_fmac_f32 v161, v157, v157
    v_add_f32 v160, v160, v158
    v_fmac_f32 v161, v158, v158
    v_add_f32 v160, v160, v159
    v_fmac_f32 v161, v159, v159
    v_lshlrev_b32 v164, 16, v136
    v_and_b32 v165, 0xffff0000, v136
    v_add_f32_dpp v160, v160, v160 row_ror:8 row_mask:0xf bank_mask:0xf
    v_add_f32_dpp v161, v161, v161 row_ror:8 row_mask:0xf bank_mask:0xf
    v_lshlrev_b32 v162, 16, v140
    v_and_b32 v163, 0xffff0000, v140
    v_add_f32 v164, v164, v162
    v_add_f32_dpp v160, v160, v160 row_ror:4 row_mask:0xf bank_mask:0xf
    v_add_f32_dpp v161, v161, v161 row_ror:4 row_mask:0xf bank_mask:0xf
    v_add_f32 v165, v165, v163
    v_lshlrev_b32 v166, 16, v137
    v_and_b32 v167, 0xffff0000, v137
    v_add_f32_dpp v160, v160, v160 row_ror:2 row_mask:0xf bank_mask:0xf
    v_add_f32_dpp v161, v161, v161 row_ror:2 row_mask:0xf bank_mask:0xf
    v_lshlrev_b32 v162, 16, v141
    v_and_b32 v163, 0xffff0000, v141
    v_add_f32 v166, v166, v162
    v_add_f32_dpp v160, v160, v160 row_ror:1 row_mask:0xf bank_mask:0xf
    v_add_f32_dpp v161, v161, v161 row_ror:1 row_mask:0xf bank_mask:0xf
    v_add_f32 v167, v167, v163
    v_lshlrev_b32 v168, 16, v138
    v_and_b32 v169, 0xffff0000, v138
    v_lshlrev_b32 v162, 16, v142
    v_and_b32 v163, 0xffff0000, v142
    v_add_f32 v168, v168, v162
    v_add_f32 v169, v169, v163
    v_lshlrev_b32 v170, 16, v139
    v_and_b32 v171, 0xffff0000, v139
    v_lshlrev_b32 v162, 16, v143
    v_and_b32 v163, 0xffff0000, v143
    v_add_f32 v170, v170, v162
    v_add_f32 v171, v171, v163
    v_mov_b32 v162, v160
    v_mov_b32 v163, v160
    s_nop 1
    v_permlane16_swap_b32 v162, v163
    s_nop 1
    v_add_f32 v160, v162, v163
    v_mov_b32 v162, v161
    v_mov_b32 v163, v161
    s_nop 1
    v_permlane16_swap_b32 v162, v163
    s_nop 1
    v_add_f32 v161, v162, v163
    v_mov_b32 v162, v160
    v_mov_b32 v163, v160
    s_nop 1
    v_permlane32_swap_b32 v162, v163
    s_nop 1
    v_add_f32 v160, v162, v163
    v_mov_b32 v162, v161
    v_mov_b32 v163, v161
    s_nop 1
    v_permlane32_swap_b32 v162, v163
    s_nop 1
    v_add_f32 v161, v162, v163
    v_mul_f32 v160, 0x3acccccd, v160
    v_mul_f32 v161, 0x3acccccd, v161
    v_fma_f32 v161, -v160, v160, v161
    v_max_f32 v161, 0, v161
    v_add_f32 v161, 0x3727c5ac, v161
    v_rsq_f32 v162, v161
    s_nop 0
    v_mul_f32 v163, v160, v162
    v_sub_f32 v163, 0, v163
    v_fma_f32 v144, v144, v162, v163
    v_fma_f32 v145, v145, v162, v163
    v_fma_f32 v146, v146, v162, v163
    v_fma_f32 v147, v147, v162, v163
    v_fma_f32 v148, v148, v162, v163
    v_fma_f32 v149, v149, v162, v163
    v_fma_f32 v150, v150, v162, v163
    v_fma_f32 v151, v151, v162, v163
    v_fma_f32 v152, v152, v162, v163
    v_fma_f32 v153, v153, v162, v163
    v_fma_f32 v154, v154, v162, v163
    v_fma_f32 v155, v155, v162, v163
    v_fma_f32 v156, v156, v162, v163
    v_fma_f32 v157, v157, v162, v163
    v_fma_f32 v158, v158, v162, v163
    v_fma_f32 v159, v159, v162, v163
    v_cvt_pk_bf16_f32 v128, v144, v145
    v_cvt_pk_bf16_f32 v129, v146, v147
    v_cvt_pk_bf16_f32 v130, v148, v149
    v_cvt_pk_bf16_f32 v131, v150, v151
    v_cvt_pk_bf16_f32 v132, v152, v153
    v_cvt_pk_bf16_f32 v133, v154, v155
    v_cvt_pk_bf16_f32 v134, v156, v157
    v_cvt_pk_bf16_f32 v135, v158, v159
    s_add_u32 s52, s44, 0x1850000
    s_addc_u32 s53, s45, 0
    s_mov_b32 s54, 0x4000
    s_mov_b32 s55, 0x20000
    s_mul_i32 s38, s48, 1296
    s_add_u32 s38, s38, 147456
    v_lshlrev_b32 v5, 4, v1
    v_add_u32 v5, s38, v5
    ds_write_b128 v5, v[128:131]
    s_mov_b64 exec, 0xffff
    ds_write_b128 v5, v[132:135] offset:1024
    s_mov_b64 exec, 1
    s_lshl_b32 s38, s51, 3
    v_mov_b32 v6, 0
    buffer_store_dwordx2 v[162:163], v6, s[52:55], s38 offen sc0 sc1
    s_mov_b64 exec, -1
    v_lshrrev_b32 v5, 4, v1
    s_lshl_b32 s38, s48, 2
    v_add_u32 v5, s38, v5
    v_lshlrev_b32 v5, 9, v5
    v_and_b32 v6, 15, v1
    v_lshl_add_u32 v5, v6, 5, v5
    v_add_u32 v5, 131072, v5
    ds_write_b128 v5, v[164:167]
    ds_write_b128 v5, v[168:171] offset:16
    s_waitcnt lgkmcnt(0)
    s_barrier
    s_mov_b32 s16, s44
    s_mov_b32 s17, s45
    s_mov_b32 s18, 0x280000
    s_mov_b32 s19, 0x20000
    s_add_u32 s20, s44, 0x280000
    s_addc_u32 s21, s45, 0
    s_mov_b32 s22, 0x500000
    s_mov_b32 s23, 0x20000
    s_cmp_lt_u32 s32, 5
    s_cbranch_scc1 recurrent_scan__mha_block__glu_gated_geglu__prompt_kernel_isq
    s_mov_b32 s16, s20
    s_mov_b32 s17, s21
    s_mov_b32 s18, s22
    s_mov_b32 s19, s23
recurrent_scan__mha_block__glu_gated_geglu__prompt_kernel_isq:
    v_mov_b32 v48, 0
    v_mov_b32 v49, 0
    v_mov_b32 v50, 0
    v_mov_b32 v51, 0
    v_mov_b32 v52, 0
    v_mov_b32 v53, 0
    v_mov_b32 v54, 0
    v_mov_b32 v55, 0
    s_mov_b32 s41, 1.0
    s_mov_b32 s46, 2560
    s_cmp_ge_u32 s32, 10
    s_cbranch_scc1 recurrent_scan__mha_block__glu_gated_geglu__prompt_kernel_vpath
    ds_read_b128 v[128:131], v8
    ds_read_b128 v[132:135], v12
    ds_read_b64_tr_b16 v[136:137], v16 offset:0
    ds_read_b64_tr_b16 v[138:139], v16 offset:512
    ds_read_b64_tr_b16 v[140:141], v17 offset:0
    ds_read_b64_tr_b16 v[142:143], v17 offset:512
    ds_read_b128 v[144:147], v9
    ds_read_b128 v[148:151], v13
    ds_read_b64_tr_b16 v[152:153], v16 offset:2048
    ds_read_b64_tr_b16 v[154:155], v16 offset:2560
    ds_read_b64_tr_b16 v[156:157], v17 offset:2048
    ds_read_b64_tr_b16 v[158:159], v17 offset:2560
    s_mov_b32 s49, 0
    s_mov_b32 s50, 0
recurrent_scan__mha_block__glu_gated_geglu__prompt_kernel_loopT:
    s_waitcnt lgkmcnt(6)
    v_mfma_f32_32x32x16_bf16 v[64:79], v[136:139], v[128:131], v[64:79]
    ds_read_b128 v[160:163], v10
    ds_read_b128 v[164:167], v14
    v_mfma_f32_32x32x16_bf16 v[80:95], v[140:143], v[128:131], v[80:95]
    ds_read_b64_tr_b16 v[168:169], v16 offset:4096
    ds_read_b64_tr_b16 v[170:171], v16 offset:4608
    v_mfma_f32_32x32x16_bf16 v[96:111], v[136:139], v[132:135], v[96:111]
    ds_read_b64_tr_b16 v[172:173], v17 offset:4096
    ds_read_b64_tr_b16 v[174:175], v17 offset:4608
    v_mfma_f32_32x32x16_bf16 v[112:127], v[140:143], v[132:135], v[112:127]
    s_waitcnt lgkmcnt(6)
    v_mfma_f32_32x32x16_bf16 v[64:79], v[152:155], v[144:147], v[64:79]
    ds_read_b128 v[176:179], v11
    ds_read_b128 v[180:183], v15
    v_mfma_f32_32x32x16_bf16 v[80:95], v[156:159], v[144:147], v[80:95]
    ds_read_b64_tr_b16 v[184:185], v16 offset:6144
    ds_read_b64_tr_b16 v[186:187], v16 offset:6656
    v_mfma_f32_32x32x16_bf16 v[96:111], v[152:155], v[148:151], v[96:111]
    ds_read_b64_tr_b16 v[188:189], v17 offset:6144
    ds_read_b64_tr_b16 v[190:191], v17 offset:6656
    v_mfma_f32_32x32x16_bf16 v[112:127], v[156:159], v[148:151], v[112:127]
    s_barrier
    s_add_u32 s50, s50, 1
    s_cmp_eq_u32 s50, 5
    s_cselect_b32 s50, 0, s50
    s_mov_b32 s37, 32768
    s_cselect_b32 s37, 0xfffe0000, s37
    v_add_u32 v8, s37, v8
    v_add_u32 v9, s37, v9
    v_add_u32 v10, s37, v10
    v_add_u32 v11, s37, v11
    v_add_u32 v12, s37, v12
    v_add_u32 v13, s37, v13
    s_waitcnt lgkmcnt(6)
    v_mfma_f32_32x32x16_bf16 v[64:79], v[168:171], v[160:163], v[64:79]
    v_add_u32 v14, s37, v14
    v_add_u32 v15, s37, v15
    v_add_u32 v16, s37, v16
    v_add_u32 v17, s37, v17
    v_mfma_f32_32x32x16_bf16 v[80:95], v[172:175], v[160:163], v[80:95]
    ds_read_b128 v[128:131], v8
    ds_read_b128 v[132:135], v12
    v_mfma_f32_32x32x16_bf16 v[96:111], v[168:171], v[164:167], v[96:111]
    ds_read_b64_tr_b16 v[136:137], v16 offset:0
    ds_read_b64_tr_b16 v[138:139], v16 offset:512
    v_mfma_f32_32x32x16_bf16 v[112:127], v[172:175], v[164:167], v[112:127]
    ds_read_b64_tr_b16 v[140:141], v17 offset:0
    ds_read_b64_tr_b16 v[142:143], v17 offset:512
    s_cmp_eq_u32 s49, 1
    s_cbranch_scc0 recurrent_scan__mha_block__glu_gated_geglu__prompt_kernel_nvT
    s_waitcnt vmcnt(0)
recurrent_scan__mha_block__glu_gated_geglu__prompt_kernel_nvT:
    s_cmp_eq_u32 s49, 7
    s_cbranch_scc0 recurrent_scan__mha_block__glu_gated_geglu__prompt_kernel_noT
    s_mov_b32 s41, 1.0
    s_mov_b32 s46, 2560
    s_cmp_lt_u32 s32, 5
    s_cselect_b32 s41, 0x3ea52b5c, s41
    s_cselect_b32 s46, 1280, s46
    s_cselect_b32 s40, 0, 5
    s_lshl_b32 s47, s46, 6
    s_sub_u32 s40, s32, s40
    v_and_b32 v5, 31, v1
    v_lshlrev_b32 v41, 3, v5
    v_lshrrev_b32 v42, 5, v1
    s_xor_b32 s38, s29, 0
    s_lshl_b32 s39, s30, 1
    s_add_u32 s38, s38, s39
    s_lshl_b32 s38, s38, 3
    s_lshl_b32 s39, s40, 5
    s_add_u32 s38, s38, s39
    v_add_u32 v2, s38, v42
    v_mul_u32_u24 v3, 205, v2
    v_lshrrev_b32 v3, 10, v3
    v_mul_u32_u24 v4, 5, v3
    v_sub_u32 v4, v2, v4
    v_mul_lo_u32 v3, v3, s47
    v_lshl_add_u32 v4, v4, 8, v41
    v_add_u32 v48, v4, v3
    v_add_u32 v2, s38, v42
    v_add_u32 v2, 2, v2
    v_mul_u32_u24 v3, 205, v2
    v_lshrrev_b32 v3, 10, v3
    v_mul_u32_u24 v4, 5, v3
    v_sub_u32 v4, v2, v4
    v_mul_lo_u32 v3, v3, s47
    v_lshl_add_u32 v4, v4, 8, v41
    v_add_u32 v49, v4, v3
    v_add_u32 v2, s38, v42
    v_add_u32 v2, 4, v2
    v_mul_u32_u24 v3, 205, v2
    v_lshrrev_b32 v3, 10, v3
    v_mul_u32_u24 v4, 5, v3
    v_sub_u32 v4, v2, v4
    v_mul_lo_u32 v3, v3, s47
    v_lshl_add_u32 v4, v4, 8, v41
    v_add_u32 v50, v4, v3
    v_add_u32 v2, s38, v42
    v_add_u32 v2, 6, v2
    v_mul_u32_u24 v3, 205, v2
    v_lshrrev_b32 v3, 10, v3
    v_mul_u32_u24 v4, 5, v3
    v_sub_u32 v4, v2, v4
    v_mul_lo_u32 v3, v3, s47
    v_lshl_add_u32 v4, v4, 8, v41
    v_add_u32 v51, v4, v3
    s_xor_b32 s38, s29, 1
    s_lshl_b32 s39, s30, 1
    s_add_u32 s38, s38, s39
    s_lshl_b32 s38, s38, 3
    s_lshl_b32 s39, s40, 5
    s_add_u32 s38, s38, s39
    v_add_u32 v2, s38, v42
    v_mul_u32_u24 v3, 205, v2
    v_lshrrev_b32 v3, 10, v3
    v_mul_u32_u24 v4, 5, v3
    v_sub_u32 v4, v2, v4
    v_mul_lo_u32 v3, v3, s47
    v_lshl_add_u32 v4, v4, 8, v41
    v_add_u32 v52, v4, v3
    v_add_u32 v2, s38, v42
    v_add_u32 v2, 2, v2
    v_mul_u32_u24 v3, 205, v2
    v_lshrrev_b32 v3, 10, v3
    v_mul_u32_u24 v4, 5, v3
    v_sub_u32 v4, v2, v4
    v_mul_lo_u32 v3, v3, s47
    v_lshl_add_u32 v4, v4, 8, v41
    v_add_u32 v53, v4, v3
    v_add_u32 v2, s38, v42
    v_add_u32 v2, 4, v2
    v_mul_u32_u24 v3, 205, v2
    v_lshrrev_b32 v3, 10, v3
    v_mul_u32_u24 v4, 5, v3
    v_sub_u32 v4, v2, v4
    v_mul_lo_u32 v3, v3, s47
    v_lshl_add_u32 v4, v4, 8, v41
    v_add_u32 v54, v4, v3
    v_add_u32 v2, s38, v42
    v_add_u32 v2, 6, v2
    v_mul_u32_u24 v3, 205, v2
    v_lshrrev_b32 v3, 10, v3
    v_mul_u32_u24 v4, 5, v3
    v_sub_u32 v4, v2, v4
    v_mul_lo_u32 v3, v3, s47
    v_lshl_add_u32 v4, v4, 8, v41
    v_add_u32 v55, v4, v3
recurrent_scan__mha_block__glu_gated_geglu__prompt_kernel_noT:
    s_waitcnt lgkmcnt(6)
    v_mfma_f32_32x32x16_bf16 v[64:79], v[184:187], v[176:179], v[64:79]
    ds_read_b128 v[144:147], v9
    ds_read_b128 v[148:151], v13
    v_mfma_f32_32x32x16_bf16 v[80:95], v[188:191], v[176:179], v[80:95]
    ds_read_b64_tr_b16 v[152:153], v16 offset:2048
    ds_read_b64_tr_b16 v[154:155], v16 offset:2560
    v_mfma_f32_32x32x16_bf16 v[96:111], v[184:187], v[180:183], v[96:111]
    ds_read_b64_tr_b16 v[156:157], v17 offset:2048
    ds_read_b64_tr_b16 v[158:159], v17 offset:2560
    v_mfma_f32_32x32x16_bf16 v[112:127], v[188:191], v[180:183], v[112:127]
    s_add_u32 s49, s49, 1
    s_cmp_lt_u32 s49, 9
    s_cbranch_scc1 recurrent_scan__mha_block__glu_gated_geglu__prompt_kernel_loopT
    s_waitcnt lgkmcnt(6)
    v_mfma_f32_32x32x16_bf16 v[64:79], v[136:139], v[128:131], v[64:79]
    ds_read_b128 v[160:163], v10
    ds_read_b128 v[164:167], v14
    v_mfma_f32_32x32x16_bf16 v[80:95], v[140:143], v[128:131], v[80:95]
    ds_read_b64_tr_b16 v[168:169], v16 offset:4096
    ds_read_b64_tr_b16 v[170:171], v16 offset:4608
    v_mfma_f32_32x32x16_bf16 v[96:111], v[136:139], v[132:135], v[96:111]
    ds_read_b64_tr_b16 v[172:173], v17 offset:4096
    ds_read_b64_tr_b16 v[174:175], v17 offset:4608
    v_mfma_f32_32x32x16_bf16 v[112:127], v[140:143], v[132:135], v[112:127]
    s_waitcnt lgkmcnt(6)
    v_mfma_f32_32x32x16_bf16 v[64:79], v[152:155], v[144:147], v[64:79]
    ds_read_b128 v[176:179], v11
    ds_read_b128 v[180:183], v15
    v_mfma_f32_32x32x16_bf16 v[80:95], v[156:159], v[144:147], v[80:95]
    ds_read_b64_tr_b16 v[184:185], v16 offset:6144
    ds_read_b64_tr_b16 v[186:187], v16 offset:6656
    v_mfma_f32_32x32x16_bf16 v[96:111], v[152:155], v[148:151], v[96:111]
    ds_read_b64_tr_b16 v[188:189], v17 offset:6144
    ds_read_b64_tr_b16 v[190:191], v17 offset:6656
    v_mfma_f32_32x32x16_bf16 v[112:127], v[156:159], v[148:151], v[112:127]
    s_waitcnt lgkmcnt(6)
    v_mfma_f32_32x32x16_bf16 v[64:79], v[168:171], v[160:163], v[64:79]
    v_mfma_f32_32x32x16_bf16 v[80:95], v[172:175], v[160:163], v[80:95]
    v_mfma_f32_32x32x16_bf16 v[96:111], v[168:171], v[164:167], v[96:111]
    v_mfma_f32_32x32x16_bf16 v[112:127], v[172:175], v[164:167], v[112:127]
    s_waitcnt lgkmcnt(0)
    v_mfma_f32_32x32x16_bf16 v[64:79], v[184:187], v[176:179], v[64:79]
    v_mfma_f32_32x32x16_bf16 v[80:95], v[188:191], v[176:179], v[80:95]
    v_mfma_f32_32x32x16_bf16 v[96:111], v[184:187], v[180:183], v[96:111]
    v_mfma_f32_32x32x16_bf16 v[112:127], v[188:191], v[180:183], v[112:127]
    s_barrier
    v_and_b32 v2, 31, v1
    s_xor_b32 s38, s30, 0
    s_lshl_b32 s39, s29, 1
    s_add_u32 s38, s38, s39
    s_lshl_b32 s38, s38, 7
    s_add_u32 s38, s38, 32768
    v_lshl_add_u32 v3, v2, 2, s38
    ds_read_b32 v128, v3
    ds_read_b32 v129, v3 offset:512
    s_xor_b32 s38, s30, 1
    s_lshl_b32 s39, s29, 1
    s_add_u32 s38, s38, s39
    s_lshl_b32 s38, s38, 7
    s_add_u32 s38, s38, 32768
    v_lshl_add_u32 v3, v2, 2, s38
    ds_read_b32 v130, v3
    ds_read_b32 v131, v3 offset:512
    v_lshrrev_b32 v4, 5, v1
    s_xor_b32 s38, s29, 0
    s_lshl_b32 s39, s30, 1
    s_add_u32 s38, s38, s39
    s_lshl_b32 s38, s38, 7
    s_add_u32 s38, s38, 32768
    v_lshl_add_u32 v3, v4, 4, s38
    ds_read_b128 v[132:135], v3 offset:1024
    ds_read_b128 v[136:139], v3 offset:1056
    ds_read_b128 v[140:143], v3 offset:1088
    ds_read_b128 v[144:147], v3 offset:1120
    s_xor_b32 s38, s29, 1
    s_lshl_b32 s39, s30, 1
    s_add_u32 s38, s38, s39
    s_lshl_b32 s38, s38, 7
    s_add_u32 s38, s38, 32768
    v_lshl_add_u32 v3, v4, 4, s38
    ds_read_b128 v[148:151], v3 offset:1024
    ds_read_b128 v[152:155], v3 offset:1056
    ds_read_b128 v[156:159], v3 offset:1088
    ds_read_b128 v[160:163], v3 offset:1120
    s_waitcnt lgkmcnt(0)
    s_barrier
    v_mov_b32 v45, 0
    global_load_dword v44, v45, s[42:43] sc0 sc1
    v_and_b32 v46, 31, v1
    s_lshl_b32 s38, s76, 5
    v_add_u32 v46, s38, v46
    v_lshlrev_b32 v46, 7, v46
    s_add_u32 s52, s44, 0x1848000
    s_addc_u32 s53, s45, 0
    s_mov_b32 s54, 0x8000
    s_mov_b32 s55, 0x20000
    buffer_load_dword v47, v46, s[52:55], 0 offen sc0 sc1
    v_mul_f32 v128, s41, v128
    v_mul_f32 v129, s41, v129
    v_mul_f32 v130, s41, v130
    v_mul_f32 v131, s41, v131
    s_xor_b32 s38, s30, 0
    s_lshl_b32 s39, s29, 1
    s_add_u32 s38, s38, s39
    s_lshl_b32 s39, s31, 2
    s_add_u32 s38, s38, s39
    s_mul_i32 s38, s38, s46
    v_mul_f32 v64, v64, v128
    v_mul_f32 v65, v65, v128
    v_mul_f32 v66, v66, v128
    v_mul_f32 v67, v67, v128
    v_fmac_f32 v64, v129, v132
    v_fmac_f32 v65, v129, v133
    v_fmac_f32 v66, v129, v134
    v_fmac_f32 v67, v129, v135
    v_cvt_pk_bf16_f32 v64, v64, v65
    v_cvt_pk_bf16_f32 v65, v66, v67
    buffer_store_dwordx2 v[64:65], v48, s[16:19], s38 offen sc0 sc1
    v_mul_f32 v68, v68, v128
    v_mul_f32 v69, v69, v128
    v_mul_f32 v70, v70, v128
    v_mul_f32 v71, v71, v128
    v_fmac_f32 v68, v129, v136
    v_fmac_f32 v69, v129, v137
    v_fmac_f32 v70, v129, v138
    v_fmac_f32 v71, v129, v139
    v_cvt_pk_bf16_f32 v68, v68, v69
    v_cvt_pk_bf16_f32 v69, v70, v71
    buffer_store_dwordx2 v[68:69], v49, s[16:19], s38 offen sc0 sc1
    v_mul_f32 v72, v72, v128
    v_mul_f32 v73, v73, v128
    v_mul_f32 v74, v74, v128
    v_mul_f32 v75, v75, v128
    v_fmac_f32 v72, v129, v140
    v_fmac_f32 v73, v129, v141
    v_fmac_f32 v74, v129, v142
    v_fmac_f32 v75, v129, v143
    v_cvt_pk_bf16_f32 v72, v72, v73
    v_cvt_pk_bf16_f32 v73, v74, v75
    buffer_store_dwordx2 v[72:73], v50, s[16:19], s38 offen sc0 sc1
    v_mul_f32 v76, v76, v128
    v_mul_f32 v77, v77, v128
    v_mul_f32 v78, v78, v128
    v_mul_f32 v79, v79, v128
    v_fmac_f32 v76, v129, v144
    v_fmac_f32 v77, v129, v145
    v_fmac_f32 v78, v129, v146
    v_fmac_f32 v79, v129, v147
    v_cvt_pk_bf16_f32 v76, v76, v77
    v_cvt_pk_bf16_f32 v77, v78, v79
    buffer_store_dwordx2 v[76:77], v51, s[16:19], s38 offen sc0 sc1
    v_mul_f32 v80, v80, v128
    v_mul_f32 v81, v81, v128
    v_mul_f32 v82, v82, v128
    v_mul_f32 v83, v83, v128
    v_fmac_f32 v80, v129, v148
    v_fmac_f32 v81, v129, v149
    v_fmac_f32 v82, v129, v150
    v_fmac_f32 v83, v129, v151
    v_cvt_pk_bf16_f32 v80, v80, v81
    v_cvt_pk_bf16_f32 v81, v82, v83
    buffer_store_dwordx2 v[80:81], v52, s[16:19], s38 offen sc0 sc1
    v_mul_f32 v84, v84, v128
    v_mul_f32 v85, v85, v128
    v_mul_f32 v86, v86, v128
    v_mul_f32 v87, v87, v128
    v_fmac_f32 v84, v129, v152
    v_fmac_f32 v85, v129, v153
    v_fmac_f32 v86, v129, v154
    v_fmac_f32 v87, v129, v155
    v_cvt_pk_bf16_f32 v84, v84, v85
    v_cvt_pk_bf16_f32 v85, v86, v87
    buffer_store_dwordx2 v[84:85], v53, s[16:19], s38 offen sc0 sc1
    v_mul_f32 v88, v88, v128
    v_mul_f32 v89, v89, v128
    v_mul_f32 v90, v90, v128
    v_mul_f32 v91, v91, v128
    v_fmac_f32 v88, v129, v156
    v_fmac_f32 v89, v129, v157
    v_fmac_f32 v90, v129, v158
    v_fmac_f32 v91, v129, v159
    v_cvt_pk_bf16_f32 v88, v88, v89
    v_cvt_pk_bf16_f32 v89, v90, v91
    buffer_store_dwordx2 v[88:89], v54, s[16:19], s38 offen sc0 sc1
    v_mul_f32 v92, v92, v128
    v_mul_f32 v93, v93, v128
    v_mul_f32 v94, v94, v128
    v_mul_f32 v95, v95, v128
    v_fmac_f32 v92, v129, v160
    v_fmac_f32 v93, v129, v161
    v_fmac_f32 v94, v129, v162
    v_fmac_f32 v95, v129, v163
    v_cvt_pk_bf16_f32 v92, v92, v93
    v_cvt_pk_bf16_f32 v93, v94, v95
    buffer_store_dwordx2 v[92:93], v55, s[16:19], s38 offen sc0 sc1
    s_xor_b32 s38, s30, 1
    s_lshl_b32 s39, s29, 1
    s_add_u32 s38, s38, s39
    s_lshl_b32 s39, s31, 2
    s_add_u32 s38, s38, s39
    s_mul_i32 s38, s38, s46
    v_mul_f32 v96, v96, v130
    v_mul_f32 v97, v97, v130
    v_mul_f32 v98, v98, v130
    v_mul_f32 v99, v99, v130
    v_fmac_f32 v96, v131, v132
    v_fmac_f32 v97, v131, v133
    v_fmac_f32 v98, v131, v134
    v_fmac_f32 v99, v131, v135
    v_cvt_pk_bf16_f32 v96, v96, v97
    v_cvt_pk_bf16_f32 v97, v98, v99
    buffer_store_dwordx2 v[96:97], v48, s[16:19], s38 offen sc0 sc1
    v_mul_f32 v100, v100, v130
    v_mul_f32 v101, v101, v130
    v_mul_f32 v102, v102, v130
    v_mul_f32 v103, v103, v130
    v_fmac_f32 v100, v131, v136
    v_fmac_f32 v101, v131, v137
    v_fmac_f32 v102, v131, v138
    v_fmac_f32 v103, v131, v139
    v_cvt_pk_bf16_f32 v100, v100, v101
    v_cvt_pk_bf16_f32 v101, v102, v103
    buffer_store_dwordx2 v[100:101], v49, s[16:19], s38 offen sc0 sc1
    v_mul_f32 v104, v104, v130
    v_mul_f32 v105, v105, v130
    v_mul_f32 v106, v106, v130
    v_mul_f32 v107, v107, v130
    v_fmac_f32 v104, v131, v140
    v_fmac_f32 v105, v131, v141
    v_fmac_f32 v106, v131, v142
    v_fmac_f32 v107, v131, v143
    v_cvt_pk_bf16_f32 v104, v104, v105
    v_cvt_pk_bf16_f32 v105, v106, v107
    buffer_store_dwordx2 v[104:105], v50, s[16:19], s38 offen sc0 sc1
    v_mul_f32 v108, v108, v130
    v_mul_f32 v109, v109, v130
    v_mul_f32 v110, v110, v130
    v_mul_f32 v111, v111, v130
    v_fmac_f32 v108, v131, v144
    v_fmac_f32 v109, v131, v145
    v_fmac_f32 v110, v131, v146
    v_fmac_f32 v111, v131, v147
    v_cvt_pk_bf16_f32 v108, v108, v109
    v_cvt_pk_bf16_f32 v109, v110, v111
    buffer_store_dwordx2 v[108:109], v51, s[16:19], s38 offen sc0 sc1
    v_mul_f32 v112, v112, v130
    v_mul_f32 v113, v113, v130
    v_mul_f32 v114, v114, v130
    v_mul_f32 v115, v115, v130
    v_fmac_f32 v112, v131, v148
    v_fmac_f32 v113, v131, v149
    v_fmac_f32 v114, v131, v150
    v_fmac_f32 v115, v131, v151
    v_cvt_pk_bf16_f32 v112, v112, v113
    v_cvt_pk_bf16_f32 v113, v114, v115
    buffer_store_dwordx2 v[112:113], v52, s[16:19], s38 offen sc0 sc1
    v_mul_f32 v116, v116, v130
    v_mul_f32 v117, v117, v130
    v_mul_f32 v118, v118, v130
    v_mul_f32 v119, v119, v130
    v_fmac_f32 v116, v131, v152
    v_fmac_f32 v117, v131, v153
    v_fmac_f32 v118, v131, v154
    v_fmac_f32 v119, v131, v155
    v_cvt_pk_bf16_f32 v116, v116, v117
    v_cvt_pk_bf16_f32 v117, v118, v119
    buffer_store_dwordx2 v[116:117], v53, s[16:19], s38 offen sc0 sc1
    v_mul_f32 v120, v120, v130
    v_mul_f32 v121, v121, v130
    v_mul_f32 v122, v122, v130
    v_mul_f32 v123, v123, v130
    v_fmac_f32 v120, v131, v156
    v_fmac_f32 v121, v131, v157
    v_fmac_f32 v122, v131, v158
    v_fmac_f32 v123, v131, v159
    v_cvt_pk_bf16_f32 v120, v120, v121
    v_cvt_pk_bf16_f32 v121, v122, v123
    buffer_store_dwordx2 v[120:121], v54, s[16:19], s38 offen sc0 sc1
    v_mul_f32 v124, v124, v130
    v_mul_f32 v125, v125, v130
    v_mul_f32 v126, v126, v130
    v_mul_f32 v127, v127, v130
    v_fmac_f32 v124, v131, v160
    v_fmac_f32 v125, v131, v161
    v_fmac_f32 v126, v131, v162
    v_fmac_f32 v127, v131, v163
    v_cvt_pk_bf16_f32 v124, v124, v125
    v_cvt_pk_bf16_f32 v125, v126, v127
    buffer_store_dwordx2 v[124:125], v55, s[16:19], s38 offen sc0 sc1
    s_branch recurrent_scan__mha_block__glu_gated_geglu__prompt_kernel_G_qdone
recurrent_scan__mha_block__glu_gated_geglu__prompt_kernel_vpath:
    ds_read_b128 v[128:131], v8
    ds_read_b128 v[132:135], v12
    ds_read_b64_tr_b16 v[136:137], v16 offset:0
    ds_read_b64_tr_b16 v[138:139], v16 offset:512
    ds_read_b64_tr_b16 v[140:141], v17 offset:0
    ds_read_b64_tr_b16 v[142:143], v17 offset:512
    ds_read_b128 v[144:147], v9
    ds_read_b128 v[148:151], v13
    ds_read_b64_tr_b16 v[152:153], v16 offset:2048
    ds_read_b64_tr_b16 v[154:155], v16 offset:2560
    ds_read_b64_tr_b16 v[156:157], v17 offset:2048
    ds_read_b64_tr_b16 v[158:159], v17 offset:2560
    s_mov_b32 s49, 0
    s_mov_b32 s50, 0
recurrent_scan__mha_block__glu_gated_geglu__prompt_kernel_loopN:
    s_waitcnt lgkmcnt(6)
    v_mfma_f32_32x32x16_bf16 v[64:79], v[128:131], v[136:139], v[64:79]
    ds_read_b128 v[160:163], v10
    ds_read_b128 v[164:167], v14
    v_mfma_f32_32x32x16_bf16 v[80:95], v[128:131], v[140:143], v[80:95]
    ds_read_b64_tr_b16 v[168:169], v16 offset:4096
    ds_read_b64_tr_b16 v[170:171], v16 offset:4608
    v_mfma_f32_32x32x16_bf16 v[96:111], v[132:135], v[136:139], v[96:111]
    ds_read_b64_tr_b16 v[172:173], v17 offset:4096
    ds_read_b64_tr_b16 v[174:175], v17 offset:4608
    v_mfma_f32_32x32x16_bf16 v[112:127], v[132:135], v[140:143], v[112:127]
    s_waitcnt lgkmcnt(6)
    v_mfma_f32_32x32x16_bf16 v[64:79], v[144:147], v[152:155], v[64:79]
    ds_read_b128 v[176:179], v11
    ds_read_b128 v[180:183], v15
    v_mfma_f32_32x32x16_bf16 v[80:95], v[144:147], v[156:159], v[80:95]
    ds_read_b64_tr_b16 v[184:185], v16 offset:6144
    ds_read_b64_tr_b16 v[186:187], v16 offset:6656
    v_mfma_f32_32x32x16_bf16 v[96:111], v[148:151], v[152:155], v[96:111]
    ds_read_b64_tr_b16 v[188:189], v17 offset:6144
    ds_read_b64_tr_b16 v[190:191], v17 offset:6656
    v_mfma_f32_32x32x16_bf16 v[112:127], v[148:151], v[156:159], v[112:127]
    s_barrier
    s_add_u32 s50, s50, 1
    s_cmp_eq_u32 s50, 5
    s_cselect_b32 s50, 0, s50
    s_mov_b32 s37, 32768
    s_cselect_b32 s37, 0xfffe0000, s37
    v_add_u32 v8, s37, v8
    v_add_u32 v9, s37, v9
    v_add_u32 v10, s37, v10
    v_add_u32 v11, s37, v11
    v_add_u32 v12, s37, v12
    v_add_u32 v13, s37, v13
    s_waitcnt lgkmcnt(6)
    v_mfma_f32_32x32x16_bf16 v[64:79], v[160:163], v[168:171], v[64:79]
    v_add_u32 v14, s37, v14
    v_add_u32 v15, s37, v15
    v_add_u32 v16, s37, v16
    v_add_u32 v17, s37, v17
    v_mfma_f32_32x32x16_bf16 v[80:95], v[160:163], v[172:175], v[80:95]
    ds_read_b128 v[128:131], v8
    ds_read_b128 v[132:135], v12
    v_mfma_f32_32x32x16_bf16 v[96:111], v[164:167], v[168:171], v[96:111]
    ds_read_b64_tr_b16 v[136:137], v16 offset:0
    ds_read_b64_tr_b16 v[138:139], v16 offset:512
    v_mfma_f32_32x32x16_bf16 v[112:127], v[164:167], v[172:175], v[112:127]
    ds_read_b64_tr_b16 v[140:141], v17 offset:0
    ds_read_b64_tr_b16 v[142:143], v17 offset:512
    s_cmp_eq_u32 s49, 1
    s_cbranch_scc0 recurrent_scan__mha_block__glu_gated_geglu__prompt_kernel_nvN
    s_waitcnt vmcnt(0)
recurrent_scan__mha_block__glu_gated_geglu__prompt_kernel_nvN:
    s_cmp_eq_u32 s49, 7
    s_cbranch_scc0 recurrent_scan__mha_block__glu_gated_geglu__prompt_kernel_noN
    s_xor_b32 s38, s29, 0
    s_lshl_b32 s39, s30, 1
    s_add_u32 s38, s38, s39
    v_and_b32 v2, 31, v1
    s_sub_u32 s39, s32, 10
    s_lshl_b32 s39, s39, 7
    s_lshl_b32 s38, s38, 5
    s_add_u32 s38, s38, s39
    v_add_u32 v2, s38, v2
    v_mul_u32_u24 v3, 3277, v2
    v_lshrrev_b32 v3, 16, v3
    v_mul_u32_u24 v4, 20, v3
    v_sub_u32 v4, v2, v4
    v_mul_u32_u24 v3, 163840, v3
    v_lshl_add_u32 v3, v4, 4, v3
    v_lshrrev_b32 v4, 5, v1
    v_mul_u32_u24 v4, 320, v4
    v_add_u32 v48, v3, v4
    s_xor_b32 s38, s29, 1
    s_lshl_b32 s39, s30, 1
    s_add_u32 s38, s38, s39
    v_and_b32 v2, 31, v1
    s_sub_u32 s39, s32, 10
    s_lshl_b32 s39, s39, 7
    s_lshl_b32 s38, s38, 5
    s_add_u32 s38, s38, s39
    v_add_u32 v2, s38, v2
    v_mul_u32_u24 v3, 3277, v2
    v_lshrrev_b32 v3, 16, v3
    v_mul_u32_u24 v4, 20, v3
    v_sub_u32 v4, v2, v4
    v_mul_u32_u24 v3, 163840, v3
    v_lshl_add_u32 v3, v4, 4, v3
    v_lshrrev_b32 v4, 5, v1
    v_mul_u32_u24 v4, 320, v4
    v_add_u32 v49, v3, v4
recurrent_scan__mha_block__glu_gated_geglu__prompt_kernel_noN:
    s_waitcnt lgkmcnt(6)
    v_mfma_f32_32x32x16_bf16 v[64:79], v[176:179], v[184:187], v[64:79]
    ds_read_b128 v[144:147], v9
    ds_read_b128 v[148:151], v13
    v_mfma_f32_32x32x16_bf16 v[80:95], v[176:179], v[188:191], v[80:95]
    ds_read_b64_tr_b16 v[152:153], v16 offset:2048
    ds_read_b64_tr_b16 v[154:155], v16 offset:2560
    v_mfma_f32_32x32x16_bf16 v[96:111], v[180:183], v[184:187], v[96:111]
    ds_read_b64_tr_b16 v[156:157], v17 offset:2048
    ds_read_b64_tr_b16 v[158:159], v17 offset:2560
    v_mfma_f32_32x32x16_bf16 v[112:127], v[180:183], v[188:191], v[112:127]
    s_add_u32 s49, s49, 1
    s_cmp_lt_u32 s49, 9
    s_cbranch_scc1 recurrent_scan__mha_block__glu_gated_geglu__prompt_kernel_loopN
    s_waitcnt lgkmcnt(6)
    v_mfma_f32_32x32x16_bf16 v[64:79], v[128:131], v[136:139], v[64:79]
    ds_read_b128 v[160:163], v10
    ds_read_b128 v[164:167], v14
    v_mfma_f32_32x32x16_bf16 v[80:95], v[128:131], v[140:143], v[80:95]
    ds_read_b64_tr_b16 v[168:169], v16 offset:4096
    ds_read_b64_tr_b16 v[170:171], v16 offset:4608
    v_mfma_f32_32x32x16_bf16 v[96:111], v[132:135], v[136:139], v[96:111]
    ds_read_b64_tr_b16 v[172:173], v17 offset:4096
    ds_read_b64_tr_b16 v[174:175], v17 offset:4608
    v_mfma_f32_32x32x16_bf16 v[112:127], v[132:135], v[140:143], v[112:127]
    s_waitcnt lgkmcnt(6)
    v_mfma_f32_32x32x16_bf16 v[64:79], v[144:147], v[152:155], v[64:79]
    ds_read_b128 v[176:179], v11
    ds_read_b128 v[180:183], v15
    v_mfma_f32_32x32x16_bf16 v[80:95], v[144:147], v[156:159], v[80:95]
    ds_read_b64_tr_b16 v[184:185], v16 offset:6144
    ds_read_b64_tr_b16 v[186:187], v16 offset:6656
    v_mfma_f32_32x32x16_bf16 v[96:111], v[148:151], v[152:155], v[96:111]
    ds_read_b64_tr_b16 v[188:189], v17 offset:6144
    ds_read_b64_tr_b16 v[190:191], v17 offset:6656
    v_mfma_f32_32x32x16_bf16 v[112:127], v[148:151], v[156:159], v[112:127]
    s_waitcnt lgkmcnt(6)
    v_mfma_f32_32x32x16_bf16 v[64:79], v[160:163], v[168:171], v[64:79]
    v_mfma_f32_32x32x16_bf16 v[80:95], v[160:163], v[172:175], v[80:95]
    v_mfma_f32_32x32x16_bf16 v[96:111], v[164:167], v[168:171], v[96:111]
    v_mfma_f32_32x32x16_bf16 v[112:127], v[164:167], v[172:175], v[112:127]
    s_waitcnt lgkmcnt(0)
    v_mfma_f32_32x32x16_bf16 v[64:79], v[176:179], v[184:187], v[64:79]
    v_mfma_f32_32x32x16_bf16 v[80:95], v[176:179], v[188:191], v[80:95]
    v_mfma_f32_32x32x16_bf16 v[96:111], v[180:183], v[184:187], v[96:111]
    v_mfma_f32_32x32x16_bf16 v[112:127], v[180:183], v[188:191], v[112:127]
    s_barrier
    v_and_b32 v2, 31, v1
    s_xor_b32 s38, s29, 0
    s_lshl_b32 s39, s30, 1
    s_add_u32 s38, s38, s39
    s_lshl_b32 s39, s38, 7
    s_add_u32 s39, s39, 32768
    v_lshl_add_u32 v3, v2, 2, s39
    ds_read_b32 v50, v3 offset:1024
    s_xor_b32 s38, s29, 1
    s_lshl_b32 s39, s30, 1
    s_add_u32 s38, s38, s39
    s_lshl_b32 s39, s38, 7
    s_add_u32 s39, s39, 32768
    v_lshl_add_u32 v3, v2, 2, s39
    ds_read_b32 v51, v3 offset:1024
    s_xor_b32 s38, s30, 0
    s_lshl_b32 s39, s29, 1
    s_add_u32 s38, s38, s39
    s_lshl_b32 s39, s38, 7
    s_add_u32 s39, s39, 32768
    v_lshrrev_b32 v4, 5, v1
    v_lshl_add_u32 v3, v4, 4, s39
    ds_read_b128 v[128:131], v3 offset:0
    ds_read_b128 v[144:147], v3 offset:512
    ds_read_b128 v[132:135], v3 offset:32
    ds_read_b128 v[148:151], v3 offset:544
    ds_read_b128 v[136:139], v3 offset:64
    ds_read_b128 v[152:155], v3 offset:576
    ds_read_b128 v[140:143], v3 offset:96
    ds_read_b128 v[156:159], v3 offset:608
    s_xor_b32 s38, s30, 1
    s_lshl_b32 s39, s29, 1
    s_add_u32 s38, s38, s39
    s_lshl_b32 s39, s38, 7
    s_add_u32 s39, s39, 32768
    v_lshrrev_b32 v4, 5, v1
    v_lshl_add_u32 v3, v4, 4, s39
    ds_read_b128 v[160:163], v3 offset:0
    ds_read_b128 v[176:179], v3 offset:512
    ds_read_b128 v[164:167], v3 offset:32
    ds_read_b128 v[180:183], v3 offset:544
    ds_read_b128 v[168:171], v3 offset:64
    ds_read_b128 v[184:187], v3 offset:576
    ds_read_b128 v[172:175], v3 offset:96
    ds_read_b128 v[188:191], v3 offset:608
    s_waitcnt lgkmcnt(0)
    s_barrier
    v_mov_b32 v45, 0
    global_load_dword v44, v45, s[42:43] sc0 sc1
    v_and_b32 v46, 31, v1
    s_lshl_b32 s38, s76, 5
    v_add_u32 v46, s38, v46
    v_lshlrev_b32 v46, 7, v46
    s_add_u32 s52, s44, 0x1848000
    s_addc_u32 s53, s45, 0
    s_mov_b32 s54, 0x8000
    s_mov_b32 s55, 0x20000
    buffer_load_dword v47, v46, s[52:55], 0 offen sc0 sc1
    s_xor_b32 s38, s30, 0
    s_lshl_b32 s39, s29, 1
    s_add_u32 s38, s38, s39
    s_lshl_b32 s39, s31, 2
    s_add_u32 s38, s38, s39
    s_mul_i32 s38, s38, 2560
    v_mul_f32 v64, v64, v128
    v_mul_f32 v65, v65, v129
    v_mul_f32 v66, v66, v130
    v_mul_f32 v67, v67, v131
    v_mul_f32 v68, v68, v132
    v_mul_f32 v69, v69, v133
    v_mul_f32 v70, v70, v134
    v_mul_f32 v71, v71, v135
    v_mul_f32 v72, v72, v136
    v_mul_f32 v73, v73, v137
    v_mul_f32 v74, v74, v138
    v_mul_f32 v75, v75, v139
    v_mul_f32 v76, v76, v140
    v_mul_f32 v77, v77, v141
    v_mul_f32 v78, v78, v142
    v_mul_f32 v79, v79, v143
    v_fmac_f32 v64, v144, v50
    v_fmac_f32 v65, v145, v50
    v_fmac_f32 v66, v146, v50
    v_fmac_f32 v67, v147, v50
    v_fmac_f32 v68, v148, v50
    v_fmac_f32 v69, v149, v50
    v_fmac_f32 v70, v150, v50
    v_fmac_f32 v71, v151, v50
    v_fmac_f32 v72, v152, v50
    v_fmac_f32 v73, v153, v50
    v_fmac_f32 v74, v154, v50
    v_fmac_f32 v75, v155, v50
    v_fmac_f32 v76, v156, v50
    v_fmac_f32 v77, v157, v50
    v_fmac_f32 v78, v158, v50
    v_fmac_f32 v79, v159, v50
    v_cvt_pk_bf16_f32 v64, v64, v65
    v_cvt_pk_bf16_f32 v65, v66, v67
    v_cvt_pk_bf16_f32 v66, v68, v69
    v_cvt_pk_bf16_f32 v67, v70, v71
    v_cvt_pk_bf16_f32 v68, v72, v73
    v_cvt_pk_bf16_f32 v69, v74, v75
    v_cvt_pk_bf16_f32 v70, v76, v77
    v_cvt_pk_bf16_f32 v71, v78, v79
    buffer_store_dwordx4 v[64:67], v48, s[20:23], s38 offen offset:1280 sc0 sc1
    buffer_store_dwordx4 v[68:71], v48, s[20:23], s38 offen offset:1920 sc0 sc1
    v_mul_f32 v80, v80, v128
    v_mul_f32 v81, v81, v129
    v_mul_f32 v82, v82, v130
    v_mul_f32 v83, v83, v131
    v_mul_f32 v84, v84, v132
    v_mul_f32 v85, v85, v133
    v_mul_f32 v86, v86, v134
    v_mul_f32 v87, v87, v135
    v_mul_f32 v88, v88, v136
    v_mul_f32 v89, v89, v137
    v_mul_f32 v90, v90, v138
    v_mul_f32 v91, v91, v139
    v_mul_f32 v92, v92, v140
    v_mul_f32 v93, v93, v141
    v_mul_f32 v94, v94, v142
    v_mul_f32 v95, v95, v143
    v_fmac_f32 v80, v144, v51
    v_fmac_f32 v81, v145, v51
    v_fmac_f32 v82, v146, v51
    v_fmac_f32 v83, v147, v51
    v_fmac_f32 v84, v148, v51
    v_fmac_f32 v85, v149, v51
    v_fmac_f32 v86, v150, v51
    v_fmac_f32 v87, v151, v51
    v_fmac_f32 v88, v152, v51
    v_fmac_f32 v89, v153, v51
    v_fmac_f32 v90, v154, v51
    v_fmac_f32 v91, v155, v51
    v_fmac_f32 v92, v156, v51
    v_fmac_f32 v93, v157, v51
    v_fmac_f32 v94, v158, v51
    v_fmac_f32 v95, v159, v51
    v_cvt_pk_bf16_f32 v80, v80, v81
    v_cvt_pk_bf16_f32 v81, v82, v83
    v_cvt_pk_bf16_f32 v82, v84, v85
    v_cvt_pk_bf16_f32 v83, v86, v87
    v_cvt_pk_bf16_f32 v84, v88, v89
    v_cvt_pk_bf16_f32 v85, v90, v91
    v_cvt_pk_bf16_f32 v86, v92, v93
    v_cvt_pk_bf16_f32 v87, v94, v95
    buffer_store_dwordx4 v[80:83], v49, s[20:23], s38 offen offset:1280 sc0 sc1
    buffer_store_dwordx4 v[84:87], v49, s[20:23], s38 offen offset:1920 sc0 sc1
    s_xor_b32 s38, s30, 1
    s_lshl_b32 s39, s29, 1
    s_add_u32 s38, s38, s39
    s_lshl_b32 s39, s31, 2
    s_add_u32 s38, s38, s39
    s_mul_i32 s38, s38, 2560
    v_mul_f32 v96, v96, v160
    v_mul_f32 v97, v97, v161
    v_mul_f32 v98, v98, v162
    v_mul_f32 v99, v99, v163
    v_mul_f32 v100, v100, v164
    v_mul_f32 v101, v101, v165
    v_mul_f32 v102, v102, v166
    v_mul_f32 v103, v103, v167
    v_mul_f32 v104, v104, v168
    v_mul_f32 v105, v105, v169
    v_mul_f32 v106, v106, v170
    v_mul_f32 v107, v107, v171
    v_mul_f32 v108, v108, v172
    v_mul_f32 v109, v109, v173
    v_mul_f32 v110, v110, v174
    v_mul_f32 v111, v111, v175
    v_fmac_f32 v96, v176, v50
    v_fmac_f32 v97, v177, v50
    v_fmac_f32 v98, v178, v50
    v_fmac_f32 v99, v179, v50
    v_fmac_f32 v100, v180, v50
    v_fmac_f32 v101, v181, v50
    v_fmac_f32 v102, v182, v50
    v_fmac_f32 v103, v183, v50
    v_fmac_f32 v104, v184, v50
    v_fmac_f32 v105, v185, v50
    v_fmac_f32 v106, v186, v50
    v_fmac_f32 v107, v187, v50
    v_fmac_f32 v108, v188, v50
    v_fmac_f32 v109, v189, v50
    v_fmac_f32 v110, v190, v50
    v_fmac_f32 v111, v191, v50
    v_cvt_pk_bf16_f32 v96, v96, v97
    v_cvt_pk_bf16_f32 v97, v98, v99
    v_cvt_pk_bf16_f32 v98, v100, v101
    v_cvt_pk_bf16_f32 v99, v102, v103
    v_cvt_pk_bf16_f32 v100, v104, v105
    v_cvt_pk_bf16_f32 v101, v106, v107
    v_cvt_pk_bf16_f32 v102, v108, v109
    v_cvt_pk_bf16_f32 v103, v110, v111
    buffer_store_dwordx4 v[96:99], v48, s[20:23], s38 offen offset:1280 sc0 sc1
    buffer_store_dwordx4 v[100:103], v48, s[20:23], s38 offen offset:1920 sc0 sc1
    v_mul_f32 v112, v112, v160
    v_mul_f32 v113, v113, v161
    v_mul_f32 v114, v114, v162
    v_mul_f32 v115, v115, v163
    v_mul_f32 v116, v116, v164
    v_mul_f32 v117, v117, v165
    v_mul_f32 v118, v118, v166
    v_mul_f32 v119, v119, v167
    v_mul_f32 v120, v120, v168
    v_mul_f32 v121, v121, v169
    v_mul_f32 v122, v122, v170
    v_mul_f32 v123, v123, v171
    v_mul_f32 v124, v124, v172
    v_mul_f32 v125, v125, v173
    v_mul_f32 v126, v126, v174
    v_mul_f32 v127, v127, v175
    v_fmac_f32 v112, v176, v51
    v_fmac_f32 v113, v177, v51
    v_fmac_f32 v114, v178, v51
    v_fmac_f32 v115, v179, v51
    v_fmac_f32 v116, v180, v51
    v_fmac_f32 v117, v181, v51
    v_fmac_f32 v118, v182, v51
    v_fmac_f32 v119, v183, v51
    v_fmac_f32 v120, v184, v51
    v_fmac_f32 v121, v185, v51
    v_fmac_f32 v122, v186, v51
    v_fmac_f32 v123, v187, v51
    v_fmac_f32 v124, v188, v51
    v_fmac_f32 v125, v189, v51
    v_fmac_f32 v126, v190, v51
    v_fmac_f32 v127, v191, v51
    v_cvt_pk_bf16_f32 v112, v112, v113
    v_cvt_pk_bf16_f32 v113, v114, v115
    v_cvt_pk_bf16_f32 v114, v116, v117
    v_cvt_pk_bf16_f32 v115, v118, v119
    v_cvt_pk_bf16_f32 v116, v120, v121
    v_cvt_pk_bf16_f32 v117, v122, v123
    v_cvt_pk_bf16_f32 v118, v124, v125
    v_cvt_pk_bf16_f32 v119, v126, v127
    buffer_store_dwordx4 v[112:115], v49, s[20:23], s38 offen offset:1280 sc0 sc1
    buffer_store_dwordx4 v[116:119], v49, s[20:23], s38 offen offset:1920 sc0 sc1
recurrent_scan__mha_block__glu_gated_geglu__prompt_kernel_G_qdone:
    s_lshl_b32 s58, s31, 4
    s_add_u32 s58, s58, s32
    s_branch recurrent_scan__mha_block__glu_gated_geglu__prompt_kernel_G_gu
recurrent_scan__mha_block__glu_gated_geglu__prompt_kernel_G_helper:
    s_setprio 2
    s_waitcnt vmcnt(0)
    v_lshlrev_b32 v144, 16, v128
    v_and_b32 v145, 0xffff0000, v128
    v_lshlrev_b32 v146, 16, v129
    v_and_b32 v147, 0xffff0000, v129
    v_lshlrev_b32 v148, 16, v130
    v_and_b32 v149, 0xffff0000, v130
    v_lshlrev_b32 v150, 16, v131
    v_and_b32 v151, 0xffff0000, v131
    v_lshlrev_b32 v152, 16, v132
    v_and_b32 v153, 0xffff0000, v132
    v_lshlrev_b32 v154, 16, v133
    v_and_b32 v155, 0xffff0000, v133
    v_lshlrev_b32 v156, 16, v134
    v_and_b32 v157, 0xffff0000, v134
    v_lshlrev_b32 v158, 16, v135
    v_and_b32 v159, 0xffff0000, v135
    v_add_f32 v160, v144, v145
    v_mul_f32 v161, v144, v144
    v_fmac_f32 v161, v145, v145
    v_add_f32 v160, v160, v146
    v_fmac_f32 v161, v146, v146
    v_add_f32 v160, v160, v147
    v_fmac_f32 v161, v147, v147
    v_add_f32 v160, v160, v148
    v_fmac_f32 v161, v148, v148
    v_add_f32 v160, v160, v149
    v_fmac_f32 v161, v149, v149
    v_add_f32 v160, v160, v150
    v_fmac_f32 v161, v150, v150
    v_add_f32 v160, v160, v151
    v_fmac_f32 v161, v151, v151
    v_add_f32 v160, v160, v152
    v_fmac_f32 v161, v152, v152
    v_add_f32 v160, v160, v153
    v_fmac_f32 v161, v153, v153
    v_add_f32 v160, v160, v154
    v_fmac_f32 v161, v154, v154
    v_add_f32 v160, v160, v155
    v_fmac_f32 v161, v155, v155
    v_add_f32 v160, v160, v156
    v_fmac_f32 v161, v156, v156
    v_add_f32 v160, v160, v157
    v_fmac_f32 v161, v157, v157
    v_add_f32 v160, v160, v158
    v_fmac_f32 v161, v158, v158
    v_add_f32 v160, v160, v159
    v_fmac_f32 v161, v159, v159
    v_lshlrev_b32 v164, 16, v136
    v_and_b32 v165, 0xffff0000, v136
    v_add_f32_dpp v160, v160, v160 row_ror:8 row_mask:0xf bank_mask:0xf
    v_add_f32_dpp v161, v161, v161 row_ror:8 row_mask:0xf bank_mask:0xf
    v_lshlrev_b32 v162, 16, v140
    v_and_b32 v163, 0xffff0000, v140
    v_add_f32 v164, v164, v162
    v_add_f32_dpp v160, v160, v160 row_ror:4 row_mask:0xf bank_mask:0xf
    v_add_f32_dpp v161, v161, v161 row_ror:4 row_mask:0xf bank_mask:0xf
    v_add_f32 v165, v165, v163
    v_lshlrev_b32 v166, 16, v137
    v_and_b32 v167, 0xffff0000, v137
    v_add_f32_dpp v160, v160, v160 row_ror:2 row_mask:0xf bank_mask:0xf
    v_add_f32_dpp v161, v161, v161 row_ror:2 row_mask:0xf bank_mask:0xf
    v_lshlrev_b32 v162, 16, v141
    v_and_b32 v163, 0xffff0000, v141
    v_add_f32 v166, v166, v162
    v_add_f32_dpp v160, v160, v160 row_ror:1 row_mask:0xf bank_mask:0xf
    v_add_f32_dpp v161, v161, v161 row_ror:1 row_mask:0xf bank_mask:0xf
    v_add_f32 v167, v167, v163
    v_lshlrev_b32 v168, 16, v138
    v_and_b32 v169, 0xffff0000, v138
    v_lshlrev_b32 v162, 16, v142
    v_and_b32 v163, 0xffff0000, v142
    v_add_f32 v168, v168, v162
    v_add_f32 v169, v169, v163
    v_lshlrev_b32 v170, 16, v139
    v_and_b32 v171, 0xffff0000, v139
    v_lshlrev_b32 v162, 16, v143
    v_and_b32 v163, 0xffff0000, v143
    v_add_f32 v170, v170, v162
    v_add_f32 v171, v171, v163
    v_mov_b32 v162, v160
    v_mov_b32 v163, v160
    s_nop 1
    v_permlane16_swap_b32 v162, v163
    s_nop 1
    v_add_f32 v160, v162, v163
    v_mov_b32 v162, v161
    v_mov_b32 v163, v161
    s_nop 1
    v_permlane16_swap_b32 v162, v163
    s_nop 1
    v_add_f32 v161, v162, v163
    v_mov_b32 v162, v160
    v_mov_b32 v163, v160
    s_nop 1
    v_permlane32_swap_b32 v162, v163
    s_nop 1
    v_add_f32 v160, v162, v163
    v_mov_b32 v162, v161
    v_mov_b32 v163, v161
    s_nop 1
    v_permlane32_swap_b32 v162, v163
    s_nop 1
    v_add_f32 v161, v162, v163
    v_mul_f32 v160, 0x3acccccd, v160
    v_mul_f32 v161, 0x3acccccd, v161
    v_fma_f32 v161, -v160, v160, v161
    v_max_f32 v161, 0, v161
    v_add_f32 v161, 0x3727c5ac, v161
    v_rsq_f32 v162, v161
    s_nop 0
    v_mul_f32 v163, v160, v162
    v_sub_f32 v163, 0, v163
    v_fma_f32 v144, v144, v162, v163
    v_fma_f32 v145, v145, v162, v163
    v_fma_f32 v146, v146, v162, v163
    v_fma_f32 v147, v147, v162, v163
    v_fma_f32 v148, v148, v162, v163
    v_fma_f32 v149, v149, v162, v163
    v_fma_f32 v150, v150, v162, v163
    v_fma_f32 v151, v151, v162, v163
    v_fma_f32 v152, v152, v162, v163
    v_fma_f32 v153, v153, v162, v163
    v_fma_f32 v154, v154, v162, v163
    v_fma_f32 v155, v155, v162, v163
    v_fma_f32 v156, v156, v162, v163
    v_fma_f32 v157, v157, v162, v163
    v_fma_f32 v158, v158, v162, v163
    v_fma_f32 v159, v159, v162, v163
    v_cvt_pk_bf16_f32 v128, v144, v145
    v_cvt_pk_bf16_f32 v129, v146, v147
    v_cvt_pk_bf16_f32 v130, v148, v149
    v_cvt_pk_bf16_f32 v131, v150, v151
    v_cvt_pk_bf16_f32 v132, v152, v153
    v_cvt_pk_bf16_f32 v133, v154, v155
    v_cvt_pk_bf16_f32 v134, v156, v157
    v_cvt_pk_bf16_f32 v135, v158, v159
    s_add_u32 s52, s44, 0x1850000
    s_addc_u32 s53, s45, 0
    s_mov_b32 s54, 0x4000
    s_mov_b32 s55, 0x20000
    s_mul_i32 s38, s48, 1296
    s_add_u32 s38, s38, 147456
    v_lshlrev_b32 v5, 4, v1
    v_add_u32 v5, s38, v5
    ds_write_b128 v5, v[128:131]
    s_mov_b64 exec, 0xffff
    ds_write_b128 v5, v[132:135] offset:1024
    s_mov_b64 exec, 1
    s_lshl_b32 s38, s51, 3
    v_mov_b32 v6, 0
    buffer_store_dwordx2 v[162:163], v6, s[52:55], s38 offen sc0 sc1
    s_mov_b64 exec, -1
    s_waitcnt vmcnt(0) lgkmcnt(0)
    s_barrier
    s_barrier
    v_mov_b32 v45, 0
    global_load_dword v44, v45, s[42:43] sc0 sc1
    v_and_b32 v46, 31, v1
    s_lshl_b32 s38, s76, 5
    v_add_u32 v46, s38, v46
    v_lshlrev_b32 v46, 7, v46
    s_add_u32 s52, s44, 0x1848000
    s_addc_u32 s53, s45, 0
    s_mov_b32 s54, 0x8000
    s_mov_b32 s55, 0x20000
    buffer_load_dword v47, v46, s[52:55], 0 offen sc0 sc1
    s_waitcnt vmcnt(0)
    s_mov_b32 s58, -1
recurrent_scan__mha_block__glu_gated_geglu__prompt_kernel_G_gu:
    s_barrier
    v_mov_b32 v216, 147456
    v_mov_b32 v217, 1
    s_mov_b32 s33, 0
    s_waitcnt vmcnt(8) lgkmcnt(0)
    v_readfirstlane_b32 s3, v44
    s_cmp_lg_u32 s3, 0
    s_cbranch_scc1 recurrent_scan__mha_block__glu_gated_geglu__prompt_kernel_ghavetag
    v_mov_b32 v5, 0
    s_mov_b32 s40, 0
recurrent_scan__mha_block__glu_gated_geglu__prompt_kernel_tag_11:
    global_load_dword v6, v5, s[42:43] sc0 sc1
    s_waitcnt vmcnt(0)
    v_readfirstlane_b32 s3, v6
    s_cmp_lg_u32 s3, 0
    s_cbranch_scc1 recurrent_scan__mha_block__glu_gated_geglu__prompt_kernel_tag_11_ok
    s_sleep 2
    s_add_u32 s40, s40, 1
    s_cmp_lt_u32 s40, 32768
    s_cbranch_scc1 recurrent_scan__mha_block__glu_gated_geglu__prompt_kernel_tag_11
recurrent_scan__mha_block__glu_gated_geglu__prompt_kernel_tag_11_ok:
recurrent_scan__mha_block__glu_gated_geglu__prompt_kernel_ghavetag:
    s_cmp_ge_u32 s77, 27
    s_cbranch_scc1 recurrent_scan__mha_block__glu_gated_geglu__prompt_kernel_gu_none
    v_lshlrev_b32 v8, 4, v1
    s_lshl_b32 s38, s29, 14
    v_add_u32 v8, s38, v8
    v_and_b32 v4, 15, v1
    v_lshrrev_b32 v3, 5, v1
    v_lshrrev_b32 v5, 2, v4
    v_lshl_add_u32 v5, v3, 3, v5
    v_lshlrev_b32 v5, 7, v5
    v_and_b32 v6, 3, v4
    v_lshl_add_u32 v5, v6, 3, v5
    v_bfe_u32 v6, v1, 4, 1
    v_lshl_add_u32 v5, v6, 5, v5
    v_bfe_u32 v6, v4, 3, 1
    v_lshl_add_u32 v5, v6, 6, v5
    s_lshl_b32 s39, s30, 6
    v_xor_b32 v9, s39, v5
    v_add_u32 v9, 32768, v9
    v_lshrrev_b32 v2, 3, v1
    v_and_b32 v3, 7, v1
    v_bfe_u32 v5, v1, 4, 1
    v_lshlrev_b32 v5, 2, v5
    v_xor_b32 v5, v5, v3
    v_lshlrev_b32 v5, 4, v5
    v_mul_u32_u24 v6, 3456, v2
    v_add_u32 v5, v5, v6
    v_add_u32 v12, 0, v5
    v_add_u32 v13, 26624, v5
    v_add_u32 v14, 53248, v5
    v_add_u32 v15, 79872, v5
    v_lshlrev_b32 v7, 4, v1
    s_lshl_b32 s38, s76, 3
    s_lshl_b32 s39, s28, 1
    s_add_u32 s38, s38, s39
    s_mul_i32 s36, s38, 40960
    s_mul_i32 s41, s30, 110592
    s_lshl_b32 s38, s77, 7
    s_add_u32 s41, s41, s38
    s_cmp_ge_u32 s28, 2
    s_cselect_b32 s4, s82, s80
    s_cselect_b32 s5, s83, s81
    s_mov_b32 s12, s4
    s_mov_b32 s13, s5
    s_mov_b32 s14, 0x21c000
    s_mov_b32 s15, 0x20000
    s_add_u32 s8, s44, 0x10c0000
    s_addc_u32 s9, s45, 0
    s_mov_b32 s10, 0x280000
    s_mov_b32 s11, 0x20000
    s_add_u32 s24, s44, 0x780000
    s_addc_u32 s25, s45, 0
    s_mov_b32 s26, 0x6c0000
    s_mov_b32 s27, 0x20000
    v_cmp_ne_u32 vcc, s3, v47
    s_nop 1
    s_cmp_eq_u64 vcc, 0
    s_cbranch_scc1 recurrent_scan__mha_block__glu_gated_geglu__prompt_kernel_xnok
    s_add_u32 s52, s44, 0x1848000
    s_addc_u32 s53, s45, 0
    s_mov_b32 s54, 0x8000
    s_mov_b32 s55, 0x20000
    s_mov_b32 s40, 0
recurrent_scan__mha_block__glu_gated_geglu__prompt_kernel_xpoll_12:
    buffer_load_dword v47, v46, s[52:55], 0 offen sc0 sc1
    s_waitcnt vmcnt(0)
    v_cmp_ne_u32 vcc, s3, v47
    s_nop 1
    s_cmp_eq_u64 vcc, 0
    s_cbranch_scc1 recurrent_scan__mha_block__glu_gated_geglu__prompt_kernel_xpoll_12_ok
    s_sleep 4
    s_add_u32 s40, s40, 1
    s_cmp_lt_u32 s40, 32768
    s_cbranch_scc1 recurrent_scan__mha_block__glu_gated_geglu__prompt_kernel_xpoll_12
recurrent_scan__mha_block__glu_gated_geglu__prompt_kernel_xpoll_12_ok:
recurrent_scan__mha_block__glu_gated_geglu__prompt_kernel_xnok:
    s_add_u32 s36, s36, 12288
    s_add_u32 s41, s41, 663552
    s_mov_b32 s34, 0
    s_mov_b32 s35, 0
    s_mov_b32 s49, 0
    s_waitcnt vmcnt(0)
    s_add_u32 s33, s33, 4
    s_mov_b64 exec, 1
    ds_add_u32 v216, v217
    s_mov_b64 exec, -1
    s_mov_b32 s57, 0
recurrent_scan__mha_block__glu_gated_geglu__prompt_kernel_sw_13:
    ds_read_b32 v218, v216
    s_add_u32 s57, s57, 1
    s_cmp_ge_u32 s57, 0x100000
    s_cbranch_scc1 recurrent_scan__mha_block__glu_gated_geglu__prompt_kernel_sw_13_x
    s_waitcnt lgkmcnt(0)
    v_readfirstlane_b32 s38, v218
    s_cmp_ge_u32 s38, s33
    s_cbranch_scc1 recurrent_scan__mha_block__glu_gated_geglu__prompt_kernel_sw_13_x
    s_sleep 1
    s_branch recurrent_scan__mha_block__glu_gated_geglu__prompt_kernel_sw_13
recurrent_scan__mha_block__glu_gated_geglu__prompt_kernel_sw_13_x:
    s_waitcnt lgkmcnt(0)
    s_cmp_eq_u32 s28, 0
    s_cbranch_scc0 recurrent_scan__mha_block__glu_gated_geglu__prompt_kernel_pq_14
    s_cmp_eq_u32 s58, -1
    s_cbranch_scc1 recurrent_scan__mha_block__glu_gated_geglu__prompt_kernel_pq_14
    s_mov_b32 s38, s58
    s_add_u32 s52, s44, 0x1872000
    s_addc_u32 s53, s45, 0
    s_mov_b32 s54, 0x8000
    s_mov_b32 s55, 0x20000
    s_lshl_b32 s38, s38, 7
    v_mov_b32 v5, s38
    v_mov_b32 v6, s3
    s_mov_b64 exec, 1
    buffer_store_dword v6, v5, s[52:55], 0 offen sc0 sc1
    s_mov_b64 exec, -1
recurrent_scan__mha_block__glu_gated_geglu__prompt_kernel_pq_14:
    v_mov_b32 v16, 0
    v_mov_b32 v17, 0
    v_mov_b32 v18, 0
    v_mov_b32 v19, 0
    v_mov_b32 v20, 0
    v_mov_b32 v21, 0
    v_mov_b32 v22, 0
    v_mov_b32 v23, 0
    v_mov_b32 v24, 0
    v_mov_b32 v25, 0
    v_mov_b32 v26, 0
    v_mov_b32 v27, 0
    v_mov_b32 v28, 0
    v_mov_b32 v29, 0
    v_mov_b32 v30, 0
    v_mov_b32 v31, 0
    v_mov_b32 v32, 0
    v_mov_b32 v33, 0
    v_mov_b32 v34, 0
    v_mov_b32 v35, 0
    v_mov_b32 v36, 0
    v_mov_b32 v37, 0
    v_mov_b32 v38, 0
    v_mov_b32 v39, 0
    v_mov_b32 v40, 0
    v_mov_b32 v41, 0
    v_mov_b32 v42, 0
    v_mov_b32 v43, 0
    v_mov_b32 v44, 0
    v_mov_b32 v45, 0
    v_mov_b32 v46, 0
    v_mov_b32 v47, 0
    v_mov_b32 v48, 0
    v_mov_b32 v49, 0
    v_mov_b32 v50, 0
    v_mov_b32 v51, 0
    v_mov_b32 v52, 0
    v_mov_b32 v53, 0
    v_mov_b32 v54, 0
    v_mov_b32 v55, 0
    v_mov_b32 v56, 0
    v_mov_b32 v57, 0
    v_mov_b32 v58, 0
    v_mov_b32 v59, 0
    v_mov_b32 v60, 0
    v_mov_b32 v61, 0
    v_mov_b32 v62, 0
    v_mov_b32 v63, 0
    v_mov_b32 v64, 0
    v_mov_b32 v65, 0
    v_mov_b32 v66, 0
    v_mov_b32 v67, 0
    v_mov_b32 v68, 0
    v_mov_b32 v69, 0
    v_mov_b32 v70, 0
    v_mov_b32 v71, 0
    v_mov_b32 v72, 0
    v_mov_b32 v73, 0
    v_mov_b32 v74, 0
    v_mov_b32 v75, 0
    v_mov_b32 v76, 0
    v_mov_b32 v77, 0
    v_mov_b32 v78, 0
    v_mov_b32 v79, 0
    v_mov_b32 v80, 0
    v_mov_b32 v81, 0
    v_mov_b32 v82, 0
    v_mov_b32 v83, 0
    v_mov_b32 v84, 0
    v_mov_b32 v85, 0
    v_mov_b32 v86, 0
    v_mov_b32 v87, 0
    v_mov_b32 v88, 0
    v_mov_b32 v89, 0
    v_mov_b32 v90, 0
    v_mov_b32 v91, 0
    v_mov_b32 v92, 0
    v_mov_b32 v93, 0
    v_mov_b32 v94, 0
    v_mov_b32 v95, 0
    v_mov_b32 v96, 0
    v_mov_b32 v97, 0
    v_mov_b32 v98, 0
    v_mov_b32 v99, 0
    v_mov_b32 v100, 0
    v_mov_b32 v101, 0
    v_mov_b32 v102, 0
    v_mov_b32 v103, 0
    v_mov_b32 v104, 0
    v_mov_b32 v105, 0
    v_mov_b32 v106, 0
    v_mov_b32 v107, 0
    v_mov_b32 v108, 0
    v_mov_b32 v109, 0
    v_mov_b32 v110, 0
    v_mov_b32 v111, 0
    v_mov_b32 v112, 0
    v_mov_b32 v113, 0
    v_mov_b32 v114, 0
    v_mov_b32 v115, 0
    v_mov_b32 v116, 0
    v_mov_b32 v117, 0
    v_mov_b32 v118, 0
    v_mov_b32 v119, 0
    v_mov_b32 v120, 0
    v_mov_b32 v121, 0
    v_mov_b32 v122, 0
    v_mov_b32 v123, 0
    v_mov_b32 v124, 0
    v_mov_b32 v125, 0
    v_mov_b32 v126, 0
    v_mov_b32 v127, 0
    v_mov_b32 v128, 0
    v_mov_b32 v129, 0
    v_mov_b32 v130, 0
    v_mov_b32 v131, 0
    v_mov_b32 v132, 0
    v_mov_b32 v133, 0
    v_mov_b32 v134, 0
    v_mov_b32 v135, 0
    v_mov_b32 v136, 0
    v_mov_b32 v137, 0
    v_mov_b32 v138, 0
    v_mov_b32 v139, 0
    v_mov_b32 v140, 0
    v_mov_b32 v141, 0
    v_mov_b32 v142, 0
    v_mov_b32 v143, 0
    v_mov_b32 v212, 147520
    v_mov_b32 v214, 147536
    s_lshl_b32 s38, s28, 2
    s_add_u32 s39, s38, 147536
    v_mov_b32 v213, s39
    s_add_u32 s39, s38, 147520
    v_mov_b32 v215, s39
    s_setprio 2
    s_mov_b32 s40, 0
recurrent_scan__mha_block__glu_gated_geglu__prompt_kernel_gw_15:
    ds_read_b128 v[224:227], v212
    s_add_u32 s40, s40, 1
    s_cmp_ge_u32 s40, 0x100000
    s_cbranch_scc1 recurrent_scan__mha_block__glu_gated_geglu__prompt_kernel_gw_15_x
    s_waitcnt lgkmcnt(0)
    v_min3_u32 v224, v224, v225, v226
    v_min_u32 v224, v224, v227
    s_nop 0
    v_readfirstlane_b32 s39, v224
    s_cmp_ge_u32 s39, 1
    s_cbranch_scc1 recurrent_scan__mha_block__glu_gated_geglu__prompt_kernel_gw_15_x
    s_sleep 1
    s_branch recurrent_scan__mha_block__glu_gated_geglu__prompt_kernel_gw_15
recurrent_scan__mha_block__glu_gated_geglu__prompt_kernel_gw_15_x:
    s_waitcnt lgkmcnt(0)
    v_mov_b32 v10, v8
    v_mov_b32 v11, v9
    ds_read_b128 v[144:147], v10 offset:0
    ds_read_b128 v[148:151], v10 offset:4096
    ds_read_b128 v[152:155], v10 offset:8192
    ds_read_b128 v[156:159], v10 offset:12288
    ds_read_b64_tr_b16 v[160:161], v11 offset:0
    ds_read_b64_tr_b16 v[162:163], v11 offset:512
    ds_read_b64_tr_b16 v[164:165], v11 offset:8192
    ds_read_b64_tr_b16 v[166:167], v11 offset:8704
recurrent_scan__mha_block__glu_gated_geglu__prompt_kernel_gu_loop:
    s_add_u32 s38, s49, 2
    s_cmp_ge_u32 s38, 3
    s_cbranch_scc0 recurrent_scan__mha_block__glu_gated_geglu__prompt_kernel_gu_nd
    s_cmp_le_u32 s38, 9
    s_cbranch_scc0 recurrent_scan__mha_block__glu_gated_geglu__prompt_kernel_gu_nd
    s_setprio 2
    s_mov_b32 s40, 0
recurrent_scan__mha_block__glu_gated_geglu__prompt_kernel_gc_16:
    ds_read_b128 v[224:227], v214
    s_add_u32 s40, s40, 1
    s_cmp_ge_u32 s40, 0x100000
    s_cbranch_scc1 recurrent_scan__mha_block__glu_gated_geglu__prompt_kernel_gc_16_x
    s_waitcnt lgkmcnt(0)
    v_min3_u32 v224, v224, v225, v226
    v_min_u32 v224, v224, v227
    s_nop 0
    v_readfirstlane_b32 s39, v224
    s_cmp_ge_u32 s39, s49
    s_cbranch_scc1 recurrent_scan__mha_block__glu_gated_geglu__prompt_kernel_gc_16_x
    s_sleep 1
    s_branch recurrent_scan__mha_block__glu_gated_geglu__prompt_kernel_gc_16
recurrent_scan__mha_block__glu_gated_geglu__prompt_kernel_gc_16_x:
    s_waitcnt lgkmcnt(0)
    s_setprio 0
    s_waitcnt lgkmcnt(0)
    s_setprio 2
    v_mfma_f32_32x32x16_bf16 v[16:31], v[160:163], v[144:147], v[16:31]
    ds_read_b128 v[168:171], v10 offset:1024
    v_mfma_f32_32x32x16_bf16 v[32:47], v[164:167], v[144:147], v[32:47]
    ds_read_b128 v[172:175], v10 offset:5120
    s_setprio 0
    v_mfma_f32_32x32x16_bf16 v[48:63], v[160:163], v[148:151], v[48:63]
    ds_read_b128 v[176:179], v10 offset:9216
    v_mfma_f32_32x32x16_bf16 v[64:79], v[164:167], v[148:151], v[64:79]
    ds_read_b128 v[180:183], v10 offset:13312
    v_mfma_f32_32x32x16_bf16 v[80:95], v[160:163], v[152:155], v[80:95]
    ds_read_b64_tr_b16 v[184:185], v11 offset:2048
    s_lshl_b32 s39, s28, 13
    s_add_u32 s39, s39, s34
    s_mov_b32 m0, s39
    s_add_u32 s37, s36, 40960
    buffer_load_dwordx4 v7, s[8:11], s36 offen lds
    v_mfma_f32_32x32x16_bf16 v[96:111], v[164:167], v[152:155], v[96:111]
    ds_read_b64_tr_b16 v[186:187], v11 offset:2560
    buffer_load_dwordx4 v7, s[8:11], s36 offen offset:1024 lds
    v_mfma_f32_32x32x16_bf16 v[112:127], v[160:163], v[156:159], v[112:127]
    ds_read_b64_tr_b16 v[188:189], v11 offset:10240
    v_mfma_f32_32x32x16_bf16 v[128:143], v[164:167], v[156:159], v[128:143]
    ds_read_b64_tr_b16 v[190:191], v11 offset:10752
    buffer_load_dwordx4 v7, s[8:11], s36 offen offset:2048 lds
    s_waitcnt lgkmcnt(0)
    s_setprio 2
    v_mfma_f32_32x32x16_bf16 v[16:31], v[184:187], v[168:171], v[16:31]
    ds_read_b128 v[144:147], v10 offset:2048
    v_mfma_f32_32x32x16_bf16 v[32:47], v[188:191], v[168:171], v[32:47]
    ds_read_b128 v[148:151], v10 offset:6144
    s_setprio 0
    v_mfma_f32_32x32x16_bf16 v[48:63], v[184:187], v[172:175], v[48:63]
    ds_read_b128 v[152:155], v10 offset:10240
    v_mfma_f32_32x32x16_bf16 v[64:79], v[188:191], v[172:175], v[64:79]
    ds_read_b128 v[156:159], v10 offset:14336
    v_mfma_f32_32x32x16_bf16 v[80:95], v[184:187], v[176:179], v[80:95]
    ds_read_b64_tr_b16 v[160:161], v11 offset:4096
    buffer_load_dwordx4 v7, s[8:11], s36 offen offset:3072 lds
    v_mfma_f32_32x32x16_bf16 v[96:111], v[188:191], v[176:179], v[96:111]
    ds_read_b64_tr_b16 v[162:163], v11 offset:4608
    s_add_u32 m0, s39, 4096
    s_add_u32 s36, s36, 4096
    buffer_load_dwordx4 v7, s[8:11], s37 offen lds
    v_mfma_f32_32x32x16_bf16 v[112:127], v[184:187], v[180:183], v[112:127]
    ds_read_b64_tr_b16 v[164:165], v11 offset:12288
    v_mfma_f32_32x32x16_bf16 v[128:143], v[188:191], v[180:183], v[128:143]
    ds_read_b64_tr_b16 v[166:167], v11 offset:12800
    buffer_load_dwordx4 v7, s[8:11], s37 offen offset:1024 lds
    s_waitcnt lgkmcnt(0)
    s_setprio 2
    v_mfma_f32_32x32x16_bf16 v[16:31], v[160:163], v[144:147], v[16:31]
    ds_read_b128 v[168:171], v10 offset:3072
    v_mfma_f32_32x32x16_bf16 v[32:47], v[164:167], v[144:147], v[32:47]
    ds_read_b128 v[172:175], v10 offset:7168
    s_setprio 0
    v_mfma_f32_32x32x16_bf16 v[48:63], v[160:163], v[148:151], v[48:63]
    ds_read_b128 v[176:179], v10 offset:11264
    v_mfma_f32_32x32x16_bf16 v[64:79], v[164:167], v[148:151], v[64:79]
    ds_read_b128 v[180:183], v10 offset:15360
    v_mfma_f32_32x32x16_bf16 v[80:95], v[160:163], v[152:155], v[80:95]
    ds_read_b64_tr_b16 v[184:185], v11 offset:6144
    buffer_load_dwordx4 v7, s[8:11], s37 offen offset:2048 lds
    v_mfma_f32_32x32x16_bf16 v[96:111], v[164:167], v[152:155], v[96:111]
    ds_read_b64_tr_b16 v[186:187], v11 offset:6656
    buffer_load_dwordx4 v7, s[8:11], s37 offen offset:3072 lds
    v_mfma_f32_32x32x16_bf16 v[112:127], v[160:163], v[156:159], v[112:127]
    ds_read_b64_tr_b16 v[188:189], v11 offset:14336
    v_mfma_f32_32x32x16_bf16 v[128:143], v[164:167], v[156:159], v[128:143]
    ds_read_b64_tr_b16 v[190:191], v11 offset:14848
    s_lshl_b32 s39, s28, 12
    s_add_u32 s39, s39, s34
    s_add_u32 m0, s39, 32768
    s_nop 0
    buffer_load_dwordx4 v12, s[12:15], s41 offen lds
    s_waitcnt lgkmcnt(0)
    s_mov_b32 s79, 1
    s_branch recurrent_scan__mha_block__glu_gated_geglu__prompt_kernel_gu_j
recurrent_scan__mha_block__glu_gated_geglu__prompt_kernel_gu_nd:
    s_waitcnt lgkmcnt(0)
    s_setprio 2
    v_mfma_f32_32x32x16_bf16 v[16:31], v[160:163], v[144:147], v[16:31]
    ds_read_b128 v[168:171], v10 offset:1024
    v_mfma_f32_32x32x16_bf16 v[32:47], v[164:167], v[144:147], v[32:47]
    ds_read_b128 v[172:175], v10 offset:5120
    s_setprio 0
    v_mfma_f32_32x32x16_bf16 v[48:63], v[160:163], v[148:151], v[48:63]
    ds_read_b128 v[176:179], v10 offset:9216
    v_mfma_f32_32x32x16_bf16 v[64:79], v[164:167], v[148:151], v[64:79]
    ds_read_b128 v[180:183], v10 offset:13312
    v_mfma_f32_32x32x16_bf16 v[80:95], v[160:163], v[152:155], v[80:95]
    ds_read_b64_tr_b16 v[184:185], v11 offset:2048
    v_mfma_f32_32x32x16_bf16 v[96:111], v[164:167], v[152:155], v[96:111]
    ds_read_b64_tr_b16 v[186:187], v11 offset:2560
    v_mfma_f32_32x32x16_bf16 v[112:127], v[160:163], v[156:159], v[112:127]
    ds_read_b64_tr_b16 v[188:189], v11 offset:10240
    v_mfma_f32_32x32x16_bf16 v[128:143], v[164:167], v[156:159], v[128:143]
    ds_read_b64_tr_b16 v[190:191], v11 offset:10752
    s_waitcnt lgkmcnt(0)
    s_setprio 2
    v_mfma_f32_32x32x16_bf16 v[16:31], v[184:187], v[168:171], v[16:31]
    ds_read_b128 v[144:147], v10 offset:2048
    v_mfma_f32_32x32x16_bf16 v[32:47], v[188:191], v[168:171], v[32:47]
    ds_read_b128 v[148:151], v10 offset:6144
    s_setprio 0
    v_mfma_f32_32x32x16_bf16 v[48:63], v[184:187], v[172:175], v[48:63]
    ds_read_b128 v[152:155], v10 offset:10240
    v_mfma_f32_32x32x16_bf16 v[64:79], v[188:191], v[172:175], v[64:79]
    ds_read_b128 v[156:159], v10 offset:14336
    v_mfma_f32_32x32x16_bf16 v[80:95], v[184:187], v[176:179], v[80:95]
    ds_read_b64_tr_b16 v[160:161], v11 offset:4096
    v_mfma_f32_32x32x16_bf16 v[96:111], v[188:191], v[176:179], v[96:111]
    ds_read_b64_tr_b16 v[162:163], v11 offset:4608
    v_mfma_f32_32x32x16_bf16 v[112:127], v[184:187], v[180:183], v[112:127]
    ds_read_b64_tr_b16 v[164:165], v11 offset:12288
    v_mfma_f32_32x32x16_bf16 v[128:143], v[188:191], v[180:183], v[128:143]
    ds_read_b64_tr_b16 v[166:167], v11 offset:12800
    s_waitcnt lgkmcnt(0)
    s_setprio 2
    v_mfma_f32_32x32x16_bf16 v[16:31], v[160:163], v[144:147], v[16:31]
    ds_read_b128 v[168:171], v10 offset:3072
    v_mfma_f32_32x32x16_bf16 v[32:47], v[164:167], v[144:147], v[32:47]
    ds_read_b128 v[172:175], v10 offset:7168
    s_setprio 0
    v_mfma_f32_32x32x16_bf16 v[48:63], v[160:163], v[148:151], v[48:63]
    ds_read_b128 v[176:179], v10 offset:11264
    v_mfma_f32_32x32x16_bf16 v[64:79], v[164:167], v[148:151], v[64:79]
    ds_read_b128 v[180:183], v10 offset:15360
    v_mfma_f32_32x32x16_bf16 v[80:95], v[160:163], v[152:155], v[80:95]
    ds_read_b64_tr_b16 v[184:185], v11 offset:6144
    v_mfma_f32_32x32x16_bf16 v[96:111], v[164:167], v[152:155], v[96:111]
    ds_read_b64_tr_b16 v[186:187], v11 offset:6656
    v_mfma_f32_32x32x16_bf16 v[112:127], v[160:163], v[156:159], v[112:127]
    ds_read_b64_tr_b16 v[188:189], v11 offset:14336
    v_mfma_f32_32x32x16_bf16 v[128:143], v[164:167], v[156:159], v[128:143]
    ds_read_b64_tr_b16 v[190:191], v11 offset:14848
    s_waitcnt lgkmcnt(0)
    s_mov_b32 s79, 0
recurrent_scan__mha_block__glu_gated_geglu__prompt_kernel_gu_j:
    s_setprio 2
    s_add_u32 s38, s49, 1
    v_mov_b32 v224, s38
    ds_write_b32 v213, v224
    s_cmp_eq_u32 s49, 9
    s_cbranch_scc1 recurrent_scan__mha_block__glu_gated_geglu__prompt_kernel_gu_last
    s_add_u32 s38, s49, 1
    s_cmp_ge_u32 s38, 3
    s_cbranch_scc0 recurrent_scan__mha_block__glu_gated_geglu__prompt_kernel_gu_nown
    s_cmp_eq_u32 s49, 8
    s_cbranch_scc1 recurrent_scan__mha_block__glu_gated_geglu__prompt_kernel_gu_w0
    s_waitcnt vmcnt(9)
    s_branch recurrent_scan__mha_block__glu_gated_geglu__prompt_kernel_gu_wj
recurrent_scan__mha_block__glu_gated_geglu__prompt_kernel_gu_w0:
    s_waitcnt vmcnt(0)
recurrent_scan__mha_block__glu_gated_geglu__prompt_kernel_gu_wj:
    s_add_u32 s38, s49, 2
    v_mov_b32 v224, s38
    ds_write_b32 v215, v224
recurrent_scan__mha_block__glu_gated_geglu__prompt_kernel_gu_nown:
    s_setprio 0
    s_cmp_eq_u32 s79, 1
    s_cbranch_scc0 recurrent_scan__mha_block__glu_gated_geglu__prompt_kernel_gu_m3n
    s_setprio 2
    v_mfma_f32_32x32x16_bf16 v[16:31], v[184:187], v[168:171], v[16:31]
    v_mfma_f32_32x32x16_bf16 v[32:47], v[188:191], v[168:171], v[32:47]
    s_setprio 0
    v_mfma_f32_32x32x16_bf16 v[48:63], v[184:187], v[172:175], v[48:63]
    v_mfma_f32_32x32x16_bf16 v[64:79], v[188:191], v[172:175], v[64:79]
    v_mfma_f32_32x32x16_bf16 v[80:95], v[184:187], v[176:179], v[80:95]
    buffer_load_dwordx4 v13, s[12:15], s41 offen offset:1024 lds
    v_mfma_f32_32x32x16_bf16 v[96:111], v[188:191], v[176:179], v[96:111]
    buffer_load_dwordx4 v14, s[12:15], s41 offen offset:2048 lds
    v_mfma_f32_32x32x16_bf16 v[112:127], v[184:187], v[180:183], v[112:127]
    v_mfma_f32_32x32x16_bf16 v[128:143], v[188:191], v[180:183], v[128:143]
    buffer_load_dwordx4 v15, s[12:15], s41 offen offset:3072 lds
    s_add_u32 s41, s41, 221184
    s_add_u32 s34, s34, 49152
    s_cmp_eq_u32 s34, 147456
    s_cselect_b32 s34, 0, s34
    s_branch recurrent_scan__mha_block__glu_gated_geglu__prompt_kernel_gu_m3j
recurrent_scan__mha_block__glu_gated_geglu__prompt_kernel_gu_m3n:
    s_setprio 2
    v_mfma_f32_32x32x16_bf16 v[16:31], v[184:187], v[168:171], v[16:31]
    v_mfma_f32_32x32x16_bf16 v[32:47], v[188:191], v[168:171], v[32:47]
    s_setprio 0
    v_mfma_f32_32x32x16_bf16 v[48:63], v[184:187], v[172:175], v[48:63]
    v_mfma_f32_32x32x16_bf16 v[64:79], v[188:191], v[172:175], v[64:79]
    v_mfma_f32_32x32x16_bf16 v[80:95], v[184:187], v[176:179], v[80:95]
    v_mfma_f32_32x32x16_bf16 v[96:111], v[188:191], v[176:179], v[96:111]
    v_mfma_f32_32x32x16_bf16 v[112:127], v[184:187], v[180:183], v[112:127]
    v_mfma_f32_32x32x16_bf16 v[128:143], v[188:191], v[180:183], v[128:143]
recurrent_scan__mha_block__glu_gated_geglu__prompt_kernel_gu_m3j:
    s_setprio 2
    s_add_u32 s58, s49, 2
    s_mov_b32 s40, 0
recurrent_scan__mha_block__glu_gated_geglu__prompt_kernel_gw_17:
    ds_read_b128 v[224:227], v212
    s_add_u32 s40, s40, 1
    s_cmp_ge_u32 s40, 0x100000
    s_cbranch_scc1 recurrent_scan__mha_block__glu_gated_geglu__prompt_kernel_gw_17_x
    s_waitcnt lgkmcnt(0)
    v_min3_u32 v224, v224, v225, v226
    v_min_u32 v224, v224, v227
    s_nop 0
    v_readfirstlane_b32 s39, v224
    s_cmp_ge_u32 s39, s58
    s_cbranch_scc1 recurrent_scan__mha_block__glu_gated_geglu__prompt_kernel_gw_17_x
    s_sleep 1
    s_branch recurrent_scan__mha_block__glu_gated_geglu__prompt_kernel_gw_17
recurrent_scan__mha_block__glu_gated_geglu__prompt_kernel_gw_17_x:
    s_waitcnt lgkmcnt(0)
    s_add_u32 s35, s35, 49152
    s_cmp_eq_u32 s35, 147456
    s_cselect_b32 s35, 0, s35
    v_add_u32 v10, s35, v8
    v_add_u32 v11, s35, v9
    ds_read_b128 v[144:147], v10 offset:0
    ds_read_b128 v[148:151], v10 offset:4096
    ds_read_b128 v[152:155], v10 offset:8192
    ds_read_b128 v[156:159], v10 offset:12288
    ds_read_b64_tr_b16 v[160:161], v11 offset:0
    ds_read_b64_tr_b16 v[162:163], v11 offset:512
    ds_read_b64_tr_b16 v[164:165], v11 offset:8192
    ds_read_b64_tr_b16 v[166:167], v11 offset:8704
    s_add_u32 s49, s49, 1
    s_branch recurrent_scan__mha_block__glu_gated_geglu__prompt_kernel_gu_loop
recurrent_scan__mha_block__glu_gated_geglu__prompt_kernel_gu_last:
    s_setprio 2
    v_mfma_f32_32x32x16_bf16 v[16:31], v[184:187], v[168:171], v[16:31]
    v_mfma_f32_32x32x16_bf16 v[32:47], v[188:191], v[168:171], v[32:47]
    s_setprio 0
    v_mfma_f32_32x32x16_bf16 v[48:63], v[184:187], v[172:175], v[48:63]
    v_mfma_f32_32x32x16_bf16 v[64:79], v[188:191], v[172:175], v[64:79]
    v_mfma_f32_32x32x16_bf16 v[80:95], v[184:187], v[176:179], v[80:95]
    v_mfma_f32_32x32x16_bf16 v[96:111], v[188:191], v[176:179], v[96:111]
    v_mfma_f32_32x32x16_bf16 v[112:127], v[184:187], v[180:183], v[112:127]
    v_mfma_f32_32x32x16_bf16 v[128:143], v[188:191], v[180:183], v[128:143]
    s_setprio 2
    s_mov_b32 s40, 0xbdd2d3e8
    v_mov_b32 v3, 0xc0135761
    s_mov_b32 s90, 0xbdd2d3e8
    s_mov_b32 s91, 0xbdd2d3e8
    v_mov_b32 v2, 0xc0135761
    s_nop 3
    v_pk_mul_f32 v[144:145], v[16:17], v[16:17]
    v_pk_mul_f32 v[146:147], v[18:19], v[18:19]
    v_pk_mul_f32 v[148:149], v[20:21], v[20:21]
    v_pk_mul_f32 v[150:151], v[22:23], v[22:23]
    v_pk_fma_f32 v[144:145], v[144:145], s[90:91], v[2:3]
    v_pk_fma_f32 v[146:147], v[146:147], s[90:91], v[2:3]
    v_pk_fma_f32 v[148:149], v[148:149], s[90:91], v[2:3]
    v_pk_fma_f32 v[150:151], v[150:151], s[90:91], v[2:3]
    v_pk_mul_f32 v[144:145], v[144:145], v[16:17]
    v_pk_mul_f32 v[146:147], v[146:147], v[18:19]
    v_pk_mul_f32 v[148:149], v[148:149], v[20:21]
    v_pk_mul_f32 v[150:151], v[150:151], v[22:23]
    v_exp_f32 v144, v144
    v_exp_f32 v145, v145
    v_exp_f32 v146, v146
    v_exp_f32 v147, v147
    v_exp_f32 v148, v148
    v_exp_f32 v149, v149
    v_exp_f32 v150, v150
    v_exp_f32 v151, v151
    v_pk_mul_f32 v[32:33], v[32:33], v[16:17]
    v_pk_mul_f32 v[34:35], v[34:35], v[18:19]
    v_pk_mul_f32 v[36:37], v[36:37], v[20:21]
    v_pk_mul_f32 v[38:39], v[38:39], v[22:23]
    v_pk_add_f32 v[144:145], v[144:145], 1.0 op_sel_hi:[1,0]
    v_pk_add_f32 v[146:147], v[146:147], 1.0 op_sel_hi:[1,0]
    v_pk_add_f32 v[148:149], v[148:149], 1.0 op_sel_hi:[1,0]
    v_pk_add_f32 v[150:151], v[150:151], 1.0 op_sel_hi:[1,0]
    v_rcp_f32 v144, v144
    v_rcp_f32 v145, v145
    v_rcp_f32 v146, v146
    v_rcp_f32 v147, v147
    v_rcp_f32 v148, v148
    v_rcp_f32 v149, v149
    v_rcp_f32 v150, v150
    v_rcp_f32 v151, v151
    s_nop 0
    v_pk_mul_f32 v[32:33], v[32:33], v[144:145]
    v_pk_mul_f32 v[34:35], v[34:35], v[146:147]
    v_pk_mul_f32 v[36:37], v[36:37], v[148:149]
    v_pk_mul_f32 v[38:39], v[38:39], v[150:151]
    v_cvt_pk_bf16_f32 v16, v32, v33
    v_cvt_pk_bf16_f32 v17, v34, v35
    v_cvt_pk_bf16_f32 v18, v36, v37
    v_cvt_pk_bf16_f32 v19, v38, v39
    s_lshl_b32 s38, s76, 3
    s_lshl_b32 s39, s29, 2
    s_add_u32 s38, s38, s39
    s_add_u32 s38, s38, 0
    s_mul_i32 s38, s38, 108
    s_lshl_b32 s39, s77, 2
    s_add_u32 s38, s38, s39
    s_lshl_b32 s39, s30, 1
    s_add_u32 s38, s38, s39
    s_add_u32 s38, s38, 0
    s_lshl_b32 s38, s38, 10
    s_setprio 0
    buffer_store_dwordx4 v[16:19], v7, s[24:27], s38 offen sc0 sc1
    s_setprio 2
    v_pk_mul_f32 v[144:145], v[24:25], v[24:25]
    v_pk_mul_f32 v[146:147], v[26:27], v[26:27]
    v_pk_mul_f32 v[148:149], v[28:29], v[28:29]
    v_pk_mul_f32 v[150:151], v[30:31], v[30:31]
    v_pk_fma_f32 v[144:145], v[144:145], s[90:91], v[2:3]
    v_pk_fma_f32 v[146:147], v[146:147], s[90:91], v[2:3]
    v_pk_fma_f32 v[148:149], v[148:149], s[90:91], v[2:3]
    v_pk_fma_f32 v[150:151], v[150:151], s[90:91], v[2:3]
    v_pk_mul_f32 v[144:145], v[144:145], v[24:25]
    v_pk_mul_f32 v[146:147], v[146:147], v[26:27]
    v_pk_mul_f32 v[148:149], v[148:149], v[28:29]
    v_pk_mul_f32 v[150:151], v[150:151], v[30:31]
    v_exp_f32 v144, v144
    v_exp_f32 v145, v145
    v_exp_f32 v146, v146
    v_exp_f32 v147, v147
    v_exp_f32 v148, v148
    v_exp_f32 v149, v149
    v_exp_f32 v150, v150
    v_exp_f32 v151, v151
    v_pk_mul_f32 v[40:41], v[40:41], v[24:25]
    v_pk_mul_f32 v[42:43], v[42:43], v[26:27]
    v_pk_mul_f32 v[44:45], v[44:45], v[28:29]
    v_pk_mul_f32 v[46:47], v[46:47], v[30:31]
    v_pk_add_f32 v[144:145], v[144:145], 1.0 op_sel_hi:[1,0]
    v_pk_add_f32 v[146:147], v[146:147], 1.0 op_sel_hi:[1,0]
    v_pk_add_f32 v[148:149], v[148:149], 1.0 op_sel_hi:[1,0]
    v_pk_add_f32 v[150:151], v[150:151], 1.0 op_sel_hi:[1,0]
    v_rcp_f32 v144, v144
    v_rcp_f32 v145, v145
    v_rcp_f32 v146, v146
    v_rcp_f32 v147, v147
    v_rcp_f32 v148, v148
    v_rcp_f32 v149, v149
    v_rcp_f32 v150, v150
    v_rcp_f32 v151, v151
    s_nop 0
    v_pk_mul_f32 v[40:41], v[40:41], v[144:145]
    v_pk_mul_f32 v[42:43], v[42:43], v[146:147]
    v_pk_mul_f32 v[44:45], v[44:45], v[148:149]
    v_pk_mul_f32 v[46:47], v[46:47], v[150:151]
    v_cvt_pk_bf16_f32 v24, v40, v41
    v_cvt_pk_bf16_f32 v25, v42, v43
    v_cvt_pk_bf16_f32 v26, v44, v45
    v_cvt_pk_bf16_f32 v27, v46, v47
    s_lshl_b32 s38, s76, 3
    s_lshl_b32 s39, s29, 2
    s_add_u32 s38, s38, s39
    s_add_u32 s38, s38, 0
    s_mul_i32 s38, s38, 108
    s_lshl_b32 s39, s77, 2
    s_add_u32 s38, s38, s39
    s_lshl_b32 s39, s30, 1
    s_add_u32 s38, s38, s39
    s_add_u32 s38, s38, 1
    s_lshl_b32 s38, s38, 10
    s_setprio 0
    buffer_store_dwordx4 v[24:27], v7, s[24:27], s38 offen sc0 sc1
    s_setprio 2
    v_pk_mul_f32 v[144:145], v[48:49], v[48:49]
    v_pk_mul_f32 v[146:147], v[50:51], v[50:51]
    v_pk_mul_f32 v[148:149], v[52:53], v[52:53]
    v_pk_mul_f32 v[150:151], v[54:55], v[54:55]
    v_pk_fma_f32 v[144:145], v[144:145], s[90:91], v[2:3]
    v_pk_fma_f32 v[146:147], v[146:147], s[90:91], v[2:3]
    v_pk_fma_f32 v[148:149], v[148:149], s[90:91], v[2:3]
    v_pk_fma_f32 v[150:151], v[150:151], s[90:91], v[2:3]
    v_pk_mul_f32 v[144:145], v[144:145], v[48:49]
    v_pk_mul_f32 v[146:147], v[146:147], v[50:51]
    v_pk_mul_f32 v[148:149], v[148:149], v[52:53]
    v_pk_mul_f32 v[150:151], v[150:151], v[54:55]
    v_exp_f32 v144, v144
    v_exp_f32 v145, v145
    v_exp_f32 v146, v146
    v_exp_f32 v147, v147
    v_exp_f32 v148, v148
    v_exp_f32 v149, v149
    v_exp_f32 v150, v150
    v_exp_f32 v151, v151
    v_pk_mul_f32 v[64:65], v[64:65], v[48:49]
    v_pk_mul_f32 v[66:67], v[66:67], v[50:51]
    v_pk_mul_f32 v[68:69], v[68:69], v[52:53]
    v_pk_mul_f32 v[70:71], v[70:71], v[54:55]
    v_pk_add_f32 v[144:145], v[144:145], 1.0 op_sel_hi:[1,0]
    v_pk_add_f32 v[146:147], v[146:147], 1.0 op_sel_hi:[1,0]
    v_pk_add_f32 v[148:149], v[148:149], 1.0 op_sel_hi:[1,0]
    v_pk_add_f32 v[150:151], v[150:151], 1.0 op_sel_hi:[1,0]
    v_rcp_f32 v144, v144
    v_rcp_f32 v145, v145
    v_rcp_f32 v146, v146
    v_rcp_f32 v147, v147
    v_rcp_f32 v148, v148
    v_rcp_f32 v149, v149
    v_rcp_f32 v150, v150
    v_rcp_f32 v151, v151
    s_nop 0
    v_pk_mul_f32 v[64:65], v[64:65], v[144:145]
    v_pk_mul_f32 v[66:67], v[66:67], v[146:147]
    v_pk_mul_f32 v[68:69], v[68:69], v[148:149]
    v_pk_mul_f32 v[70:71], v[70:71], v[150:151]
    v_cvt_pk_bf16_f32 v48, v64, v65
    v_cvt_pk_bf16_f32 v49, v66, v67
    v_cvt_pk_bf16_f32 v50, v68, v69
    v_cvt_pk_bf16_f32 v51, v70, v71
    s_lshl_b32 s38, s76, 3
    s_lshl_b32 s39, s29, 2
    s_add_u32 s38, s38, s39
    s_add_u32 s38, s38, 1
    s_mul_i32 s38, s38, 108
    s_lshl_b32 s39, s77, 2
    s_add_u32 s38, s38, s39
    s_lshl_b32 s39, s30, 1
    s_add_u32 s38, s38, s39
    s_add_u32 s38, s38, 0
    s_lshl_b32 s38, s38, 10
    s_setprio 0
    buffer_store_dwordx4 v[48:51], v7, s[24:27], s38 offen sc0 sc1
    s_setprio 2
    v_pk_mul_f32 v[144:145], v[56:57], v[56:57]
    v_pk_mul_f32 v[146:147], v[58:59], v[58:59]
    v_pk_mul_f32 v[148:149], v[60:61], v[60:61]
    v_pk_mul_f32 v[150:151], v[62:63], v[62:63]
    v_pk_fma_f32 v[144:145], v[144:145], s[90:91], v[2:3]
    v_pk_fma_f32 v[146:147], v[146:147], s[90:91], v[2:3]
    v_pk_fma_f32 v[148:149], v[148:149], s[90:91], v[2:3]
    v_pk_fma_f32 v[150:151], v[150:151], s[90:91], v[2:3]
    v_pk_mul_f32 v[144:145], v[144:145], v[56:57]
    v_pk_mul_f32 v[146:147], v[146:147], v[58:59]
    v_pk_mul_f32 v[148:149], v[148:149], v[60:61]
    v_pk_mul_f32 v[150:151], v[150:151], v[62:63]
    v_exp_f32 v144, v144
    v_exp_f32 v145, v145
    v_exp_f32 v146, v146
    v_exp_f32 v147, v147
    v_exp_f32 v148, v148
    v_exp_f32 v149, v149
    v_exp_f32 v150, v150
    v_exp_f32 v151, v151
    v_pk_mul_f32 v[72:73], v[72:73], v[56:57]
    v_pk_mul_f32 v[74:75], v[74:75], v[58:59]
    v_pk_mul_f32 v[76:77], v[76:77], v[60:61]
    v_pk_mul_f32 v[78:79], v[78:79], v[62:63]
    v_pk_add_f32 v[144:145], v[144:145], 1.0 op_sel_hi:[1,0]
    v_pk_add_f32 v[146:147], v[146:147], 1.0 op_sel_hi:[1,0]
    v_pk_add_f32 v[148:149], v[148:149], 1.0 op_sel_hi:[1,0]
    v_pk_add_f32 v[150:151], v[150:151], 1.0 op_sel_hi:[1,0]
    v_rcp_f32 v144, v144
    v_rcp_f32 v145, v145
    v_rcp_f32 v146, v146
    v_rcp_f32 v147, v147
    v_rcp_f32 v148, v148
    v_rcp_f32 v149, v149
    v_rcp_f32 v150, v150
    v_rcp_f32 v151, v151
    s_nop 0
    v_pk_mul_f32 v[72:73], v[72:73], v[144:145]
    v_pk_mul_f32 v[74:75], v[74:75], v[146:147]
    v_pk_mul_f32 v[76:77], v[76:77], v[148:149]
    v_pk_mul_f32 v[78:79], v[78:79], v[150:151]
    v_cvt_pk_bf16_f32 v56, v72, v73
    v_cvt_pk_bf16_f32 v57, v74, v75
    v_cvt_pk_bf16_f32 v58, v76, v77
    v_cvt_pk_bf16_f32 v59, v78, v79
    s_lshl_b32 s38, s76, 3
    s_lshl_b32 s39, s29, 2
    s_add_u32 s38, s38, s39
    s_add_u32 s38, s38, 1
    s_mul_i32 s38, s38, 108
    s_lshl_b32 s39, s77, 2
    s_add_u32 s38, s38, s39
    s_lshl_b32 s39, s30, 1
    s_add_u32 s38, s38, s39
    s_add_u32 s38, s38, 1
    s_lshl_b32 s38, s38, 10
    s_setprio 0
    buffer_store_dwordx4 v[56:59], v7, s[24:27], s38 offen sc0 sc1
    s_setprio 2
    v_pk_mul_f32 v[144:145], v[80:81], v[80:81]
    v_pk_mul_f32 v[146:147], v[82:83], v[82:83]
    v_pk_mul_f32 v[148:149], v[84:85], v[84:85]
    v_pk_mul_f32 v[150:151], v[86:87], v[86:87]
    v_pk_fma_f32 v[144:145], v[144:145], s[90:91], v[2:3]
    v_pk_fma_f32 v[146:147], v[146:147], s[90:91], v[2:3]
    v_pk_fma_f32 v[148:149], v[148:149], s[90:91], v[2:3]
    v_pk_fma_f32 v[150:151], v[150:151], s[90:91], v[2:3]
    v_pk_mul_f32 v[144:145], v[144:145], v[80:81]
    v_pk_mul_f32 v[146:147], v[146:147], v[82:83]
    v_pk_mul_f32 v[148:149], v[148:149], v[84:85]
    v_pk_mul_f32 v[150:151], v[150:151], v[86:87]
    v_exp_f32 v144, v144
    v_exp_f32 v145, v145
    v_exp_f32 v146, v146
    v_exp_f32 v147, v147
    v_exp_f32 v148, v148
    v_exp_f32 v149, v149
    v_exp_f32 v150, v150
    v_exp_f32 v151, v151
    v_pk_mul_f32 v[96:97], v[96:97], v[80:81]
    v_pk_mul_f32 v[98:99], v[98:99], v[82:83]
    v_pk_mul_f32 v[100:101], v[100:101], v[84:85]
    v_pk_mul_f32 v[102:103], v[102:103], v[86:87]
    v_pk_add_f32 v[144:145], v[144:145], 1.0 op_sel_hi:[1,0]
    v_pk_add_f32 v[146:147], v[146:147], 1.0 op_sel_hi:[1,0]
    v_pk_add_f32 v[148:149], v[148:149], 1.0 op_sel_hi:[1,0]
    v_pk_add_f32 v[150:151], v[150:151], 1.0 op_sel_hi:[1,0]
    v_rcp_f32 v144, v144
    v_rcp_f32 v145, v145
    v_rcp_f32 v146, v146
    v_rcp_f32 v147, v147
    v_rcp_f32 v148, v148
    v_rcp_f32 v149, v149
    v_rcp_f32 v150, v150
    v_rcp_f32 v151, v151
    s_nop 0
    v_pk_mul_f32 v[96:97], v[96:97], v[144:145]
    v_pk_mul_f32 v[98:99], v[98:99], v[146:147]
    v_pk_mul_f32 v[100:101], v[100:101], v[148:149]
    v_pk_mul_f32 v[102:103], v[102:103], v[150:151]
    v_cvt_pk_bf16_f32 v80, v96, v97
    v_cvt_pk_bf16_f32 v81, v98, v99
    v_cvt_pk_bf16_f32 v82, v100, v101
    v_cvt_pk_bf16_f32 v83, v102, v103
    s_lshl_b32 s38, s76, 3
    s_lshl_b32 s39, s29, 2
    s_add_u32 s38, s38, s39
    s_add_u32 s38, s38, 2
    s_mul_i32 s38, s38, 108
    s_lshl_b32 s39, s77, 2
    s_add_u32 s38, s38, s39
    s_lshl_b32 s39, s30, 1
    s_add_u32 s38, s38, s39
    s_add_u32 s38, s38, 0
    s_lshl_b32 s38, s38, 10
    s_setprio 0
    buffer_store_dwordx4 v[80:83], v7, s[24:27], s38 offen sc0 sc1
    s_setprio 2
    v_pk_mul_f32 v[144:145], v[88:89], v[88:89]
    v_pk_mul_f32 v[146:147], v[90:91], v[90:91]
    v_pk_mul_f32 v[148:149], v[92:93], v[92:93]
    v_pk_mul_f32 v[150:151], v[94:95], v[94:95]
    v_pk_fma_f32 v[144:145], v[144:145], s[90:91], v[2:3]
    v_pk_fma_f32 v[146:147], v[146:147], s[90:91], v[2:3]
    v_pk_fma_f32 v[148:149], v[148:149], s[90:91], v[2:3]
    v_pk_fma_f32 v[150:151], v[150:151], s[90:91], v[2:3]
    v_pk_mul_f32 v[144:145], v[144:145], v[88:89]
    v_pk_mul_f32 v[146:147], v[146:147], v[90:91]
    v_pk_mul_f32 v[148:149], v[148:149], v[92:93]
    v_pk_mul_f32 v[150:151], v[150:151], v[94:95]
    v_exp_f32 v144, v144
    v_exp_f32 v145, v145
    v_exp_f32 v146, v146
    v_exp_f32 v147, v147
    v_exp_f32 v148, v148
    v_exp_f32 v149, v149
    v_exp_f32 v150, v150
    v_exp_f32 v151, v151
    v_pk_mul_f32 v[104:105], v[104:105], v[88:89]
    v_pk_mul_f32 v[106:107], v[106:107], v[90:91]
    v_pk_mul_f32 v[108:109], v[108:109], v[92:93]
    v_pk_mul_f32 v[110:111], v[110:111], v[94:95]
    v_pk_add_f32 v[144:145], v[144:145], 1.0 op_sel_hi:[1,0]
    v_pk_add_f32 v[146:147], v[146:147], 1.0 op_sel_hi:[1,0]
    v_pk_add_f32 v[148:149], v[148:149], 1.0 op_sel_hi:[1,0]
    v_pk_add_f32 v[150:151], v[150:151], 1.0 op_sel_hi:[1,0]
    v_rcp_f32 v144, v144
    v_rcp_f32 v145, v145
    v_rcp_f32 v146, v146
    v_rcp_f32 v147, v147
    v_rcp_f32 v148, v148
    v_rcp_f32 v149, v149
    v_rcp_f32 v150, v150
    v_rcp_f32 v151, v151
    s_nop 0
    v_pk_mul_f32 v[104:105], v[104:105], v[144:145]
    v_pk_mul_f32 v[106:107], v[106:107], v[146:147]
    v_pk_mul_f32 v[108:109], v[108:109], v[148:149]
    v_pk_mul_f32 v[110:111], v[110:111], v[150:151]
    v_cvt_pk_bf16_f32 v88, v104, v105
    v_cvt_pk_bf16_f32 v89, v106, v107
    v_cvt_pk_bf16_f32 v90, v108, v109
    v_cvt_pk_bf16_f32 v91, v110, v111
    s_lshl_b32 s38, s76, 3
    s_lshl_b32 s39, s29, 2
    s_add_u32 s38, s38, s39
    s_add_u32 s38, s38, 2
    s_mul_i32 s38, s38, 108
    s_lshl_b32 s39, s77, 2
    s_add_u32 s38, s38, s39
    s_lshl_b32 s39, s30, 1
    s_add_u32 s38, s38, s39
    s_add_u32 s38, s38, 1
    s_lshl_b32 s38, s38, 10
    s_setprio 0
    buffer_store_dwordx4 v[88:91], v7, s[24:27], s38 offen sc0 sc1
    s_setprio 2
    v_pk_mul_f32 v[144:145], v[112:113], v[112:113]
    v_pk_mul_f32 v[146:147], v[114:115], v[114:115]
    v_pk_mul_f32 v[148:149], v[116:117], v[116:117]
    v_pk_mul_f32 v[150:151], v[118:119], v[118:119]
    v_pk_fma_f32 v[144:145], v[144:145], s[90:91], v[2:3]
    v_pk_fma_f32 v[146:147], v[146:147], s[90:91], v[2:3]
    v_pk_fma_f32 v[148:149], v[148:149], s[90:91], v[2:3]
    v_pk_fma_f32 v[150:151], v[150:151], s[90:91], v[2:3]
    v_pk_mul_f32 v[144:145], v[144:145], v[112:113]
    v_pk_mul_f32 v[146:147], v[146:147], v[114:115]
    v_pk_mul_f32 v[148:149], v[148:149], v[116:117]
    v_pk_mul_f32 v[150:151], v[150:151], v[118:119]
    v_exp_f32 v144, v144
    v_exp_f32 v145, v145
    v_exp_f32 v146, v146
    v_exp_f32 v147, v147
    v_exp_f32 v148, v148
    v_exp_f32 v149, v149
    v_exp_f32 v150, v150
    v_exp_f32 v151, v151
    v_pk_mul_f32 v[128:129], v[128:129], v[112:113]
    v_pk_mul_f32 v[130:131], v[130:131], v[114:115]
    v_pk_mul_f32 v[132:133], v[132:133], v[116:117]
    v_pk_mul_f32 v[134:135], v[134:135], v[118:119]
    v_pk_add_f32 v[144:145], v[144:145], 1.0 op_sel_hi:[1,0]
    v_pk_add_f32 v[146:147], v[146:147], 1.0 op_sel_hi:[1,0]
    v_pk_add_f32 v[148:149], v[148:149], 1.0 op_sel_hi:[1,0]
    v_pk_add_f32 v[150:151], v[150:151], 1.0 op_sel_hi:[1,0]
    v_rcp_f32 v144, v144
    v_rcp_f32 v145, v145
    v_rcp_f32 v146, v146
    v_rcp_f32 v147, v147
    v_rcp_f32 v148, v148
    v_rcp_f32 v149, v149
    v_rcp_f32 v150, v150
    v_rcp_f32 v151, v151
    s_nop 0
    v_pk_mul_f32 v[128:129], v[128:129], v[144:145]
    v_pk_mul_f32 v[130:131], v[130:131], v[146:147]
    v_pk_mul_f32 v[132:133], v[132:133], v[148:149]
    v_pk_mul_f32 v[134:135], v[134:135], v[150:151]
    v_cvt_pk_bf16_f32 v112, v128, v129
    v_cvt_pk_bf16_f32 v113, v130, v131
    v_cvt_pk_bf16_f32 v114, v132, v133
    v_cvt_pk_bf16_f32 v115, v134, v135
    s_lshl_b32 s38, s76, 3
    s_lshl_b32 s39, s29, 2
    s_add_u32 s38, s38, s39
    s_add_u32 s38, s38, 3
    s_mul_i32 s38, s38, 108
    s_lshl_b32 s39, s77, 2
    s_add_u32 s38, s38, s39
    s_lshl_b32 s39, s30, 1
    s_add_u32 s38, s38, s39
    s_add_u32 s38, s38, 0
    s_lshl_b32 s38, s38, 10
    s_setprio 0
    buffer_store_dwordx4 v[112:115], v7, s[24:27], s38 offen sc0 sc1
    s_setprio 2
    v_pk_mul_f32 v[144:145], v[120:121], v[120:121]
    v_pk_mul_f32 v[146:147], v[122:123], v[122:123]
    v_pk_mul_f32 v[148:149], v[124:125], v[124:125]
    v_pk_mul_f32 v[150:151], v[126:127], v[126:127]
    v_pk_fma_f32 v[144:145], v[144:145], s[90:91], v[2:3]
    v_pk_fma_f32 v[146:147], v[146:147], s[90:91], v[2:3]
    v_pk_fma_f32 v[148:149], v[148:149], s[90:91], v[2:3]
    v_pk_fma_f32 v[150:151], v[150:151], s[90:91], v[2:3]
    v_pk_mul_f32 v[144:145], v[144:145], v[120:121]
    v_pk_mul_f32 v[146:147], v[146:147], v[122:123]
    v_pk_mul_f32 v[148:149], v[148:149], v[124:125]
    v_pk_mul_f32 v[150:151], v[150:151], v[126:127]
    v_exp_f32 v144, v144
    v_exp_f32 v145, v145
    v_exp_f32 v146, v146
    v_exp_f32 v147, v147
    v_exp_f32 v148, v148
    v_exp_f32 v149, v149
    v_exp_f32 v150, v150
    v_exp_f32 v151, v151
    v_pk_mul_f32 v[136:137], v[136:137], v[120:121]
    v_pk_mul_f32 v[138:139], v[138:139], v[122:123]
    v_pk_mul_f32 v[140:141], v[140:141], v[124:125]
    v_pk_mul_f32 v[142:143], v[142:143], v[126:127]
    v_pk_add_f32 v[144:145], v[144:145], 1.0 op_sel_hi:[1,0]
    v_pk_add_f32 v[146:147], v[146:147], 1.0 op_sel_hi:[1,0]
    v_pk_add_f32 v[148:149], v[148:149], 1.0 op_sel_hi:[1,0]
    v_pk_add_f32 v[150:151], v[150:151], 1.0 op_sel_hi:[1,0]
    v_rcp_f32 v144, v144
    v_rcp_f32 v145, v145
    v_rcp_f32 v146, v146
    v_rcp_f32 v147, v147
    v_rcp_f32 v148, v148
    v_rcp_f32 v149, v149
    v_rcp_f32 v150, v150
    v_rcp_f32 v151, v151
    s_nop 0
    v_pk_mul_f32 v[136:137], v[136:137], v[144:145]
    v_pk_mul_f32 v[138:139], v[138:139], v[146:147]
    v_pk_mul_f32 v[140:141], v[140:141], v[148:149]
    v_pk_mul_f32 v[142:143], v[142:143], v[150:151]
    v_cvt_pk_bf16_f32 v120, v136, v137
    v_cvt_pk_bf16_f32 v121, v138, v139
    v_cvt_pk_bf16_f32 v122, v140, v141
    v_cvt_pk_bf16_f32 v123, v142, v143
    s_lshl_b32 s38, s76, 3
    s_lshl_b32 s39, s29, 2
    s_add_u32 s38, s38, s39
    s_add_u32 s38, s38, 3
    s_mul_i32 s38, s38, 108
    s_lshl_b32 s39, s77, 2
    s_add_u32 s38, s38, s39
    s_lshl_b32 s39, s30, 1
    s_add_u32 s38, s38, s39
    s_add_u32 s38, s38, 1
    s_lshl_b32 s38, s38, 10
    s_setprio 0
    buffer_store_dwordx4 v[120:123], v7, s[24:27], s38 offen sc0 sc1
    s_setprio 2
    s_mov_b32 s78, 1
    s_branch recurrent_scan__mha_block__glu_gated_geglu__prompt_kernel_gu_skip
recurrent_scan__mha_block__glu_gated_geglu__prompt_kernel_gu_none:
    s_waitcnt vmcnt(0)
    s_add_u32 s33, s33, 4
    s_mov_b64 exec, 1
    ds_add_u32 v216, v217
    s_mov_b64 exec, -1
    s_mov_b32 s57, 0
recurrent_scan__mha_block__glu_gated_geglu__prompt_kernel_sw_18:
    ds_read_b32 v218, v216
    s_add_u32 s57, s57, 1
    s_cmp_ge_u32 s57, 0x100000
    s_cbranch_scc1 recurrent_scan__mha_block__glu_gated_geglu__prompt_kernel_sw_18_x
    s_waitcnt lgkmcnt(0)
    v_readfirstlane_b32 s38, v218
    s_cmp_ge_u32 s38, s33
    s_cbranch_scc1 recurrent_scan__mha_block__glu_gated_geglu__prompt_kernel_sw_18_x
    s_sleep 1
    s_branch recurrent_scan__mha_block__glu_gated_geglu__prompt_kernel_sw_18
recurrent_scan__mha_block__glu_gated_geglu__prompt_kernel_sw_18_x:
    s_waitcnt lgkmcnt(0)
    s_cmp_eq_u32 s28, 0
    s_cbranch_scc0 recurrent_scan__mha_block__glu_gated_geglu__prompt_kernel_pq_19
    s_cmp_eq_u32 s58, -1
    s_cbranch_scc1 recurrent_scan__mha_block__glu_gated_geglu__prompt_kernel_pq_19
    s_mov_b32 s38, s58
    s_add_u32 s52, s44, 0x1872000
    s_addc_u32 s53, s45, 0
    s_mov_b32 s54, 0x8000
    s_mov_b32 s55, 0x20000
    s_lshl_b32 s38, s38, 7
    v_mov_b32 v5, s38
    v_mov_b32 v6, s3
    s_mov_b64 exec, 1
    buffer_store_dword v6, v5, s[52:55], 0 offen sc0 sc1
    s_mov_b64 exec, -1
recurrent_scan__mha_block__glu_gated_geglu__prompt_kernel_pq_19:
    s_lshr_b32 s38, s2, 3
    s_and_b32 s39, s2, 7
    s_and_b32 s40, s38, 3
    s_lshl_b32 s92, s40, 3
    s_add_u32 s92, s92, s39
    s_lshl_b32 s93, s40, 1
    s_and_b32 s39, s39, 1
    s_add_u32 s93, s93, s39
    s_add_u32 s93, s93, 32
    s_lshr_b32 s38, s38, 2
    s_cmp_eq_u32 s38, 7
    s_cselect_b32 s92, s92, s93
    s_lshl_b32 s92, s92, 2
    s_add_u32 s49, s92, s28
recurrent_scan__mha_block__glu_gated_geglu__prompt_kernel_rp_20_top:
    s_cmp_ge_u32 s49, 592
    s_cbranch_scc1 recurrent_scan__mha_block__glu_gated_geglu__prompt_kernel_rp_20
    s_mov_b32 s4, s84
    s_mov_b32 s5, s85
    s_mov_b32 s6, s86
    s_mov_b32 s7, s87
    s_cmp_lt_u32 s49, 432
    s_cselect_b32 s94, 0, 1
    s_sub_u32 s38, s49, 432
    s_cselect_b32 s38, s38, s38
    s_cmp_eq_u32 s94, 0
    s_cselect_b32 s38, s49, s38
    s_cselect_b32 s39, 54, 20
    s_mul_i32 s40, s38, 1214
    s_lshr_b32 s40, s40, 16
    s_mul_i32 s96, s38, 3277
    s_lshr_b32 s96, s96, 16
    s_cmp_eq_u32 s94, 0
    s_cselect_b32 s40, s40, s96
    s_mul_i32 s96, s40, s39
    s_sub_u32 s96, s38, s96
    s_mov_b32 s97, 0
    s_cmp_eq_u32 s94, 1
    s_cselect_b32 s97, 1, 0
    s_cmp_ge_u32 s96, 16
    s_cselect_b32 s98, 2, 1
    s_cmp_eq_u32 s94, 1
    s_cselect_b32 s97, s98, 0
    s_mul_i32 s98, s96, 32
    s_mul_i32 s99, s96, 40
    s_sub_u32 s95, s96, 16
    s_mul_i32 s95, s95, 160
    s_cmp_eq_u32 s97, 1
    s_cselect_b32 s98, s99, s98
    s_cmp_eq_u32 s97, 2
    s_cselect_b32 s98, s95, s98
    s_mul_i32 s98, s98, 1280
    s_mul_i32 s99, s40, 160
    s_add_u32 s98, s98, s99
    v_add_u32 v4, 0, v1
    v_mul_u32_u24 v5, 6554, v4
    v_lshrrev_b32 v5, 16, v5
    v_mul_u32_u24 v2, 10, v5
    v_sub_u32 v2, v4, v2
    v_lshlrev_b32 v2, 4, v2
    v_add_u32 v2, 4096, v2
    v_lshrrev_b32 v3, 4, v5
    v_mul_u32_u24 v6, 20, v3
    v_and_b32 v4, 15, v5
    v_add_u32 v6, v6, v4
    v_mul_u32_u24 v3, 80, v3
    v_bfe_u32 v4, v5, 3, 1
    v_mul_u32_u24 v4, 40, v4
    v_add_u32 v3, v3, v4
    v_bfe_u32 v4, v5, 2, 1
    v_mul_u32_u24 v4, 20, v4
    v_add_u32 v3, v3, v4
    v_and_b32 v4, 3, v5
    v_add_u32 v3, v3, v4
    v_add_u32 v3, 16, v3
    s_cmp_eq_u32 s97, 1
    s_cselect_b64 vcc, -1, 0
    v_cndmask_b32 v5, v5, v6, vcc
    s_cmp_eq_u32 s97, 2
    s_cselect_b64 vcc, -1, 0
    v_cndmask_b32 v5, v5, v3, vcc
    v_mul_u32_u24 v5, 1280, v5
    v_add_u32 v16, v5, v2
    v_add_u32 v4, 64, v1
    v_mul_u32_u24 v5, 6554, v4
    v_lshrrev_b32 v5, 16, v5
    v_mul_u32_u24 v2, 10, v5
    v_sub_u32 v2, v4, v2
    v_lshlrev_b32 v2, 4, v2
    v_add_u32 v2, 3072, v2
    v_lshrrev_b32 v3, 4, v5
    v_mul_u32_u24 v6, 20, v3
    v_and_b32 v4, 15, v5
    v_add_u32 v6, v6, v4
    v_mul_u32_u24 v3, 80, v3
    v_bfe_u32 v4, v5, 3, 1
    v_mul_u32_u24 v4, 40, v4
    v_add_u32 v3, v3, v4
    v_bfe_u32 v4, v5, 2, 1
    v_mul_u32_u24 v4, 20, v4
    v_add_u32 v3, v3, v4
    v_and_b32 v4, 3, v5
    v_add_u32 v3, v3, v4
    v_add_u32 v3, 16, v3
    s_cmp_eq_u32 s97, 1
    s_cselect_b64 vcc, -1, 0
    v_cndmask_b32 v5, v5, v6, vcc
    s_cmp_eq_u32 s97, 2
    s_cselect_b64 vcc, -1, 0
    v_cndmask_b32 v5, v5, v3, vcc
    v_mul_u32_u24 v5, 1280, v5
    v_add_u32 v17, v5, v2
    v_add_u32 v4, 128, v1
    v_mul_u32_u24 v5, 6554, v4
    v_lshrrev_b32 v5, 16, v5
    v_mul_u32_u24 v2, 10, v5
    v_sub_u32 v2, v4, v2
    v_lshlrev_b32 v2, 4, v2
    v_add_u32 v2, 2048, v2
    v_lshrrev_b32 v3, 4, v5
    v_mul_u32_u24 v6, 20, v3
    v_and_b32 v4, 15, v5
    v_add_u32 v6, v6, v4
    v_mul_u32_u24 v3, 80, v3
    v_bfe_u32 v4, v5, 3, 1
    v_mul_u32_u24 v4, 40, v4
    v_add_u32 v3, v3, v4
    v_bfe_u32 v4, v5, 2, 1
    v_mul_u32_u24 v4, 20, v4
    v_add_u32 v3, v3, v4
    v_and_b32 v4, 3, v5
    v_add_u32 v3, v3, v4
    v_add_u32 v3, 16, v3
    s_cmp_eq_u32 s97, 1
    s_cselect_b64 vcc, -1, 0
    v_cndmask_b32 v5, v5, v6, vcc
    s_cmp_eq_u32 s97, 2
    s_cselect_b64 vcc, -1, 0
    v_cndmask_b32 v5, v5, v3, vcc
    v_mul_u32_u24 v5, 1280, v5
    v_add_u32 v18, v5, v2
    v_add_u32 v4, 192, v1
    v_mul_u32_u24 v5, 6554, v4
    v_lshrrev_b32 v5, 16, v5
    v_mul_u32_u24 v2, 10, v5
    v_sub_u32 v2, v4, v2
    v_lshlrev_b32 v2, 4, v2
    v_add_u32 v2, 1024, v2
    v_lshrrev_b32 v3, 4, v5
    v_mul_u32_u24 v6, 20, v3
    v_and_b32 v4, 15, v5
    v_add_u32 v6, v6, v4
    v_mul_u32_u24 v3, 80, v3
    v_bfe_u32 v4, v5, 3, 1
    v_mul_u32_u24 v4, 40, v4
    v_add_u32 v3, v3, v4
    v_bfe_u32 v4, v5, 2, 1
    v_mul_u32_u24 v4, 20, v4
    v_add_u32 v3, v3, v4
    v_and_b32 v4, 3, v5
    v_add_u32 v3, v3, v4
    v_add_u32 v3, 16, v3
    s_cmp_eq_u32 s97, 1
    s_cselect_b64 vcc, -1, 0
    v_cndmask_b32 v5, v5, v6, vcc
    s_cmp_eq_u32 s97, 2
    s_cselect_b64 vcc, -1, 0
    v_cndmask_b32 v5, v5, v3, vcc
    v_mul_u32_u24 v5, 1280, v5
    v_add_u32 v19, v5, v2
    v_add_u32 v4, 256, v1
    v_mul_u32_u24 v5, 6554, v4
    v_lshrrev_b32 v5, 16, v5
    v_mul_u32_u24 v2, 10, v5
    v_sub_u32 v2, v4, v2
    v_lshlrev_b32 v2, 4, v2
    v_add_u32 v2, 4096, v2
    v_lshrrev_b32 v3, 4, v5
    v_mul_u32_u24 v6, 20, v3
    v_and_b32 v4, 15, v5
    v_add_u32 v6, v6, v4
    v_mul_u32_u24 v3, 80, v3
    v_bfe_u32 v4, v5, 3, 1
    v_mul_u32_u24 v4, 40, v4
    v_add_u32 v3, v3, v4
    v_bfe_u32 v4, v5, 2, 1
    v_mul_u32_u24 v4, 20, v4
    v_add_u32 v3, v3, v4
    v_and_b32 v4, 3, v5
    v_add_u32 v3, v3, v4
    v_add_u32 v3, 16, v3
    s_cmp_eq_u32 s97, 1
    s_cselect_b64 vcc, -1, 0
    v_cndmask_b32 v5, v5, v6, vcc
    s_cmp_eq_u32 s97, 2
    s_cselect_b64 vcc, -1, 0
    v_cndmask_b32 v5, v5, v3, vcc
    v_mul_u32_u24 v5, 1280, v5
    v_add_u32 v20, v5, v2
    s_waitcnt lgkmcnt(0)
    s_cmp_eq_u32 s94, 0
    s_cselect_b32 s4, s4, s6
    s_cselect_b32 s5, s5, s7
    s_mov_b32 s99, 2215936
    s_cselect_b32 s99, s99, 823296
    s_sub_u32 s8, s4, 4096
    s_subb_u32 s9, s5, 0
    s_mov_b32 s10, s99
    s_mov_b32 s11, 0x20000
    s_mul_i32 s95, s28, 5120
    s_add_u32 s95, s95, 0
    s_mov_b32 m0, s95
    s_nop 0
    buffer_load_dwordx4 v16, s[8:11], s98 offen offset:0 lds
    buffer_load_dwordx4 v17, s[8:11], s98 offen offset:1024 lds
    buffer_load_dwordx4 v18, s[8:11], s98 offen offset:2048 lds
    buffer_load_dwordx4 v19, s[8:11], s98 offen offset:3072 lds
    s_add_u32 m0, s95, 4096
    s_nop 0
    buffer_load_dwordx4 v20, s[8:11], s98 offen lds
    v_and_b32 v2, 15, v1
    v_lshrrev_b32 v3, 4, v1
    v_lshrrev_b32 v4, 1, v3
    v_lshlrev_b32 v4, 4, v4
    v_and_b32 v5, 1, v3
    v_lshl_add_u32 v4, v5, 2, v4
    v_lshrrev_b32 v5, 2, v2
    v_add_u32 v4, v4, v5
    v_mul_u32_u24 v4, 160, v4
    v_and_b32 v5, 3, v2
    v_lshl_add_u32 v4, v5, 3, v4
    v_add_u32 v4, s95, v4
    s_add_u32 s52, s44, 0x18ae000
    s_addc_u32 s53, s45, 0
    s_mov_b32 s54, 0x2e4000
    s_mov_b32 s55, 0x20000
    v_lshlrev_b32 v6, 4, v1
    s_mul_i32 s98, s49, 5120
    s_waitcnt vmcnt(0)
    ds_read_b64_tr_b16 v[24:25], v4 offset:0
    ds_read_b64_tr_b16 v[26:27], v4 offset:1280
    ds_read_b64_tr_b16 v[28:29], v4 offset:32
    ds_read_b64_tr_b16 v[30:31], v4 offset:1312
    ds_read_b64_tr_b16 v[32:33], v4 offset:64
    ds_read_b64_tr_b16 v[34:35], v4 offset:1344
    ds_read_b64_tr_b16 v[36:37], v4 offset:96
    ds_read_b64_tr_b16 v[38:39], v4 offset:1376
    ds_read_b64_tr_b16 v[40:41], v4 offset:128
    ds_read_b64_tr_b16 v[42:43], v4 offset:1408
    s_waitcnt lgkmcnt(0)
    buffer_store_dwordx4 v[24:27], v6, s[52:55], s98 offen offset:0 sc0 sc1
    buffer_store_dwordx4 v[28:31], v6, s[52:55], s98 offen offset:1024 sc0 sc1
    buffer_store_dwordx4 v[32:35], v6, s[52:55], s98 offen offset:2048 sc0 sc1
    buffer_store_dwordx4 v[36:39], v6, s[52:55], s98 offen offset:3072 sc0 sc1
    s_add_u32 s98, s98, 4096
    buffer_store_dwordx4 v[40:43], v6, s[52:55], s98 offen sc0 sc1
    s_waitcnt vmcnt(0)
    s_mov_b32 s38, s49
    s_add_u32 s52, s44, 0x189a000
    s_addc_u32 s53, s45, 0
    s_mov_b32 s54, 0x14000
    s_mov_b32 s55, 0x20000
    s_lshl_b32 s38, s38, 7
    v_mov_b32 v5, s38
    v_mov_b32 v6, s3
    s_mov_b64 exec, 1
    buffer_store_dword v6, v5, s[52:55], 0 offen sc0 sc1
    s_mov_b64 exec, -1
    s_add_u32 s49, s49, 160
    s_branch recurrent_scan__mha_block__glu_gated_geglu__prompt_kernel_rp_20_top
recurrent_scan__mha_block__glu_gated_geglu__prompt_kernel_rp_20:
    s_mov_b32 s78, 0
recurrent_scan__mha_block__glu_gated_geglu__prompt_kernel_gu_skip:
    s_and_b32 s38, s2, 7
    s_lshr_b32 s39, s2, 3
    s_lshr_b32 s50, s38, 1
    s_lshl_b32 s50, s50, 3
    s_and_b32 s40, s39, 7
    s_add_u32 s50, s50, s40
    s_and_b32 s51, s38, 1
    s_lshl_b32 s51, s51, 2
    s_lshr_b32 s40, s39, 3
    s_add_u32 s51, s51, s40
    v_and_b32 v2, 15, v1
    v_lshrrev_b32 v3, 4, v1
    v_lshlrev_b32 v8, 4, v2
    v_lshl_add_u32 v8, v3, 9, v8
    v_lshlrev_b32 v9, 4, v1
    s_add_u32 s8, s44, 0x780000
    s_addc_u32 s9, s45, 0
    s_mov_b32 s10, 0x6c0000
    s_mov_b32 s11, 0x20000
    s_add_u32 s12, s44, 0x18ae000
    s_addc_u32 s13, s45, 0
    s_mov_b32 s14, 0x2e4000
    s_mov_b32 s15, 0x20000
    s_mul_i32 s38, s28, 14
    s_lshl_b32 s39, s50, 1
    s_mul_i32 s39, s39, 108
    s_lshl_b32 s40, s38, 1
    s_add_u32 s39, s39, s40
    s_lshl_b32 s35, s39, 10
    s_mul_i32 s34, s51, 54
    s_add_u32 s34, s34, s38
    s_mul_i32 s34, s34, 5120
    s_waitcnt vmcnt(0)
    v_mov_b32 v16, 0
    v_mov_b32 v17, 0
    v_mov_b32 v18, 0
    v_mov_b32 v19, 0
    v_mov_b32 v20, 0
    v_mov_b32 v21, 0
    v_mov_b32 v22, 0
    v_mov_b32 v23, 0
    v_mov_b32 v24, 0
    v_mov_b32 v25, 0
    v_mov_b32 v26, 0
    v_mov_b32 v27, 0
    v_mov_b32 v28, 0
    v_mov_b32 v29, 0
    v_mov_b32 v30, 0
    v_mov_b32 v31, 0
    v_mov_b32 v32, 0
    v_mov_b32 v33, 0
    v_mov_b32 v34, 0
    v_mov_b32 v35, 0
    v_mov_b32 v36, 0
    v_mov_b32 v37, 0
    v_mov_b32 v38, 0
    v_mov_b32 v39, 0
    v_mov_b32 v40, 0
    v_mov_b32 v41, 0
    v_mov_b32 v42, 0
    v_mov_b32 v43, 0
    v_mov_b32 v44, 0
    v_mov_b32 v45, 0
    v_mov_b32 v46, 0
    v_mov_b32 v47, 0
    v_mov_b32 v48, 0
    v_mov_b32 v49, 0
    v_mov_b32 v50, 0
    v_mov_b32 v51, 0
    v_mov_b32 v52, 0
    v_mov_b32 v53, 0
    v_mov_b32 v54, 0
    v_mov_b32 v55, 0
    v_mov_b32 v56, 0
    v_mov_b32 v57, 0
    v_mov_b32 v58, 0
    v_mov_b32 v59, 0
    v_mov_b32 v60, 0
    v_mov_b32 v61, 0
    v_mov_b32 v62, 0
    v_mov_b32 v63, 0
    v_mov_b32 v64, 0
    v_mov_b32 v65, 0
    v_mov_b32 v66, 0
    v_mov_b32 v67, 0
    v_mov_b32 v68, 0
    v_mov_b32 v69, 0
    v_mov_b32 v70, 0
    v_mov_b32 v71, 0
    v_mov_b32 v72, 0
    v_mov_b32 v73, 0
    v_mov_b32 v74, 0
    v_mov_b32 v75, 0
    v_mov_b32 v76, 0
    v_mov_b32 v77, 0
    v_mov_b32 v78, 0
    v_mov_b32 v79, 0
    v_mov_b32 v80, 0
    v_mov_b32 v81, 0
    v_mov_b32 v82, 0
    v_mov_b32 v83, 0
    v_mov_b32 v84, 0
    v_mov_b32 v85, 0
    v_mov_b32 v86, 0
    v_mov_b32 v87, 0
    v_mov_b32 v88, 0
    v_mov_b32 v89, 0
    v_mov_b32 v90, 0
    v_mov_b32 v91, 0
    v_mov_b32 v92, 0
    v_mov_b32 v93, 0
    v_mov_b32 v94, 0
    v_mov_b32 v95, 0
    s_add_u32 s33, s33, 4
    s_mov_b64 exec, 1
    ds_add_u32 v216, v217
    s_mov_b64 exec, -1
    s_mov_b32 s57, 0
recurrent_scan__mha_block__glu_gated_geglu__prompt_kernel_sw_21:
    ds_read_b32 v218, v216
    s_add_u32 s57, s57, 1
    s_cmp_ge_u32 s57, 0x100000
    s_cbranch_scc1 recurrent_scan__mha_block__glu_gated_geglu__prompt_kernel_sw_21_x
    s_waitcnt lgkmcnt(0)
    v_readfirstlane_b32 s38, v218
    s_cmp_ge_u32 s38, s33
    s_cbranch_scc1 recurrent_scan__mha_block__glu_gated_geglu__prompt_kernel_sw_21_x
    s_sleep 1
    s_branch recurrent_scan__mha_block__glu_gated_geglu__prompt_kernel_sw_21
recurrent_scan__mha_block__glu_gated_geglu__prompt_kernel_sw_21_x:
    s_waitcnt lgkmcnt(0)
    s_cmp_eq_u32 s28, 0
    s_cbranch_scc0 recurrent_scan__mha_block__glu_gated_geglu__prompt_kernel_nohflag
    s_cmp_eq_u32 s78, 1
    s_cbranch_scc0 recurrent_scan__mha_block__glu_gated_geglu__prompt_kernel_nohflag
    s_lshl_b32 s38, s76, 5
    s_add_u32 s38, s38, s77
    s_add_u32 s52, s44, 0x1840000
    s_addc_u32 s53, s45, 0
    s_mov_b32 s54, 0x8000
    s_mov_b32 s55, 0x20000
    s_lshl_b32 s38, s38, 7
    v_mov_b32 v2, s38
    v_mov_b32 v3, s3
    s_mov_b64 exec, 1
    buffer_store_dword v3, v2, s[52:55], 0 offen sc0 sc1
    s_mov_b64 exec, -1
recurrent_scan__mha_block__glu_gated_geglu__prompt_kernel_nohflag:
    v_mov_b32 v2, 147488
    s_mov_b64 exec, 1
    ds_add_u32 v2, v217
    s_mov_b64 exec, -1
    s_cmp_eq_u32 s28, 0
    s_cbranch_scc0 recurrent_scan__mha_block__glu_gated_geglu__prompt_kernel_ww_22
    s_add_u32 s52, s44, 0x189a000
    s_addc_u32 s53, s45, 0
    s_mov_b32 s54, 0x14000
    s_mov_b32 s55, 0x20000
    v_min_u32 v2, 53, v1
    s_mul_i32 s38, s51, 54
    v_add_u32 v2, s38, v2
    v_lshlrev_b32 v2, 7, v2
    s_mov_b32 s40, 0
recurrent_scan__mha_block__glu_gated_geglu__prompt_kernel_wpoll_23:
    buffer_load_dword v3, v2, s[52:55], 0 offen sc0 sc1
    s_waitcnt vmcnt(0)
    v_cmp_ne_u32 vcc, s3, v3
    s_nop 1
    s_cmp_eq_u64 vcc, 0
    s_cbranch_scc1 recurrent_scan__mha_block__glu_gated_geglu__prompt_kernel_wpoll_23_ok
    s_sleep 4
    s_add_u32 s40, s40, 1
    s_cmp_lt_u32 s40, 32768
    s_cbranch_scc1 recurrent_scan__mha_block__glu_gated_geglu__prompt_kernel_wpoll_23
recurrent_scan__mha_block__glu_gated_geglu__prompt_kernel_wpoll_23_ok:
    v_min_u32 v2, 19, v1
    s_mul_i32 s38, s51, 20
    s_add_u32 s38, s38, 432
    v_add_u32 v2, s38, v2
    v_lshlrev_b32 v2, 7, v2
    s_mov_b32 s40, 0
recurrent_scan__mha_block__glu_gated_geglu__prompt_kernel_wpoll2_24:
    buffer_load_dword v3, v2, s[52:55], 0 offen sc0 sc1
    s_waitcnt vmcnt(0)
    v_cmp_ne_u32 vcc, s3, v3
    s_nop 1
    s_cmp_eq_u64 vcc, 0
    s_cbranch_scc1 recurrent_scan__mha_block__glu_gated_geglu__prompt_kernel_wpoll2_24_ok
    s_sleep 4
    s_add_u32 s40, s40, 1
    s_cmp_lt_u32 s40, 32768
    s_cbranch_scc1 recurrent_scan__mha_block__glu_gated_geglu__prompt_kernel_wpoll2_24
recurrent_scan__mha_block__glu_gated_geglu__prompt_kernel_wpoll2_24_ok:
recurrent_scan__mha_block__glu_gated_geglu__prompt_kernel_ww_22:
    s_mul_i32 s58, s51, 20
    s_add_u32 s58, s58, 432
    s_mul_i32 s58, s58, 5120
    s_mul_i32 s36, s28, 25600
    s_add_u32 s58, s58, s36
    s_add_u32 s33, s33, 4
    s_mov_b64 exec, 1
    ds_add_u32 v216, v217
    s_mov_b64 exec, -1
    s_mov_b32 s57, 0
recurrent_scan__mha_block__glu_gated_geglu__prompt_kernel_sw_25:
    ds_read_b32 v218, v216
    s_add_u32 s57, s57, 1
    s_cmp_ge_u32 s57, 0x100000
    s_cbranch_scc1 recurrent_scan__mha_block__glu_gated_geglu__prompt_kernel_sw_25_x
    s_waitcnt lgkmcnt(0)
    v_readfirstlane_b32 s38, v218
    s_cmp_ge_u32 s38, s33
    s_cbranch_scc1 recurrent_scan__mha_block__glu_gated_geglu__prompt_kernel_sw_25_x
    s_sleep 1
    s_branch recurrent_scan__mha_block__glu_gated_geglu__prompt_kernel_sw_25
recurrent_scan__mha_block__glu_gated_geglu__prompt_kernel_sw_25_x:
    s_waitcnt lgkmcnt(0)
    s_setprio 0
    s_add_u32 m0, s36, 0
    s_nop 0
    buffer_load_dwordx4 v9, s[12:15], s58 offen offset:0 lds
    buffer_load_dwordx4 v9, s[12:15], s58 offen offset:1024 lds
    buffer_load_dwordx4 v9, s[12:15], s58 offen offset:2048 lds
    buffer_load_dwordx4 v9, s[12:15], s58 offen offset:3072 lds
    s_add_u32 m0, s36, 4096
    s_add_u32 s58, s58, 4096
    buffer_load_dwordx4 v9, s[12:15], s58 offen offset:0 lds
    buffer_load_dwordx4 v9, s[12:15], s58 offen offset:1024 lds
    buffer_load_dwordx4 v9, s[12:15], s58 offen offset:2048 lds
    buffer_load_dwordx4 v9, s[12:15], s58 offen offset:3072 lds
    s_add_u32 m0, s36, 8192
    s_add_u32 s58, s58, 4096
    buffer_load_dwordx4 v9, s[12:15], s58 offen offset:0 lds
    buffer_load_dwordx4 v9, s[12:15], s58 offen offset:1024 lds
    buffer_load_dwordx4 v9, s[12:15], s58 offen offset:2048 lds
    buffer_load_dwordx4 v9, s[12:15], s58 offen offset:3072 lds
    s_add_u32 m0, s36, 12288
    s_add_u32 s58, s58, 4096
    buffer_load_dwordx4 v9, s[12:15], s58 offen offset:0 lds
    buffer_load_dwordx4 v9, s[12:15], s58 offen offset:1024 lds
    buffer_load_dwordx4 v9, s[12:15], s58 offen offset:2048 lds
    buffer_load_dwordx4 v9, s[12:15], s58 offen offset:3072 lds
    s_add_u32 m0, s36, 16384
    s_add_u32 s58, s58, 4096
    buffer_load_dwordx4 v9, s[12:15], s58 offen offset:0 lds
    buffer_load_dwordx4 v9, s[12:15], s58 offen offset:1024 lds
    buffer_load_dwordx4 v9, s[12:15], s58 offen offset:2048 lds
    buffer_load_dwordx4 v9, s[12:15], s58 offen offset:3072 lds
    s_add_u32 m0, s36, 20480
    s_add_u32 s58, s58, 4096
    buffer_load_dwordx4 v9, s[12:15], s58 offen offset:0 lds
    buffer_load_dwordx4 v9, s[12:15], s58 offen offset:1024 lds
    buffer_load_dwordx4 v9, s[12:15], s58 offen offset:2048 lds
    buffer_load_dwordx4 v9, s[12:15], s58 offen offset:3072 lds
    s_add_u32 m0, s36, 24576
    s_add_u32 s58, s58, 4096
    buffer_load_dwordx4 v9, s[12:15], s58 offen offset:0 lds
    s_setprio 2
    s_load_dwordx2 s[6:7], s[0:1], 0
    v_and_b32 v2, 15, v1
    v_lshrrev_b32 v3, 4, v1
    v_mul_u32_u24 v11, 1280, v2
    v_lshl_add_u32 v11, v3, 3, v11
    s_lshl_b32 s38, s50, 6
    s_lshl_b32 s39, s28, 4
    s_add_u32 s38, s38, s39
    s_mul_i32 s38, s38, 1280
    s_mul_i32 s39, s51, 160
    s_add_u32 s59, s38, s39
    s_waitcnt lgkmcnt(0)
    s_mov_b32 s16, s6
    s_mov_b32 s17, s7
    s_mov_b32 s18, 0x280000
    s_mov_b32 s19, 0x20000
    s_mov_b32 s20, s88
    s_mov_b32 s21, s89
    s_mov_b32 s22, 0x280000
    s_mov_b32 s23, 0x20000
    buffer_load_dwordx2 v[224:225], v11, s[16:19], s59 offen offset:0
    buffer_load_dwordx2 v[226:227], v11, s[16:19], s59 offen offset:32
    buffer_load_dwordx2 v[228:229], v11, s[16:19], s59 offen offset:64
    buffer_load_dwordx2 v[230:231], v11, s[16:19], s59 offen offset:96
    buffer_load_dwordx2 v[232:233], v11, s[16:19], s59 offen offset:128
    s_cmp_eq_u32 s28, 0
    s_cbranch_scc0 recurrent_scan__mha_block__glu_gated_geglu__prompt_kernel_hw_26
    s_add_u32 s52, s44, 0x1840000
    s_addc_u32 s53, s45, 0
    s_mov_b32 s54, 0x8000
    s_mov_b32 s55, 0x20000
    s_lshr_b32 s38, s50, 2
    s_lshl_b32 s38, s38, 12
    v_min_u32 v2, 26, v1
    v_lshlrev_b32 v2, 7, v2
    v_add_u32 v2, s38, v2
    s_mov_b32 s40, 0
recurrent_scan__mha_block__glu_gated_geglu__prompt_kernel_hpoll_27:
    buffer_load_dword v3, v2, s[52:55], 0 offen sc0 sc1
    s_waitcnt vmcnt(0)
    v_cmp_ne_u32 vcc, s3, v3
    s_nop 1
    s_cmp_eq_u64 vcc, 0
    s_cbranch_scc1 recurrent_scan__mha_block__glu_gated_geglu__prompt_kernel_hpoll_27_ok
    s_sleep 4
    s_add_u32 s40, s40, 1
    s_cmp_lt_u32 s40, 32768
    s_cbranch_scc1 recurrent_scan__mha_block__glu_gated_geglu__prompt_kernel_hpoll_27
recurrent_scan__mha_block__glu_gated_geglu__prompt_kernel_hpoll_27_ok:
recurrent_scan__mha_block__glu_gated_geglu__prompt_kernel_hw_26:
    s_add_u32 s33, s33, 4
    s_mov_b64 exec, 1
    ds_add_u32 v216, v217
    s_mov_b64 exec, -1
    s_mov_b32 s57, 0
recurrent_scan__mha_block__glu_gated_geglu__prompt_kernel_sw_28:
    ds_read_b32 v218, v216
    s_add_u32 s57, s57, 1
    s_cmp_ge_u32 s57, 0x100000
    s_cbranch_scc1 recurrent_scan__mha_block__glu_gated_geglu__prompt_kernel_sw_28_x
    s_waitcnt lgkmcnt(0)
    v_readfirstlane_b32 s38, v218
    s_cmp_ge_u32 s38, s33
    s_cbranch_scc1 recurrent_scan__mha_block__glu_gated_geglu__prompt_kernel_sw_28_x
    s_sleep 1
    s_branch recurrent_scan__mha_block__glu_gated_geglu__prompt_kernel_sw_28
recurrent_scan__mha_block__glu_gated_geglu__prompt_kernel_sw_28_x:
    s_waitcnt lgkmcnt(0)
    s_setprio 0
    s_add_u32 s47, s35, 110592
    buffer_load_dwordx4 v[96:99], v8, s[8:11], s35 offen offset:0
    buffer_load_dwordx4 v[100:103], v8, s[8:11], s35 offen offset:256
    buffer_load_dwordx4 v[104:107], v8, s[8:11], s47 offen offset:0
    buffer_load_dwordx4 v[108:111], v8, s[8:11], s47 offen offset:256
    buffer_load_dwordx4 v[112:115], v9, s[12:15], s34 offen offset:0
    buffer_load_dwordx4 v[116:119], v9, s[12:15], s34 offen offset:1024
    buffer_load_dwordx4 v[120:123], v9, s[12:15], s34 offen offset:2048
    buffer_load_dwordx4 v[124:127], v9, s[12:15], s34 offen offset:3072
    s_add_u32 s39, s34, 4096
    buffer_load_dwordx4 v[128:131], v9, s[12:15], s39 offen
    s_add_u32 s35, s35, 2048
    s_add_u32 s34, s34, 5120
    s_add_u32 s47, s35, 110592
    buffer_load_dwordx4 v[132:135], v8, s[8:11], s35 offen offset:0
    buffer_load_dwordx4 v[136:139], v8, s[8:11], s35 offen offset:256
    buffer_load_dwordx4 v[140:143], v8, s[8:11], s47 offen offset:0
    buffer_load_dwordx4 v[144:147], v8, s[8:11], s47 offen offset:256
    buffer_load_dwordx4 v[148:151], v9, s[12:15], s34 offen offset:0
    buffer_load_dwordx4 v[152:155], v9, s[12:15], s34 offen offset:1024
    buffer_load_dwordx4 v[156:159], v9, s[12:15], s34 offen offset:2048
    buffer_load_dwordx4 v[160:163], v9, s[12:15], s34 offen offset:3072
    s_add_u32 s39, s34, 4096
    buffer_load_dwordx4 v[164:167], v9, s[12:15], s39 offen
    s_add_u32 s35, s35, 2048
    s_add_u32 s34, s34, 5120
    s_waitcnt vmcnt(9)
    v_mfma_f32_16x16x32_bf16 v[16:19], v[112:115], v[96:99], v[16:19]
    v_mfma_f32_16x16x32_bf16 v[36:39], v[112:115], v[100:103], v[36:39]
    v_mfma_f32_16x16x32_bf16 v[56:59], v[112:115], v[104:107], v[56:59]
    v_mfma_f32_16x16x32_bf16 v[76:79], v[112:115], v[108:111], v[76:79]
    s_add_u32 s47, s35, 110592
    buffer_load_dwordx4 v[168:171], v8, s[8:11], s35 offen offset:0
    buffer_load_dwordx4 v[172:175], v8, s[8:11], s35 offen offset:256
    v_mfma_f32_16x16x32_bf16 v[20:23], v[116:119], v[96:99], v[20:23]
    v_mfma_f32_16x16x32_bf16 v[40:43], v[116:119], v[100:103], v[40:43]
    v_mfma_f32_16x16x32_bf16 v[60:63], v[116:119], v[104:107], v[60:63]
    v_mfma_f32_16x16x32_bf16 v[80:83], v[116:119], v[108:111], v[80:83]
    buffer_load_dwordx4 v[176:179], v8, s[8:11], s47 offen offset:0
    buffer_load_dwordx4 v[180:183], v8, s[8:11], s47 offen offset:256
    v_mfma_f32_16x16x32_bf16 v[24:27], v[120:123], v[96:99], v[24:27]
    v_mfma_f32_16x16x32_bf16 v[44:47], v[120:123], v[100:103], v[44:47]
    v_mfma_f32_16x16x32_bf16 v[64:67], v[120:123], v[104:107], v[64:67]
    v_mfma_f32_16x16x32_bf16 v[84:87], v[120:123], v[108:111], v[84:87]
    buffer_load_dwordx4 v[184:187], v9, s[12:15], s34 offen offset:0
    buffer_load_dwordx4 v[188:191], v9, s[12:15], s34 offen offset:1024
    v_mfma_f32_16x16x32_bf16 v[28:31], v[124:127], v[96:99], v[28:31]
    v_mfma_f32_16x16x32_bf16 v[48:51], v[124:127], v[100:103], v[48:51]
    v_mfma_f32_16x16x32_bf16 v[68:71], v[124:127], v[104:107], v[68:71]
    v_mfma_f32_16x16x32_bf16 v[88:91], v[124:127], v[108:111], v[88:91]
    buffer_load_dwordx4 v[192:195], v9, s[12:15], s34 offen offset:2048
    buffer_load_dwordx4 v[196:199], v9, s[12:15], s34 offen offset:3072
    v_mfma_f32_16x16x32_bf16 v[32:35], v[128:131], v[96:99], v[32:35]
    v_mfma_f32_16x16x32_bf16 v[52:55], v[128:131], v[100:103], v[52:55]
    v_mfma_f32_16x16x32_bf16 v[72:75], v[128:131], v[104:107], v[72:75]
    v_mfma_f32_16x16x32_bf16 v[92:95], v[128:131], v[108:111], v[92:95]
    s_add_u32 s39, s34, 4096
    buffer_load_dwordx4 v[200:203], v9, s[12:15], s39 offen
    s_add_u32 s35, s35, 2048
    s_add_u32 s34, s34, 5120
    s_waitcnt vmcnt(9)
    v_mfma_f32_16x16x32_bf16 v[16:19], v[148:151], v[132:135], v[16:19]
    v_mfma_f32_16x16x32_bf16 v[36:39], v[148:151], v[136:139], v[36:39]
    v_mfma_f32_16x16x32_bf16 v[56:59], v[148:151], v[140:143], v[56:59]
    v_mfma_f32_16x16x32_bf16 v[76:79], v[148:151], v[144:147], v[76:79]
    s_add_u32 s47, s35, 110592
    buffer_load_dwordx4 v[96:99], v8, s[8:11], s35 offen offset:0
    buffer_load_dwordx4 v[100:103], v8, s[8:11], s35 offen offset:256
    v_mfma_f32_16x16x32_bf16 v[20:23], v[152:155], v[132:135], v[20:23]
    v_mfma_f32_16x16x32_bf16 v[40:43], v[152:155], v[136:139], v[40:43]
    v_mfma_f32_16x16x32_bf16 v[60:63], v[152:155], v[140:143], v[60:63]
    v_mfma_f32_16x16x32_bf16 v[80:83], v[152:155], v[144:147], v[80:83]
    buffer_load_dwordx4 v[104:107], v8, s[8:11], s47 offen offset:0
    buffer_load_dwordx4 v[108:111], v8, s[8:11], s47 offen offset:256
    v_mfma_f32_16x16x32_bf16 v[24:27], v[156:159], v[132:135], v[24:27]
    v_mfma_f32_16x16x32_bf16 v[44:47], v[156:159], v[136:139], v[44:47]
    v_mfma_f32_16x16x32_bf16 v[64:67], v[156:159], v[140:143], v[64:67]
    v_mfma_f32_16x16x32_bf16 v[84:87], v[156:159], v[144:147], v[84:87]
    buffer_load_dwordx4 v[112:115], v9, s[12:15], s34 offen offset:0
    buffer_load_dwordx4 v[116:119], v9, s[12:15], s34 offen offset:1024
    v_mfma_f32_16x16x32_bf16 v[28:31], v[160:163], v[132:135], v[28:31]
    v_mfma_f32_16x16x32_bf16 v[48:51], v[160:163], v[136:139], v[48:51]
    v_mfma_f32_16x16x32_bf16 v[68:71], v[160:163], v[140:143], v[68:71]
    v_mfma_f32_16x16x32_bf16 v[88:91], v[160:163], v[144:147], v[88:91]
    buffer_load_dwordx4 v[120:123], v9, s[12:15], s34 offen offset:2048
    buffer_load_dwordx4 v[124:127], v9, s[12:15], s34 offen offset:3072
    v_mfma_f32_16x16x32_bf16 v[32:35], v[164:167], v[132:135], v[32:35]
    v_mfma_f32_16x16x32_bf16 v[52:55], v[164:167], v[136:139], v[52:55]
    v_mfma_f32_16x16x32_bf16 v[72:75], v[164:167], v[140:143], v[72:75]
    v_mfma_f32_16x16x32_bf16 v[92:95], v[164:167], v[144:147], v[92:95]
    s_add_u32 s39, s34, 4096
    buffer_load_dwordx4 v[128:131], v9, s[12:15], s39 offen
    s_add_u32 s35, s35, 2048
    s_add_u32 s34, s34, 5120
    s_waitcnt vmcnt(9)
    v_mfma_f32_16x16x32_bf16 v[16:19], v[184:187], v[168:171], v[16:19]
    v_mfma_f32_16x16x32_bf16 v[36:39], v[184:187], v[172:175], v[36:39]
    v_mfma_f32_16x16x32_bf16 v[56:59], v[184:187], v[176:179], v[56:59]
    v_mfma_f32_16x16x32_bf16 v[76:79], v[184:187], v[180:183], v[76:79]
    s_add_u32 s47, s35, 110592
    buffer_load_dwordx4 v[132:135], v8, s[8:11], s35 offen offset:0
    buffer_load_dwordx4 v[136:139], v8, s[8:11], s35 offen offset:256
    v_mfma_f32_16x16x32_bf16 v[20:23], v[188:191], v[168:171], v[20:23]
    v_mfma_f32_16x16x32_bf16 v[40:43], v[188:191], v[172:175], v[40:43]
    v_mfma_f32_16x16x32_bf16 v[60:63], v[188:191], v[176:179], v[60:63]
    v_mfma_f32_16x16x32_bf16 v[80:83], v[188:191], v[180:183], v[80:83]
    buffer_load_dwordx4 v[140:143], v8, s[8:11], s47 offen offset:0
    buffer_load_dwordx4 v[144:147], v8, s[8:11], s47 offen offset:256
    v_mfma_f32_16x16x32_bf16 v[24:27], v[192:195], v[168:171], v[24:27]
    v_mfma_f32_16x16x32_bf16 v[44:47], v[192:195], v[172:175], v[44:47]
    v_mfma_f32_16x16x32_bf16 v[64:67], v[192:195], v[176:179], v[64:67]
    v_mfma_f32_16x16x32_bf16 v[84:87], v[192:195], v[180:183], v[84:87]
    buffer_load_dwordx4 v[148:151], v9, s[12:15], s34 offen offset:0
    buffer_load_dwordx4 v[152:155], v9, s[12:15], s34 offen offset:1024
    v_mfma_f32_16x16x32_bf16 v[28:31], v[196:199], v[168:171], v[28:31]
    v_mfma_f32_16x16x32_bf16 v[48:51], v[196:199], v[172:175], v[48:51]
    v_mfma_f32_16x16x32_bf16 v[68:71], v[196:199], v[176:179], v[68:71]
    v_mfma_f32_16x16x32_bf16 v[88:91], v[196:199], v[180:183], v[88:91]
    buffer_load_dwordx4 v[156:159], v9, s[12:15], s34 offen offset:2048
    buffer_load_dwordx4 v[160:163], v9, s[12:15], s34 offen offset:3072
    v_mfma_f32_16x16x32_bf16 v[32:35], v[200:203], v[168:171], v[32:35]
    v_mfma_f32_16x16x32_bf16 v[52:55], v[200:203], v[172:175], v[52:55]
    v_mfma_f32_16x16x32_bf16 v[72:75], v[200:203], v[176:179], v[72:75]
    v_mfma_f32_16x16x32_bf16 v[92:95], v[200:203], v[180:183], v[92:95]
    s_add_u32 s39, s34, 4096
    buffer_load_dwordx4 v[164:167], v9, s[12:15], s39 offen
    s_add_u32 s35, s35, 2048
    s_add_u32 s34, s34, 5120
    s_waitcnt vmcnt(9)
    v_mfma_f32_16x16x32_bf16 v[16:19], v[112:115], v[96:99], v[16:19]
    v_mfma_f32_16x16x32_bf16 v[36:39], v[112:115], v[100:103], v[36:39]
    v_mfma_f32_16x16x32_bf16 v[56:59], v[112:115], v[104:107], v[56:59]
    v_mfma_f32_16x16x32_bf16 v[76:79], v[112:115], v[108:111], v[76:79]
    s_add_u32 s47, s35, 110592
    buffer_load_dwordx4 v[168:171], v8, s[8:11], s35 offen offset:0
    buffer_load_dwordx4 v[172:175], v8, s[8:11], s35 offen offset:256
    v_mfma_f32_16x16x32_bf16 v[20:23], v[116:119], v[96:99], v[20:23]
    v_mfma_f32_16x16x32_bf16 v[40:43], v[116:119], v[100:103], v[40:43]
    v_mfma_f32_16x16x32_bf16 v[60:63], v[116:119], v[104:107], v[60:63]
    v_mfma_f32_16x16x32_bf16 v[80:83], v[116:119], v[108:111], v[80:83]
    buffer_load_dwordx4 v[176:179], v8, s[8:11], s47 offen offset:0
    buffer_load_dwordx4 v[180:183], v8, s[8:11], s47 offen offset:256
    v_mfma_f32_16x16x32_bf16 v[24:27], v[120:123], v[96:99], v[24:27]
    v_mfma_f32_16x16x32_bf16 v[44:47], v[120:123], v[100:103], v[44:47]
    v_mfma_f32_16x16x32_bf16 v[64:67], v[120:123], v[104:107], v[64:67]
    v_mfma_f32_16x16x32_bf16 v[84:87], v[120:123], v[108:111], v[84:87]
    buffer_load_dwordx4 v[184:187], v9, s[12:15], s34 offen offset:0
    buffer_load_dwordx4 v[188:191], v9, s[12:15], s34 offen offset:1024
    v_mfma_f32_16x16x32_bf16 v[28:31], v[124:127], v[96:99], v[28:31]
    v_mfma_f32_16x16x32_bf16 v[48:51], v[124:127], v[100:103], v[48:51]
    v_mfma_f32_16x16x32_bf16 v[68:71], v[124:127], v[104:107], v[68:71]
    v_mfma_f32_16x16x32_bf16 v[88:91], v[124:127], v[108:111], v[88:91]
    buffer_load_dwordx4 v[192:195], v9, s[12:15], s34 offen offset:2048
    buffer_load_dwordx4 v[196:199], v9, s[12:15], s34 offen offset:3072
    v_mfma_f32_16x16x32_bf16 v[32:35], v[128:131], v[96:99], v[32:35]
    v_mfma_f32_16x16x32_bf16 v[52:55], v[128:131], v[100:103], v[52:55]
    v_mfma_f32_16x16x32_bf16 v[72:75], v[128:131], v[104:107], v[72:75]
    v_mfma_f32_16x16x32_bf16 v[92:95], v[128:131], v[108:111], v[92:95]
    s_add_u32 s39, s34, 4096
    buffer_load_dwordx4 v[200:203], v9, s[12:15], s39 offen
    s_add_u32 s35, s35, 2048
    s_add_u32 s34, s34, 5120
    s_waitcnt vmcnt(9)
    v_mfma_f32_16x16x32_bf16 v[16:19], v[148:151], v[132:135], v[16:19]
    v_mfma_f32_16x16x32_bf16 v[36:39], v[148:151], v[136:139], v[36:39]
    v_mfma_f32_16x16x32_bf16 v[56:59], v[148:151], v[140:143], v[56:59]
    v_mfma_f32_16x16x32_bf16 v[76:79], v[148:151], v[144:147], v[76:79]
    s_add_u32 s47, s35, 110592
    buffer_load_dwordx4 v[96:99], v8, s[8:11], s35 offen offset:0
    buffer_load_dwordx4 v[100:103], v8, s[8:11], s35 offen offset:256
    v_mfma_f32_16x16x32_bf16 v[20:23], v[152:155], v[132:135], v[20:23]
    v_mfma_f32_16x16x32_bf16 v[40:43], v[152:155], v[136:139], v[40:43]
    v_mfma_f32_16x16x32_bf16 v[60:63], v[152:155], v[140:143], v[60:63]
    v_mfma_f32_16x16x32_bf16 v[80:83], v[152:155], v[144:147], v[80:83]
    buffer_load_dwordx4 v[104:107], v8, s[8:11], s47 offen offset:0
    buffer_load_dwordx4 v[108:111], v8, s[8:11], s47 offen offset:256
    v_mfma_f32_16x16x32_bf16 v[24:27], v[156:159], v[132:135], v[24:27]
    v_mfma_f32_16x16x32_bf16 v[44:47], v[156:159], v[136:139], v[44:47]
    v_mfma_f32_16x16x32_bf16 v[64:67], v[156:159], v[140:143], v[64:67]
    v_mfma_f32_16x16x32_bf16 v[84:87], v[156:159], v[144:147], v[84:87]
    buffer_load_dwordx4 v[112:115], v9, s[12:15], s34 offen offset:0
    buffer_load_dwordx4 v[116:119], v9, s[12:15], s34 offen offset:1024
    v_mfma_f32_16x16x32_bf16 v[28:31], v[160:163], v[132:135], v[28:31]
    v_mfma_f32_16x16x32_bf16 v[48:51], v[160:163], v[136:139], v[48:51]
    v_mfma_f32_16x16x32_bf16 v[68:71], v[160:163], v[140:143], v[68:71]
    v_mfma_f32_16x16x32_bf16 v[88:91], v[160:163], v[144:147], v[88:91]
    buffer_load_dwordx4 v[120:123], v9, s[12:15], s34 offen offset:2048
    buffer_load_dwordx4 v[124:127], v9, s[12:15], s34 offen offset:3072
    v_mfma_f32_16x16x32_bf16 v[32:35], v[164:167], v[132:135], v[32:35]
    v_mfma_f32_16x16x32_bf16 v[52:55], v[164:167], v[136:139], v[52:55]
    v_mfma_f32_16x16x32_bf16 v[72:75], v[164:167], v[140:143], v[72:75]
    v_mfma_f32_16x16x32_bf16 v[92:95], v[164:167], v[144:147], v[92:95]
    s_add_u32 s39, s34, 4096
    buffer_load_dwordx4 v[128:131], v9, s[12:15], s39 offen
    s_add_u32 s35, s35, 2048
    s_add_u32 s34, s34, 5120
    s_waitcnt vmcnt(9)
    v_mfma_f32_16x16x32_bf16 v[16:19], v[184:187], v[168:171], v[16:19]
    v_mfma_f32_16x16x32_bf16 v[36:39], v[184:187], v[172:175], v[36:39]
    v_mfma_f32_16x16x32_bf16 v[56:59], v[184:187], v[176:179], v[56:59]
    v_mfma_f32_16x16x32_bf16 v[76:79], v[184:187], v[180:183], v[76:79]
    s_add_u32 s47, s35, 110592
    buffer_load_dwordx4 v[132:135], v8, s[8:11], s35 offen offset:0
    buffer_load_dwordx4 v[136:139], v8, s[8:11], s35 offen offset:256
    v_mfma_f32_16x16x32_bf16 v[20:23], v[188:191], v[168:171], v[20:23]
    v_mfma_f32_16x16x32_bf16 v[40:43], v[188:191], v[172:175], v[40:43]
    v_mfma_f32_16x16x32_bf16 v[60:63], v[188:191], v[176:179], v[60:63]
    v_mfma_f32_16x16x32_bf16 v[80:83], v[188:191], v[180:183], v[80:83]
    buffer_load_dwordx4 v[140:143], v8, s[8:11], s47 offen offset:0
    buffer_load_dwordx4 v[144:147], v8, s[8:11], s47 offen offset:256
    v_mfma_f32_16x16x32_bf16 v[24:27], v[192:195], v[168:171], v[24:27]
    v_mfma_f32_16x16x32_bf16 v[44:47], v[192:195], v[172:175], v[44:47]
    v_mfma_f32_16x16x32_bf16 v[64:67], v[192:195], v[176:179], v[64:67]
    v_mfma_f32_16x16x32_bf16 v[84:87], v[192:195], v[180:183], v[84:87]
    buffer_load_dwordx4 v[148:151], v9, s[12:15], s34 offen offset:0
    buffer_load_dwordx4 v[152:155], v9, s[12:15], s34 offen offset:1024
    v_mfma_f32_16x16x32_bf16 v[28:31], v[196:199], v[168:171], v[28:31]
    v_mfma_f32_16x16x32_bf16 v[48:51], v[196:199], v[172:175], v[48:51]
    v_mfma_f32_16x16x32_bf16 v[68:71], v[196:199], v[176:179], v[68:71]
    v_mfma_f32_16x16x32_bf16 v[88:91], v[196:199], v[180:183], v[88:91]
    buffer_load_dwordx4 v[156:159], v9, s[12:15], s34 offen offset:2048
    buffer_load_dwordx4 v[160:163], v9, s[12:15], s34 offen offset:3072
    v_mfma_f32_16x16x32_bf16 v[32:35], v[200:203], v[168:171], v[32:35]
    v_mfma_f32_16x16x32_bf16 v[52:55], v[200:203], v[172:175], v[52:55]
    v_mfma_f32_16x16x32_bf16 v[72:75], v[200:203], v[176:179], v[72:75]
    v_mfma_f32_16x16x32_bf16 v[92:95], v[200:203], v[180:183], v[92:95]
    s_add_u32 s39, s34, 4096
    buffer_load_dwordx4 v[164:167], v9, s[12:15], s39 offen
    s_add_u32 s35, s35, 2048
    s_add_u32 s34, s34, 5120
    s_waitcnt vmcnt(9)
    v_mfma_f32_16x16x32_bf16 v[16:19], v[112:115], v[96:99], v[16:19]
    v_mfma_f32_16x16x32_bf16 v[36:39], v[112:115], v[100:103], v[36:39]
    v_mfma_f32_16x16x32_bf16 v[56:59], v[112:115], v[104:107], v[56:59]
    v_mfma_f32_16x16x32_bf16 v[76:79], v[112:115], v[108:111], v[76:79]
    s_add_u32 s47, s35, 110592
    buffer_load_dwordx4 v[168:171], v8, s[8:11], s35 offen offset:0
    buffer_load_dwordx4 v[172:175], v8, s[8:11], s35 offen offset:256
    v_mfma_f32_16x16x32_bf16 v[20:23], v[116:119], v[96:99], v[20:23]
    v_mfma_f32_16x16x32_bf16 v[40:43], v[116:119], v[100:103], v[40:43]
    v_mfma_f32_16x16x32_bf16 v[60:63], v[116:119], v[104:107], v[60:63]
    v_mfma_f32_16x16x32_bf16 v[80:83], v[116:119], v[108:111], v[80:83]
    buffer_load_dwordx4 v[176:179], v8, s[8:11], s47 offen offset:0
    buffer_load_dwordx4 v[180:183], v8, s[8:11], s47 offen offset:256
    v_mfma_f32_16x16x32_bf16 v[24:27], v[120:123], v[96:99], v[24:27]
    v_mfma_f32_16x16x32_bf16 v[44:47], v[120:123], v[100:103], v[44:47]
    v_mfma_f32_16x16x32_bf16 v[64:67], v[120:123], v[104:107], v[64:67]
    v_mfma_f32_16x16x32_bf16 v[84:87], v[120:123], v[108:111], v[84:87]
    buffer_load_dwordx4 v[184:187], v9, s[12:15], s34 offen offset:0
    buffer_load_dwordx4 v[188:191], v9, s[12:15], s34 offen offset:1024
    v_mfma_f32_16x16x32_bf16 v[28:31], v[124:127], v[96:99], v[28:31]
    v_mfma_f32_16x16x32_bf16 v[48:51], v[124:127], v[100:103], v[48:51]
    v_mfma_f32_16x16x32_bf16 v[68:71], v[124:127], v[104:107], v[68:71]
    v_mfma_f32_16x16x32_bf16 v[88:91], v[124:127], v[108:111], v[88:91]
    buffer_load_dwordx4 v[192:195], v9, s[12:15], s34 offen offset:2048
    buffer_load_dwordx4 v[196:199], v9, s[12:15], s34 offen offset:3072
    v_mfma_f32_16x16x32_bf16 v[32:35], v[128:131], v[96:99], v[32:35]
    v_mfma_f32_16x16x32_bf16 v[52:55], v[128:131], v[100:103], v[52:55]
    v_mfma_f32_16x16x32_bf16 v[72:75], v[128:131], v[104:107], v[72:75]
    v_mfma_f32_16x16x32_bf16 v[92:95], v[128:131], v[108:111], v[92:95]
    s_add_u32 s39, s34, 4096
    buffer_load_dwordx4 v[200:203], v9, s[12:15], s39 offen
    s_add_u32 s35, s35, 2048
    s_add_u32 s34, s34, 5120
    s_waitcnt vmcnt(9)
    v_mfma_f32_16x16x32_bf16 v[16:19], v[148:151], v[132:135], v[16:19]
    v_mfma_f32_16x16x32_bf16 v[36:39], v[148:151], v[136:139], v[36:39]
    v_mfma_f32_16x16x32_bf16 v[56:59], v[148:151], v[140:143], v[56:59]
    v_mfma_f32_16x16x32_bf16 v[76:79], v[148:151], v[144:147], v[76:79]
    s_add_u32 s47, s35, 110592
    buffer_load_dwordx4 v[96:99], v8, s[8:11], s35 offen offset:0
    buffer_load_dwordx4 v[100:103], v8, s[8:11], s35 offen offset:256
    v_mfma_f32_16x16x32_bf16 v[20:23], v[152:155], v[132:135], v[20:23]
    v_mfma_f32_16x16x32_bf16 v[40:43], v[152:155], v[136:139], v[40:43]
    v_mfma_f32_16x16x32_bf16 v[60:63], v[152:155], v[140:143], v[60:63]
    v_mfma_f32_16x16x32_bf16 v[80:83], v[152:155], v[144:147], v[80:83]
    buffer_load_dwordx4 v[104:107], v8, s[8:11], s47 offen offset:0
    buffer_load_dwordx4 v[108:111], v8, s[8:11], s47 offen offset:256
    v_mfma_f32_16x16x32_bf16 v[24:27], v[156:159], v[132:135], v[24:27]
    v_mfma_f32_16x16x32_bf16 v[44:47], v[156:159], v[136:139], v[44:47]
    v_mfma_f32_16x16x32_bf16 v[64:67], v[156:159], v[140:143], v[64:67]
    v_mfma_f32_16x16x32_bf16 v[84:87], v[156:159], v[144:147], v[84:87]
    buffer_load_dwordx4 v[112:115], v9, s[12:15], s34 offen offset:0
    buffer_load_dwordx4 v[116:119], v9, s[12:15], s34 offen offset:1024
    v_mfma_f32_16x16x32_bf16 v[28:31], v[160:163], v[132:135], v[28:31]
    v_mfma_f32_16x16x32_bf16 v[48:51], v[160:163], v[136:139], v[48:51]
    v_mfma_f32_16x16x32_bf16 v[68:71], v[160:163], v[140:143], v[68:71]
    v_mfma_f32_16x16x32_bf16 v[88:91], v[160:163], v[144:147], v[88:91]
    buffer_load_dwordx4 v[120:123], v9, s[12:15], s34 offen offset:2048
    buffer_load_dwordx4 v[124:127], v9, s[12:15], s34 offen offset:3072
    v_mfma_f32_16x16x32_bf16 v[32:35], v[164:167], v[132:135], v[32:35]
    v_mfma_f32_16x16x32_bf16 v[52:55], v[164:167], v[136:139], v[52:55]
    v_mfma_f32_16x16x32_bf16 v[72:75], v[164:167], v[140:143], v[72:75]
    v_mfma_f32_16x16x32_bf16 v[92:95], v[164:167], v[144:147], v[92:95]
    s_add_u32 s39, s34, 4096
    buffer_load_dwordx4 v[128:131], v9, s[12:15], s39 offen
    s_add_u32 s35, s35, 2048
    s_add_u32 s34, s34, 5120
    s_waitcnt vmcnt(9)
    v_mfma_f32_16x16x32_bf16 v[16:19], v[184:187], v[168:171], v[16:19]
    v_mfma_f32_16x16x32_bf16 v[36:39], v[184:187], v[172:175], v[36:39]
    v_mfma_f32_16x16x32_bf16 v[56:59], v[184:187], v[176:179], v[56:59]
    v_mfma_f32_16x16x32_bf16 v[76:79], v[184:187], v[180:183], v[76:79]
    s_add_u32 s47, s35, 110592
    buffer_load_dwordx4 v[132:135], v8, s[8:11], s35 offen offset:0
    buffer_load_dwordx4 v[136:139], v8, s[8:11], s35 offen offset:256
    v_mfma_f32_16x16x32_bf16 v[20:23], v[188:191], v[168:171], v[20:23]
    v_mfma_f32_16x16x32_bf16 v[40:43], v[188:191], v[172:175], v[40:43]
    v_mfma_f32_16x16x32_bf16 v[60:63], v[188:191], v[176:179], v[60:63]
    v_mfma_f32_16x16x32_bf16 v[80:83], v[188:191], v[180:183], v[80:83]
    buffer_load_dwordx4 v[140:143], v8, s[8:11], s47 offen offset:0
    buffer_load_dwordx4 v[144:147], v8, s[8:11], s47 offen offset:256
    v_mfma_f32_16x16x32_bf16 v[24:27], v[192:195], v[168:171], v[24:27]
    v_mfma_f32_16x16x32_bf16 v[44:47], v[192:195], v[172:175], v[44:47]
    v_mfma_f32_16x16x32_bf16 v[64:67], v[192:195], v[176:179], v[64:67]
    v_mfma_f32_16x16x32_bf16 v[84:87], v[192:195], v[180:183], v[84:87]
    buffer_load_dwordx4 v[148:151], v9, s[12:15], s34 offen offset:0
    buffer_load_dwordx4 v[152:155], v9, s[12:15], s34 offen offset:1024
    v_mfma_f32_16x16x32_bf16 v[28:31], v[196:199], v[168:171], v[28:31]
    v_mfma_f32_16x16x32_bf16 v[48:51], v[196:199], v[172:175], v[48:51]
    v_mfma_f32_16x16x32_bf16 v[68:71], v[196:199], v[176:179], v[68:71]
    v_mfma_f32_16x16x32_bf16 v[88:91], v[196:199], v[180:183], v[88:91]
    buffer_load_dwordx4 v[156:159], v9, s[12:15], s34 offen offset:2048
    buffer_load_dwordx4 v[160:163], v9, s[12:15], s34 offen offset:3072
    v_mfma_f32_16x16x32_bf16 v[32:35], v[200:203], v[168:171], v[32:35]
    v_mfma_f32_16x16x32_bf16 v[52:55], v[200:203], v[172:175], v[52:55]
    v_mfma_f32_16x16x32_bf16 v[72:75], v[200:203], v[176:179], v[72:75]
    v_mfma_f32_16x16x32_bf16 v[92:95], v[200:203], v[180:183], v[92:95]
    s_add_u32 s39, s34, 4096
    buffer_load_dwordx4 v[164:167], v9, s[12:15], s39 offen
    s_add_u32 s35, s35, 2048
    s_add_u32 s34, s34, 5120
    s_waitcnt vmcnt(9)
    v_mfma_f32_16x16x32_bf16 v[16:19], v[112:115], v[96:99], v[16:19]
    v_mfma_f32_16x16x32_bf16 v[36:39], v[112:115], v[100:103], v[36:39]
    v_mfma_f32_16x16x32_bf16 v[56:59], v[112:115], v[104:107], v[56:59]
    v_mfma_f32_16x16x32_bf16 v[76:79], v[112:115], v[108:111], v[76:79]
    s_add_u32 s47, s35, 110592
    buffer_load_dwordx4 v[168:171], v8, s[8:11], s35 offen offset:0
    buffer_load_dwordx4 v[172:175], v8, s[8:11], s35 offen offset:256
    v_mfma_f32_16x16x32_bf16 v[20:23], v[116:119], v[96:99], v[20:23]
    v_mfma_f32_16x16x32_bf16 v[40:43], v[116:119], v[100:103], v[40:43]
    v_mfma_f32_16x16x32_bf16 v[60:63], v[116:119], v[104:107], v[60:63]
    v_mfma_f32_16x16x32_bf16 v[80:83], v[116:119], v[108:111], v[80:83]
    buffer_load_dwordx4 v[176:179], v8, s[8:11], s47 offen offset:0
    buffer_load_dwordx4 v[180:183], v8, s[8:11], s47 offen offset:256
    v_mfma_f32_16x16x32_bf16 v[24:27], v[120:123], v[96:99], v[24:27]
    v_mfma_f32_16x16x32_bf16 v[44:47], v[120:123], v[100:103], v[44:47]
    v_mfma_f32_16x16x32_bf16 v[64:67], v[120:123], v[104:107], v[64:67]
    v_mfma_f32_16x16x32_bf16 v[84:87], v[120:123], v[108:111], v[84:87]
    buffer_load_dwordx4 v[184:187], v9, s[12:15], s34 offen offset:0
    buffer_load_dwordx4 v[188:191], v9, s[12:15], s34 offen offset:1024
    v_mfma_f32_16x16x32_bf16 v[28:31], v[124:127], v[96:99], v[28:31]
    v_mfma_f32_16x16x32_bf16 v[48:51], v[124:127], v[100:103], v[48:51]
    v_mfma_f32_16x16x32_bf16 v[68:71], v[124:127], v[104:107], v[68:71]
    v_mfma_f32_16x16x32_bf16 v[88:91], v[124:127], v[108:111], v[88:91]
    buffer_load_dwordx4 v[192:195], v9, s[12:15], s34 offen offset:2048
    buffer_load_dwordx4 v[196:199], v9, s[12:15], s34 offen offset:3072
    v_mfma_f32_16x16x32_bf16 v[32:35], v[128:131], v[96:99], v[32:35]
    v_mfma_f32_16x16x32_bf16 v[52:55], v[128:131], v[100:103], v[52:55]
    v_mfma_f32_16x16x32_bf16 v[72:75], v[128:131], v[104:107], v[72:75]
    v_mfma_f32_16x16x32_bf16 v[92:95], v[128:131], v[108:111], v[92:95]
    s_add_u32 s39, s34, 4096
    buffer_load_dwordx4 v[200:203], v9, s[12:15], s39 offen
    s_add_u32 s35, s35, 2048
    s_add_u32 s34, s34, 5120
    s_waitcnt vmcnt(9)
    v_mfma_f32_16x16x32_bf16 v[16:19], v[148:151], v[132:135], v[16:19]
    v_mfma_f32_16x16x32_bf16 v[36:39], v[148:151], v[136:139], v[36:39]
    v_mfma_f32_16x16x32_bf16 v[56:59], v[148:151], v[140:143], v[56:59]
    v_mfma_f32_16x16x32_bf16 v[76:79], v[148:151], v[144:147], v[76:79]
    s_cmp_eq_u32 s28, 3
    s_cselect_b32 s35, 0x7ff00000, s35
    s_cselect_b32 s34, 0x7ff00000, s34
    s_add_u32 s47, s35, 110592
    buffer_load_dwordx4 v[96:99], v8, s[8:11], s35 offen offset:0
    buffer_load_dwordx4 v[100:103], v8, s[8:11], s35 offen offset:256
    v_mfma_f32_16x16x32_bf16 v[20:23], v[152:155], v[132:135], v[20:23]
    v_mfma_f32_16x16x32_bf16 v[40:43], v[152:155], v[136:139], v[40:43]
    v_mfma_f32_16x16x32_bf16 v[60:63], v[152:155], v[140:143], v[60:63]
    v_mfma_f32_16x16x32_bf16 v[80:83], v[152:155], v[144:147], v[80:83]
    buffer_load_dwordx4 v[104:107], v8, s[8:11], s47 offen offset:0
    buffer_load_dwordx4 v[108:111], v8, s[8:11], s47 offen offset:256
    v_mfma_f32_16x16x32_bf16 v[24:27], v[156:159], v[132:135], v[24:27]
    v_mfma_f32_16x16x32_bf16 v[44:47], v[156:159], v[136:139], v[44:47]
    v_mfma_f32_16x16x32_bf16 v[64:67], v[156:159], v[140:143], v[64:67]
    v_mfma_f32_16x16x32_bf16 v[84:87], v[156:159], v[144:147], v[84:87]
    buffer_load_dwordx4 v[112:115], v9, s[12:15], s34 offen offset:0
    buffer_load_dwordx4 v[116:119], v9, s[12:15], s34 offen offset:1024
    v_mfma_f32_16x16x32_bf16 v[28:31], v[160:163], v[132:135], v[28:31]
    v_mfma_f32_16x16x32_bf16 v[48:51], v[160:163], v[136:139], v[48:51]
    v_mfma_f32_16x16x32_bf16 v[68:71], v[160:163], v[140:143], v[68:71]
    v_mfma_f32_16x16x32_bf16 v[88:91], v[160:163], v[144:147], v[88:91]
    buffer_load_dwordx4 v[120:123], v9, s[12:15], s34 offen offset:2048
    buffer_load_dwordx4 v[124:127], v9, s[12:15], s34 offen offset:3072
    v_mfma_f32_16x16x32_bf16 v[32:35], v[164:167], v[132:135], v[32:35]
    v_mfma_f32_16x16x32_bf16 v[52:55], v[164:167], v[136:139], v[52:55]
    v_mfma_f32_16x16x32_bf16 v[72:75], v[164:167], v[140:143], v[72:75]
    v_mfma_f32_16x16x32_bf16 v[92:95], v[164:167], v[144:147], v[92:95]
    s_add_u32 s39, s34, 4096
    buffer_load_dwordx4 v[128:131], v9, s[12:15], s39 offen
    s_add_u32 s35, s35, 2048
    s_add_u32 s34, s34, 5120
    s_waitcnt vmcnt(9)
    v_mfma_f32_16x16x32_bf16 v[16:19], v[184:187], v[168:171], v[16:19]
    v_mfma_f32_16x16x32_bf16 v[36:39], v[184:187], v[172:175], v[36:39]
    v_mfma_f32_16x16x32_bf16 v[56:59], v[184:187], v[176:179], v[56:59]
    v_mfma_f32_16x16x32_bf16 v[76:79], v[184:187], v[180:183], v[76:79]
    s_cmp_eq_u32 s28, 3
    s_cselect_b32 s35, 0x7ff00000, s35
    s_cselect_b32 s34, 0x7ff00000, s34
    s_add_u32 s47, s35, 110592
    buffer_load_dwordx4 v[132:135], v8, s[8:11], s35 offen offset:0
    buffer_load_dwordx4 v[136:139], v8, s[8:11], s35 offen offset:256
    v_mfma_f32_16x16x32_bf16 v[20:23], v[188:191], v[168:171], v[20:23]
    v_mfma_f32_16x16x32_bf16 v[40:43], v[188:191], v[172:175], v[40:43]
    v_mfma_f32_16x16x32_bf16 v[60:63], v[188:191], v[176:179], v[60:63]
    v_mfma_f32_16x16x32_bf16 v[80:83], v[188:191], v[180:183], v[80:83]
    buffer_load_dwordx4 v[140:143], v8, s[8:11], s47 offen offset:0
    buffer_load_dwordx4 v[144:147], v8, s[8:11], s47 offen offset:256
    v_mfma_f32_16x16x32_bf16 v[24:27], v[192:195], v[168:171], v[24:27]
    v_mfma_f32_16x16x32_bf16 v[44:47], v[192:195], v[172:175], v[44:47]
    v_mfma_f32_16x16x32_bf16 v[64:67], v[192:195], v[176:179], v[64:67]
    v_mfma_f32_16x16x32_bf16 v[84:87], v[192:195], v[180:183], v[84:87]
    buffer_load_dwordx4 v[148:151], v9, s[12:15], s34 offen offset:0
    buffer_load_dwordx4 v[152:155], v9, s[12:15], s34 offen offset:1024
    v_mfma_f32_16x16x32_bf16 v[28:31], v[196:199], v[168:171], v[28:31]
    v_mfma_f32_16x16x32_bf16 v[48:51], v[196:199], v[172:175], v[48:51]
    v_mfma_f32_16x16x32_bf16 v[68:71], v[196:199], v[176:179], v[68:71]
    v_mfma_f32_16x16x32_bf16 v[88:91], v[196:199], v[180:183], v[88:91]
    buffer_load_dwordx4 v[156:159], v9, s[12:15], s34 offen offset:2048
    buffer_load_dwordx4 v[160:163], v9, s[12:15], s34 offen offset:3072
    v_mfma_f32_16x16x32_bf16 v[32:35], v[200:203], v[168:171], v[32:35]
    v_mfma_f32_16x16x32_bf16 v[52:55], v[200:203], v[172:175], v[52:55]
    v_mfma_f32_16x16x32_bf16 v[72:75], v[200:203], v[176:179], v[72:75]
    v_mfma_f32_16x16x32_bf16 v[92:95], v[200:203], v[180:183], v[92:95]
    s_add_u32 s39, s34, 4096
    buffer_load_dwordx4 v[164:167], v9, s[12:15], s39 offen
    s_add_u32 s35, s35, 2048
    s_add_u32 s34, s34, 5120
    s_waitcnt vmcnt(9)
    v_mfma_f32_16x16x32_bf16 v[16:19], v[112:115], v[96:99], v[16:19]
    v_mfma_f32_16x16x32_bf16 v[36:39], v[112:115], v[100:103], v[36:39]
    v_mfma_f32_16x16x32_bf16 v[56:59], v[112:115], v[104:107], v[56:59]
    v_mfma_f32_16x16x32_bf16 v[76:79], v[112:115], v[108:111], v[76:79]
    v_mfma_f32_16x16x32_bf16 v[20:23], v[116:119], v[96:99], v[20:23]
    v_mfma_f32_16x16x32_bf16 v[40:43], v[116:119], v[100:103], v[40:43]
    v_mfma_f32_16x16x32_bf16 v[60:63], v[116:119], v[104:107], v[60:63]
    v_mfma_f32_16x16x32_bf16 v[80:83], v[116:119], v[108:111], v[80:83]
    v_mfma_f32_16x16x32_bf16 v[24:27], v[120:123], v[96:99], v[24:27]
    v_mfma_f32_16x16x32_bf16 v[44:47], v[120:123], v[100:103], v[44:47]
    v_mfma_f32_16x16x32_bf16 v[64:67], v[120:123], v[104:107], v[64:67]
    v_mfma_f32_16x16x32_bf16 v[84:87], v[120:123], v[108:111], v[84:87]
    v_mfma_f32_16x16x32_bf16 v[28:31], v[124:127], v[96:99], v[28:31]
    v_mfma_f32_16x16x32_bf16 v[48:51], v[124:127], v[100:103], v[48:51]
    v_mfma_f32_16x16x32_bf16 v[68:71], v[124:127], v[104:107], v[68:71]
    v_mfma_f32_16x16x32_bf16 v[88:91], v[124:127], v[108:111], v[88:91]
    v_mfma_f32_16x16x32_bf16 v[32:35], v[128:131], v[96:99], v[32:35]
    v_mfma_f32_16x16x32_bf16 v[52:55], v[128:131], v[100:103], v[52:55]
    v_mfma_f32_16x16x32_bf16 v[72:75], v[128:131], v[104:107], v[72:75]
    v_mfma_f32_16x16x32_bf16 v[92:95], v[128:131], v[108:111], v[92:95]
    s_waitcnt vmcnt(0)
    v_mfma_f32_16x16x32_bf16 v[16:19], v[148:151], v[132:135], v[16:19]
    v_mfma_f32_16x16x32_bf16 v[36:39], v[148:151], v[136:139], v[36:39]
    v_mfma_f32_16x16x32_bf16 v[56:59], v[148:151], v[140:143], v[56:59]
    v_mfma_f32_16x16x32_bf16 v[76:79], v[148:151], v[144:147], v[76:79]
    v_mfma_f32_16x16x32_bf16 v[20:23], v[152:155], v[132:135], v[20:23]
    v_mfma_f32_16x16x32_bf16 v[40:43], v[152:155], v[136:139], v[40:43]
    v_mfma_f32_16x16x32_bf16 v[60:63], v[152:155], v[140:143], v[60:63]
    v_mfma_f32_16x16x32_bf16 v[80:83], v[152:155], v[144:147], v[80:83]
    v_mfma_f32_16x16x32_bf16 v[24:27], v[156:159], v[132:135], v[24:27]
    v_mfma_f32_16x16x32_bf16 v[44:47], v[156:159], v[136:139], v[44:47]
    v_mfma_f32_16x16x32_bf16 v[64:67], v[156:159], v[140:143], v[64:67]
    v_mfma_f32_16x16x32_bf16 v[84:87], v[156:159], v[144:147], v[84:87]
    v_mfma_f32_16x16x32_bf16 v[28:31], v[160:163], v[132:135], v[28:31]
    v_mfma_f32_16x16x32_bf16 v[48:51], v[160:163], v[136:139], v[48:51]
    v_mfma_f32_16x16x32_bf16 v[68:71], v[160:163], v[140:143], v[68:71]
    v_mfma_f32_16x16x32_bf16 v[88:91], v[160:163], v[144:147], v[88:91]
    v_mfma_f32_16x16x32_bf16 v[32:35], v[164:167], v[132:135], v[32:35]
    v_mfma_f32_16x16x32_bf16 v[52:55], v[164:167], v[136:139], v[52:55]
    v_mfma_f32_16x16x32_bf16 v[72:75], v[164:167], v[140:143], v[72:75]
    v_mfma_f32_16x16x32_bf16 v[92:95], v[164:167], v[144:147], v[92:95]
    s_setprio 2
    s_waitcnt vmcnt(0)
    s_nop 7
    v_cvt_pk_bf16_f32 v96, v16, v17
    v_cvt_pk_bf16_f32 v97, v18, v19
    v_cvt_pk_bf16_f32 v98, v20, v21
    v_cvt_pk_bf16_f32 v99, v22, v23
    v_cvt_pk_bf16_f32 v100, v24, v25
    v_cvt_pk_bf16_f32 v101, v26, v27
    v_cvt_pk_bf16_f32 v102, v28, v29
    v_cvt_pk_bf16_f32 v103, v30, v31
    v_cvt_pk_bf16_f32 v104, v32, v33
    v_cvt_pk_bf16_f32 v105, v34, v35
    v_cvt_pk_bf16_f32 v106, v36, v37
    v_cvt_pk_bf16_f32 v107, v38, v39
    v_cvt_pk_bf16_f32 v108, v40, v41
    v_cvt_pk_bf16_f32 v109, v42, v43
    v_cvt_pk_bf16_f32 v110, v44, v45
    v_cvt_pk_bf16_f32 v111, v46, v47
    v_cvt_pk_bf16_f32 v112, v48, v49
    v_cvt_pk_bf16_f32 v113, v50, v51
    v_cvt_pk_bf16_f32 v114, v52, v53
    v_cvt_pk_bf16_f32 v115, v54, v55
    v_cvt_pk_bf16_f32 v116, v56, v57
    v_cvt_pk_bf16_f32 v117, v58, v59
    v_cvt_pk_bf16_f32 v118, v60, v61
    v_cvt_pk_bf16_f32 v119, v62, v63
    v_cvt_pk_bf16_f32 v120, v64, v65
    v_cvt_pk_bf16_f32 v121, v66, v67
    v_cvt_pk_bf16_f32 v122, v68, v69
    v_cvt_pk_bf16_f32 v123, v70, v71
    v_cvt_pk_bf16_f32 v124, v72, v73
    v_cvt_pk_bf16_f32 v125, v74, v75
    v_cvt_pk_bf16_f32 v126, v76, v77
    v_cvt_pk_bf16_f32 v127, v78, v79
    v_cvt_pk_bf16_f32 v128, v80, v81
    v_cvt_pk_bf16_f32 v129, v82, v83
    v_cvt_pk_bf16_f32 v130, v84, v85
    v_cvt_pk_bf16_f32 v131, v86, v87
    v_cvt_pk_bf16_f32 v132, v88, v89
    v_cvt_pk_bf16_f32 v133, v90, v91
    v_cvt_pk_bf16_f32 v134, v92, v93
    v_cvt_pk_bf16_f32 v135, v94, v95
    s_lshr_b32 s38, s28, 1
    s_mul_i32 s38, s38, 46080
    s_and_b32 s39, s28, 1
    s_mul_i32 s39, s39, 7680
    s_add_u32 s38, s38, s39
    s_add_u32 s38, s38, 102400
    v_lshlrev_b32 v2, 3, v1
    v_add_u32 v3, s38, v2
    s_cmp_eq_u32 s28, 0
    s_cbranch_scc1 recurrent_scan__mha_block__glu_gated_geglu__prompt_kernel_rd_29
    s_sub_u32 s39, 3, s28
    s_and_b32 s39, s39, 3
    s_mul_i32 s39, s39, 2560
    v_add_u32 v4, s39, v3
    ds_write_b64 v4, v[96:97] offset:0
    ds_write_b64 v4, v[98:99] offset:512
    ds_write_b64 v4, v[100:101] offset:1024
    ds_write_b64 v4, v[102:103] offset:1536
    ds_write_b64 v4, v[104:105] offset:2048
recurrent_scan__mha_block__glu_gated_geglu__prompt_kernel_rd_29:
    s_cmp_eq_u32 s28, 1
    s_cbranch_scc1 recurrent_scan__mha_block__glu_gated_geglu__prompt_kernel_rd_30
    s_sub_u32 s39, 4, s28
    s_and_b32 s39, s39, 3
    s_mul_i32 s39, s39, 2560
    v_add_u32 v4, s39, v3
    ds_write_b64 v4, v[106:107] offset:0
    ds_write_b64 v4, v[108:109] offset:512
    ds_write_b64 v4, v[110:111] offset:1024
    ds_write_b64 v4, v[112:113] offset:1536
    ds_write_b64 v4, v[114:115] offset:2048
recurrent_scan__mha_block__glu_gated_geglu__prompt_kernel_rd_30:
    s_cmp_eq_u32 s28, 2
    s_cbranch_scc1 recurrent_scan__mha_block__glu_gated_geglu__prompt_kernel_rd_31
    s_sub_u32 s39, 5, s28
    s_and_b32 s39, s39, 3
    s_mul_i32 s39, s39, 2560
    v_add_u32 v4, s39, v3
    ds_write_b64 v4, v[116:117] offset:0
    ds_write_b64 v4, v[118:119] offset:512
    ds_write_b64 v4, v[120:121] offset:1024
    ds_write_b64 v4, v[122:123] offset:1536
    ds_write_b64 v4, v[124:125] offset:2048
recurrent_scan__mha_block__glu_gated_geglu__prompt_kernel_rd_31:
    s_cmp_eq_u32 s28, 3
    s_cbranch_scc1 recurrent_scan__mha_block__glu_gated_geglu__prompt_kernel_rd_32
    s_sub_u32 s39, 6, s28
    s_and_b32 s39, s39, 3
    s_mul_i32 s39, s39, 2560
    v_add_u32 v4, s39, v3
    ds_write_b64 v4, v[126:127] offset:0
    ds_write_b64 v4, v[128:129] offset:512
    ds_write_b64 v4, v[130:131] offset:1024
    ds_write_b64 v4, v[132:133] offset:1536
    ds_write_b64 v4, v[134:135] offset:2048
recurrent_scan__mha_block__glu_gated_geglu__prompt_kernel_rd_32:
    s_waitcnt lgkmcnt(0)
    s_add_u32 s33, s33, 4
    s_mov_b64 exec, 1
    ds_add_u32 v216, v217
    s_mov_b64 exec, -1
    s_mov_b32 s57, 0
recurrent_scan__mha_block__glu_gated_geglu__prompt_kernel_sw_33:
    ds_read_b32 v218, v216
    s_add_u32 s57, s57, 1
    s_cmp_ge_u32 s57, 0x100000
    s_cbranch_scc1 recurrent_scan__mha_block__glu_gated_geglu__prompt_kernel_sw_33_x
    s_waitcnt lgkmcnt(0)
    v_readfirstlane_b32 s38, v218
    s_cmp_ge_u32 s38, s33
    s_cbranch_scc1 recurrent_scan__mha_block__glu_gated_geglu__prompt_kernel_sw_33_x
    s_sleep 1
    s_branch recurrent_scan__mha_block__glu_gated_geglu__prompt_kernel_sw_33
recurrent_scan__mha_block__glu_gated_geglu__prompt_kernel_sw_33_x:
    s_waitcnt lgkmcnt(0)
    s_cmp_eq_u32 s28, 1
    s_cbranch_scc0 recurrent_scan__mha_block__glu_gated_geglu__prompt_kernel_mv_34
    v_mov_b32 v16, v36
    v_mov_b32 v17, v37
    v_mov_b32 v18, v38
    v_mov_b32 v19, v39
    v_mov_b32 v20, v40
    v_mov_b32 v21, v41
    v_mov_b32 v22, v42
    v_mov_b32 v23, v43
    v_mov_b32 v24, v44
    v_mov_b32 v25, v45
    v_mov_b32 v26, v46
    v_mov_b32 v27, v47
    v_mov_b32 v28, v48
    v_mov_b32 v29, v49
    v_mov_b32 v30, v50
    v_mov_b32 v31, v51
    v_mov_b32 v32, v52
    v_mov_b32 v33, v53
    v_mov_b32 v34, v54
    v_mov_b32 v35, v55
recurrent_scan__mha_block__glu_gated_geglu__prompt_kernel_mv_34:
    s_cmp_eq_u32 s28, 2
    s_cbranch_scc0 recurrent_scan__mha_block__glu_gated_geglu__prompt_kernel_mv_35
    v_mov_b32 v16, v56
    v_mov_b32 v17, v57
    v_mov_b32 v18, v58
    v_mov_b32 v19, v59
    v_mov_b32 v20, v60
    v_mov_b32 v21, v61
    v_mov_b32 v22, v62
    v_mov_b32 v23, v63
    v_mov_b32 v24, v64
    v_mov_b32 v25, v65
    v_mov_b32 v26, v66
    v_mov_b32 v27, v67
    v_mov_b32 v28, v68
    v_mov_b32 v29, v69
    v_mov_b32 v30, v70
    v_mov_b32 v31, v71
    v_mov_b32 v32, v72
    v_mov_b32 v33, v73
    v_mov_b32 v34, v74
    v_mov_b32 v35, v75
recurrent_scan__mha_block__glu_gated_geglu__prompt_kernel_mv_35:
    s_cmp_eq_u32 s28, 3
    s_cbranch_scc0 recurrent_scan__mha_block__glu_gated_geglu__prompt_kernel_mv_36
    v_mov_b32 v16, v76
    v_mov_b32 v17, v77
    v_mov_b32 v18, v78
    v_mov_b32 v19, v79
    v_mov_b32 v20, v80
    v_mov_b32 v21, v81
    v_mov_b32 v22, v82
    v_mov_b32 v23, v83
    v_mov_b32 v24, v84
    v_mov_b32 v25, v85
    v_mov_b32 v26, v86
    v_mov_b32 v27, v87
    v_mov_b32 v28, v88
    v_mov_b32 v29, v89
    v_mov_b32 v30, v90
    v_mov_b32 v31, v91
    v_mov_b32 v32, v92
    v_mov_b32 v33, v93
    v_mov_b32 v34, v94
    v_mov_b32 v35, v95
recurrent_scan__mha_block__glu_gated_geglu__prompt_kernel_mv_36:
    s_add_u32 s39, s28, 1
    s_and_b32 s39, s39, 3
    s_lshr_b32 s40, s39, 1
    s_mul_i32 s40, s40, 46080
    s_and_b32 s38, s39, 1
    s_mul_i32 s38, s38, 7680
    s_add_u32 s40, s40, s38
    s_add_u32 s40, s40, 102400
    s_add_u32 s40, s40, 5120
    v_add_u32 v4, s40, v2
    ds_read_b64 v[136:137], v4 offset:0
    ds_read_b64 v[138:139], v4 offset:512
    ds_read_b64 v[140:141], v4 offset:1024
    ds_read_b64 v[142:143], v4 offset:1536
    ds_read_b64 v[144:145], v4 offset:2048
    s_add_u32 s39, s28, 2
    s_and_b32 s39, s39, 3
    s_lshr_b32 s40, s39, 1
    s_mul_i32 s40, s40, 46080
    s_and_b32 s38, s39, 1
    s_mul_i32 s38, s38, 7680
    s_add_u32 s40, s40, s38
    s_add_u32 s40, s40, 102400
    s_add_u32 s40, s40, 2560
    v_add_u32 v4, s40, v2
    ds_read_b64 v[146:147], v4 offset:0
    ds_read_b64 v[148:149], v4 offset:512
    ds_read_b64 v[150:151], v4 offset:1024
    ds_read_b64 v[152:153], v4 offset:1536
    ds_read_b64 v[154:155], v4 offset:2048
    s_add_u32 s39, s28, 3
    s_and_b32 s39, s39, 3
    s_lshr_b32 s40, s39, 1
    s_mul_i32 s40, s40, 46080
    s_and_b32 s38, s39, 1
    s_mul_i32 s38, s38, 7680
    s_add_u32 s40, s40, s38
    s_add_u32 s40, s40, 102400
    s_add_u32 s40, s40, 0
    v_add_u32 v4, s40, v2
    ds_read_b64 v[156:157], v4 offset:0
    ds_read_b64 v[158:159], v4 offset:512
    ds_read_b64 v[160:161], v4 offset:1024
    ds_read_b64 v[162:163], v4 offset:1536
    ds_read_b64 v[164:165], v4 offset:2048
    s_waitcnt lgkmcnt(0)
    v_lshlrev_b32 v2, 16, v136
    v_and_b32 v3, 0xffff0000, v136
    v_add_f32 v16, v16, v2
    v_add_f32 v17, v17, v3
    v_lshlrev_b32 v2, 16, v137
    v_and_b32 v3, 0xffff0000, v137
    v_add_f32 v18, v18, v2
    v_add_f32 v19, v19, v3
    v_lshlrev_b32 v2, 16, v138
    v_and_b32 v3, 0xffff0000, v138
    v_add_f32 v20, v20, v2
    v_add_f32 v21, v21, v3
    v_lshlrev_b32 v2, 16, v139
    v_and_b32 v3, 0xffff0000, v139
    v_add_f32 v22, v22, v2
    v_add_f32 v23, v23, v3
    v_lshlrev_b32 v2, 16, v140
    v_and_b32 v3, 0xffff0000, v140
    v_add_f32 v24, v24, v2
    v_add_f32 v25, v25, v3
    v_lshlrev_b32 v2, 16, v141
    v_and_b32 v3, 0xffff0000, v141
    v_add_f32 v26, v26, v2
    v_add_f32 v27, v27, v3
    v_lshlrev_b32 v2, 16, v142
    v_and_b32 v3, 0xffff0000, v142
    v_add_f32 v28, v28, v2
    v_add_f32 v29, v29, v3
    v_lshlrev_b32 v2, 16, v143
    v_and_b32 v3, 0xffff0000, v143
    v_add_f32 v30, v30, v2
    v_add_f32 v31, v31, v3
    v_lshlrev_b32 v2, 16, v144
    v_and_b32 v3, 0xffff0000, v144
    v_add_f32 v32, v32, v2
    v_add_f32 v33, v33, v3
    v_lshlrev_b32 v2, 16, v145
    v_and_b32 v3, 0xffff0000, v145
    v_add_f32 v34, v34, v2
    v_add_f32 v35, v35, v3
    v_lshlrev_b32 v2, 16, v146
    v_and_b32 v3, 0xffff0000, v146
    v_add_f32 v16, v16, v2
    v_add_f32 v17, v17, v3
    v_lshlrev_b32 v2, 16, v147
    v_and_b32 v3, 0xffff0000, v147
    v_add_f32 v18, v18, v2
    v_add_f32 v19, v19, v3
    v_lshlrev_b32 v2, 16, v148
    v_and_b32 v3, 0xffff0000, v148
    v_add_f32 v20, v20, v2
    v_add_f32 v21, v21, v3
    v_lshlrev_b32 v2, 16, v149
    v_and_b32 v3, 0xffff0000, v149
    v_add_f32 v22, v22, v2
    v_add_f32 v23, v23, v3
    v_lshlrev_b32 v2, 16, v150
    v_and_b32 v3, 0xffff0000, v150
    v_add_f32 v24, v24, v2
    v_add_f32 v25, v25, v3
    v_lshlrev_b32 v2, 16, v151
    v_and_b32 v3, 0xffff0000, v151
    v_add_f32 v26, v26, v2
    v_add_f32 v27, v27, v3
    v_lshlrev_b32 v2, 16, v152
    v_and_b32 v3, 0xffff0000, v152
    v_add_f32 v28, v28, v2
    v_add_f32 v29, v29, v3
    v_lshlrev_b32 v2, 16, v153
    v_and_b32 v3, 0xffff0000, v153
    v_add_f32 v30, v30, v2
    v_add_f32 v31, v31, v3
    v_lshlrev_b32 v2, 16, v154
    v_and_b32 v3, 0xffff0000, v154
    v_add_f32 v32, v32, v2
    v_add_f32 v33, v33, v3
    v_lshlrev_b32 v2, 16, v155
    v_and_b32 v3, 0xffff0000, v155
    v_add_f32 v34, v34, v2
    v_add_f32 v35, v35, v3
    v_lshlrev_b32 v2, 16, v156
    v_and_b32 v3, 0xffff0000, v156
    v_add_f32 v16, v16, v2
    v_add_f32 v17, v17, v3
    v_lshlrev_b32 v2, 16, v157
    v_and_b32 v3, 0xffff0000, v157
    v_add_f32 v18, v18, v2
    v_add_f32 v19, v19, v3
    v_lshlrev_b32 v2, 16, v158
    v_and_b32 v3, 0xffff0000, v158
    v_add_f32 v20, v20, v2
    v_add_f32 v21, v21, v3
    v_lshlrev_b32 v2, 16, v159
    v_and_b32 v3, 0xffff0000, v159
    v_add_f32 v22, v22, v2
    v_add_f32 v23, v23, v3
    v_lshlrev_b32 v2, 16, v160
    v_and_b32 v3, 0xffff0000, v160
    v_add_f32 v24, v24, v2
    v_add_f32 v25, v25, v3
    v_lshlrev_b32 v2, 16, v161
    v_and_b32 v3, 0xffff0000, v161
    v_add_f32 v26, v26, v2
    v_add_f32 v27, v27, v3
    v_lshlrev_b32 v2, 16, v162
    v_and_b32 v3, 0xffff0000, v162
    v_add_f32 v28, v28, v2
    v_add_f32 v29, v29, v3
    v_lshlrev_b32 v2, 16, v163
    v_and_b32 v3, 0xffff0000, v163
    v_add_f32 v30, v30, v2
    v_add_f32 v31, v31, v3
    v_lshlrev_b32 v2, 16, v164
    v_and_b32 v3, 0xffff0000, v164
    v_add_f32 v32, v32, v2
    v_add_f32 v33, v33, v3
    v_lshlrev_b32 v2, 16, v165
    v_and_b32 v3, 0xffff0000, v165
    v_add_f32 v34, v34, v2
    v_add_f32 v35, v35, v3
    s_mov_b32 s40, 0xbfb8aa3b
    v_mul_f32 v56, s40, v16
    v_mul_f32 v57, s40, v17
    v_mul_f32 v58, s40, v18
    v_mul_f32 v59, s40, v19
    v_mul_f32 v60, s40, v20
    v_mul_f32 v61, s40, v21
    v_mul_f32 v62, s40, v22
    v_mul_f32 v63, s40, v23
    v_mul_f32 v64, s40, v24
    v_mul_f32 v65, s40, v25
    v_mul_f32 v66, s40, v26
    v_mul_f32 v67, s40, v27
    v_mul_f32 v68, s40, v28
    v_mul_f32 v69, s40, v29
    v_mul_f32 v70, s40, v30
    v_mul_f32 v71, s40, v31
    v_mul_f32 v72, s40, v32
    v_mul_f32 v73, s40, v33
    v_mul_f32 v74, s40, v34
    v_mul_f32 v75, s40, v35
    v_exp_f32 v56, v56
    v_exp_f32 v57, v57
    v_exp_f32 v58, v58
    v_exp_f32 v59, v59
    v_exp_f32 v60, v60
    v_exp_f32 v61, v61
    v_exp_f32 v62, v62
    v_exp_f32 v63, v63
    v_exp_f32 v64, v64
    v_exp_f32 v65, v65
    v_exp_f32 v66, v66
    v_exp_f32 v67, v67
    v_exp_f32 v68, v68
    v_exp_f32 v69, v69
    v_exp_f32 v70, v70
    v_exp_f32 v71, v71
    v_exp_f32 v72, v72
    v_exp_f32 v73, v73
    v_exp_f32 v74, v74
    v_exp_f32 v75, v75
    s_nop 0
    v_add_f32 v56, 1.0, v56
    v_add_f32 v57, 1.0, v57
    v_add_f32 v58, 1.0, v58
    v_add_f32 v59, 1.0, v59
    v_add_f32 v60, 1.0, v60
    v_add_f32 v61, 1.0, v61
    v_add_f32 v62, 1.0, v62
    v_add_f32 v63, 1.0, v63
    v_add_f32 v64, 1.0, v64
    v_add_f32 v65, 1.0, v65
    v_add_f32 v66, 1.0, v66
    v_add_f32 v67, 1.0, v67
    v_add_f32 v68, 1.0, v68
    v_add_f32 v69, 1.0, v69
    v_add_f32 v70, 1.0, v70
    v_add_f32 v71, 1.0, v71
    v_add_f32 v72, 1.0, v72
    v_add_f32 v73, 1.0, v73
    v_add_f32 v74, 1.0, v74
    v_add_f32 v75, 1.0, v75
    v_rcp_f32 v56, v56
    v_rcp_f32 v57, v57
    v_rcp_f32 v58, v58
    v_rcp_f32 v59, v59
    v_rcp_f32 v60, v60
    v_rcp_f32 v61, v61
    v_rcp_f32 v62, v62
    v_rcp_f32 v63, v63
    v_rcp_f32 v64, v64
    v_rcp_f32 v65, v65
    v_rcp_f32 v66, v66
    v_rcp_f32 v67, v67
    v_rcp_f32 v68, v68
    v_rcp_f32 v69, v69
    v_rcp_f32 v70, v70
    v_rcp_f32 v71, v71
    v_rcp_f32 v72, v72
    v_rcp_f32 v73, v73
    v_rcp_f32 v74, v74
    v_rcp_f32 v75, v75
    s_nop 0
    v_mul_f32 v196, v16, v56
    v_mul_f32 v197, v17, v57
    v_mul_f32 v198, v18, v58
    v_mul_f32 v199, v19, v59
    v_mul_f32 v200, v20, v60
    v_mul_f32 v201, v21, v61
    v_mul_f32 v202, v22, v62
    v_mul_f32 v203, v23, v63
    v_mul_f32 v204, v24, v64
    v_mul_f32 v205, v25, v65
    v_mul_f32 v206, v26, v66
    v_mul_f32 v207, v27, v67
    v_mul_f32 v208, v28, v68
    v_mul_f32 v209, v29, v69
    v_mul_f32 v210, v30, v70
    v_mul_f32 v211, v31, v71
    v_mul_f32 v212, v32, v72
    v_mul_f32 v213, v33, v73
    v_mul_f32 v214, v34, v74
    v_mul_f32 v215, v35, v75
    s_add_u32 s8, s44, 0xe40000
    s_addc_u32 s9, s45, 0
    s_mov_b32 s10, 0x280000
    s_mov_b32 s11, 0x20000
    v_mov_b32 v16, 0
    v_mov_b32 v17, 0
    v_mov_b32 v18, 0
    v_mov_b32 v19, 0
    v_mov_b32 v20, 0
    v_mov_b32 v21, 0
    v_mov_b32 v22, 0
    v_mov_b32 v23, 0
    v_mov_b32 v24, 0
    v_mov_b32 v25, 0
    v_mov_b32 v26, 0
    v_mov_b32 v27, 0
    v_mov_b32 v28, 0
    v_mov_b32 v29, 0
    v_mov_b32 v30, 0
    v_mov_b32 v31, 0
    v_mov_b32 v32, 0
    v_mov_b32 v33, 0
    v_mov_b32 v34, 0
    v_mov_b32 v35, 0
    s_lshl_b32 s38, s50, 1
    s_add_u32 s38, s38, s29
    s_mul_i32 s35, s38, 40960
    s_lshl_b32 s38, s30, 8
    s_add_u32 s35, s35, s38
    v_add_u32 v10, 61440, v9
    s_add_u32 s52, s44, 0x187a000
    s_addc_u32 s53, s45, 0
    s_mov_b32 s54, 0x20000
    s_mov_b32 s55, 0x20000
    v_and_b32 v2, 31, v1
    s_lshl_b32 s38, s50, 5
    v_add_u32 v2, s38, v2
    v_lshlrev_b32 v2, 7, v2
    s_mov_b32 s40, 0
recurrent_scan__mha_block__glu_gated_geglu__prompt_kernel_opoll_37:
    buffer_load_dword v3, v2, s[52:55], 0 offen sc0 sc1
    s_waitcnt vmcnt(0)
    v_cmp_ne_u32 vcc, s3, v3
    s_nop 1
    s_cmp_eq_u64 vcc, 0
    s_cbranch_scc1 recurrent_scan__mha_block__glu_gated_geglu__prompt_kernel_opoll_37_ok
    s_sleep 2
    s_add_u32 s40, s40, 1
    s_cmp_lt_u32 s40, 32768
    s_cbranch_scc1 recurrent_scan__mha_block__glu_gated_geglu__prompt_kernel_opoll_37
recurrent_scan__mha_block__glu_gated_geglu__prompt_kernel_opoll_37_ok:
    buffer_load_dwordx4 v[96:99], v8, s[8:11], s35 offen
    s_add_u32 s35, s35, 2048
    buffer_load_dwordx4 v[100:103], v8, s[8:11], s35 offen
    s_add_u32 s35, s35, 2048
    buffer_load_dwordx4 v[104:107], v8, s[8:11], s35 offen
    s_add_u32 s35, s35, 2048
    buffer_load_dwordx4 v[108:111], v8, s[8:11], s35 offen
    s_add_u32 s35, s35, 2048
    buffer_load_dwordx4 v[112:115], v8, s[8:11], s35 offen
    s_add_u32 s35, s35, 2048
    buffer_load_dwordx4 v[116:119], v8, s[8:11], s35 offen
    s_add_u32 s35, s35, 2048
    buffer_load_dwordx4 v[120:123], v8, s[8:11], s35 offen
    s_add_u32 s35, s35, 2048
    buffer_load_dwordx4 v[124:127], v8, s[8:11], s35 offen
    s_add_u32 s35, s35, 2048
    buffer_load_dwordx4 v[128:131], v8, s[8:11], s35 offen
    s_add_u32 s35, s35, 2048
    buffer_load_dwordx4 v[132:135], v8, s[8:11], s35 offen
    s_add_u32 s35, s35, 2048
    buffer_load_dwordx4 v[136:139], v8, s[8:11], s35 offen
    s_add_u32 s35, s35, 2048
    buffer_load_dwordx4 v[140:143], v8, s[8:11], s35 offen
    s_add_u32 s35, s35, 2048
    buffer_load_dwordx4 v[144:147], v8, s[8:11], s35 offen
    s_add_u32 s35, s35, 2048
    buffer_load_dwordx4 v[148:151], v8, s[8:11], s35 offen
    s_add_u32 s35, s35, 2048
    buffer_load_dwordx4 v[152:155], v8, s[8:11], s35 offen
    s_add_u32 s35, s35, 2048
    buffer_load_dwordx4 v[156:159], v8, s[8:11], s35 offen
    s_add_u32 s35, s35, 2048
    buffer_load_dwordx4 v[160:163], v8, s[8:11], s35 offen
    s_add_u32 s35, s35, 2048
    buffer_load_dwordx4 v[164:167], v8, s[8:11], s35 offen
    s_add_u32 s35, s35, 2048
    buffer_load_dwordx4 v[168:171], v8, s[8:11], s35 offen
    s_add_u32 s35, s35, 2048
    buffer_load_dwordx4 v[172:175], v8, s[8:11], s35 offen
    ds_read_b128 v[36:39], v9 offset:0
    ds_read_b128 v[40:43], v9 offset:1024
    ds_read_b128 v[44:47], v9 offset:2048
    ds_read_b128 v[48:51], v9 offset:3072
    ds_read_b128 v[52:55], v9 offset:4096
    s_waitcnt vmcnt(19) lgkmcnt(0)
    v_mfma_f32_16x16x32_bf16 v[16:19], v[36:39], v[96:99], v[16:19]
    ds_read_b128 v[56:59], v9 offset:5120
    v_mfma_f32_16x16x32_bf16 v[20:23], v[40:43], v[96:99], v[20:23]
    ds_read_b128 v[60:63], v9 offset:6144
    v_mfma_f32_16x16x32_bf16 v[24:27], v[44:47], v[96:99], v[24:27]
    ds_read_b128 v[64:67], v9 offset:7168
    v_mfma_f32_16x16x32_bf16 v[28:31], v[48:51], v[96:99], v[28:31]
    ds_read_b128 v[68:71], v9 offset:8192
    v_mfma_f32_16x16x32_bf16 v[32:35], v[52:55], v[96:99], v[32:35]
    ds_read_b128 v[72:75], v9 offset:9216
    s_waitcnt vmcnt(18) lgkmcnt(0)
    v_mfma_f32_16x16x32_bf16 v[16:19], v[56:59], v[100:103], v[16:19]
    ds_read_b128 v[36:39], v9 offset:10240
    v_mfma_f32_16x16x32_bf16 v[20:23], v[60:63], v[100:103], v[20:23]
    ds_read_b128 v[40:43], v9 offset:11264
    v_mfma_f32_16x16x32_bf16 v[24:27], v[64:67], v[100:103], v[24:27]
    ds_read_b128 v[44:47], v9 offset:12288
    v_mfma_f32_16x16x32_bf16 v[28:31], v[68:71], v[100:103], v[28:31]
    ds_read_b128 v[48:51], v9 offset:13312
    v_mfma_f32_16x16x32_bf16 v[32:35], v[72:75], v[100:103], v[32:35]
    ds_read_b128 v[52:55], v9 offset:14336
    s_waitcnt vmcnt(17) lgkmcnt(0)
    v_mfma_f32_16x16x32_bf16 v[16:19], v[36:39], v[104:107], v[16:19]
    ds_read_b128 v[56:59], v9 offset:15360
    v_mfma_f32_16x16x32_bf16 v[20:23], v[40:43], v[104:107], v[20:23]
    ds_read_b128 v[60:63], v9 offset:16384
    v_mfma_f32_16x16x32_bf16 v[24:27], v[44:47], v[104:107], v[24:27]
    ds_read_b128 v[64:67], v9 offset:17408
    v_mfma_f32_16x16x32_bf16 v[28:31], v[48:51], v[104:107], v[28:31]
    ds_read_b128 v[68:71], v9 offset:18432
    v_mfma_f32_16x16x32_bf16 v[32:35], v[52:55], v[104:107], v[32:35]
    ds_read_b128 v[72:75], v9 offset:19456
    s_waitcnt vmcnt(16) lgkmcnt(0)
    v_mfma_f32_16x16x32_bf16 v[16:19], v[56:59], v[108:111], v[16:19]
    ds_read_b128 v[36:39], v9 offset:20480
    v_mfma_f32_16x16x32_bf16 v[20:23], v[60:63], v[108:111], v[20:23]
    ds_read_b128 v[40:43], v9 offset:21504
    v_mfma_f32_16x16x32_bf16 v[24:27], v[64:67], v[108:111], v[24:27]
    ds_read_b128 v[44:47], v9 offset:22528
    v_mfma_f32_16x16x32_bf16 v[28:31], v[68:71], v[108:111], v[28:31]
    ds_read_b128 v[48:51], v9 offset:23552
    v_mfma_f32_16x16x32_bf16 v[32:35], v[72:75], v[108:111], v[32:35]
    ds_read_b128 v[52:55], v9 offset:24576
    s_waitcnt vmcnt(15) lgkmcnt(0)
    v_mfma_f32_16x16x32_bf16 v[16:19], v[36:39], v[112:115], v[16:19]
    ds_read_b128 v[56:59], v9 offset:25600
    v_mfma_f32_16x16x32_bf16 v[20:23], v[40:43], v[112:115], v[20:23]
    ds_read_b128 v[60:63], v9 offset:26624
    v_mfma_f32_16x16x32_bf16 v[24:27], v[44:47], v[112:115], v[24:27]
    ds_read_b128 v[64:67], v9 offset:27648
    v_mfma_f32_16x16x32_bf16 v[28:31], v[48:51], v[112:115], v[28:31]
    ds_read_b128 v[68:71], v9 offset:28672
    v_mfma_f32_16x16x32_bf16 v[32:35], v[52:55], v[112:115], v[32:35]
    ds_read_b128 v[72:75], v9 offset:29696
    s_waitcnt vmcnt(14) lgkmcnt(0)
    v_mfma_f32_16x16x32_bf16 v[16:19], v[56:59], v[116:119], v[16:19]
    ds_read_b128 v[36:39], v9 offset:30720
    v_mfma_f32_16x16x32_bf16 v[20:23], v[60:63], v[116:119], v[20:23]
    ds_read_b128 v[40:43], v9 offset:31744
    v_mfma_f32_16x16x32_bf16 v[24:27], v[64:67], v[116:119], v[24:27]
    ds_read_b128 v[44:47], v9 offset:32768
    v_mfma_f32_16x16x32_bf16 v[28:31], v[68:71], v[116:119], v[28:31]
    ds_read_b128 v[48:51], v9 offset:33792
    v_mfma_f32_16x16x32_bf16 v[32:35], v[72:75], v[116:119], v[32:35]
    ds_read_b128 v[52:55], v9 offset:34816
    s_waitcnt vmcnt(13) lgkmcnt(0)
    v_mfma_f32_16x16x32_bf16 v[16:19], v[36:39], v[120:123], v[16:19]
    ds_read_b128 v[56:59], v9 offset:35840
    v_mfma_f32_16x16x32_bf16 v[20:23], v[40:43], v[120:123], v[20:23]
    ds_read_b128 v[60:63], v9 offset:36864
    v_mfma_f32_16x16x32_bf16 v[24:27], v[44:47], v[120:123], v[24:27]
    ds_read_b128 v[64:67], v9 offset:37888
    v_mfma_f32_16x16x32_bf16 v[28:31], v[48:51], v[120:123], v[28:31]
    ds_read_b128 v[68:71], v9 offset:38912
    v_mfma_f32_16x16x32_bf16 v[32:35], v[52:55], v[120:123], v[32:35]
    ds_read_b128 v[72:75], v9 offset:39936
    s_waitcnt vmcnt(12) lgkmcnt(0)
    v_mfma_f32_16x16x32_bf16 v[16:19], v[56:59], v[124:127], v[16:19]
    ds_read_b128 v[36:39], v9 offset:40960
    v_mfma_f32_16x16x32_bf16 v[20:23], v[60:63], v[124:127], v[20:23]
    ds_read_b128 v[40:43], v9 offset:41984
    v_mfma_f32_16x16x32_bf16 v[24:27], v[64:67], v[124:127], v[24:27]
    ds_read_b128 v[44:47], v9 offset:43008
    v_mfma_f32_16x16x32_bf16 v[28:31], v[68:71], v[124:127], v[28:31]
    ds_read_b128 v[48:51], v9 offset:44032
    v_mfma_f32_16x16x32_bf16 v[32:35], v[72:75], v[124:127], v[32:35]
    ds_read_b128 v[52:55], v9 offset:45056
    s_waitcnt vmcnt(11) lgkmcnt(0)
    v_mfma_f32_16x16x32_bf16 v[16:19], v[36:39], v[128:131], v[16:19]
    ds_read_b128 v[56:59], v9 offset:46080
    v_mfma_f32_16x16x32_bf16 v[20:23], v[40:43], v[128:131], v[20:23]
    ds_read_b128 v[60:63], v9 offset:47104
    v_mfma_f32_16x16x32_bf16 v[24:27], v[44:47], v[128:131], v[24:27]
    ds_read_b128 v[64:67], v9 offset:48128
    v_mfma_f32_16x16x32_bf16 v[28:31], v[48:51], v[128:131], v[28:31]
    ds_read_b128 v[68:71], v9 offset:49152
    v_mfma_f32_16x16x32_bf16 v[32:35], v[52:55], v[128:131], v[32:35]
    ds_read_b128 v[72:75], v9 offset:50176
    s_waitcnt vmcnt(10) lgkmcnt(0)
    v_mfma_f32_16x16x32_bf16 v[16:19], v[56:59], v[132:135], v[16:19]
    ds_read_b128 v[36:39], v9 offset:51200
    v_mfma_f32_16x16x32_bf16 v[20:23], v[60:63], v[132:135], v[20:23]
    ds_read_b128 v[40:43], v9 offset:52224
    v_mfma_f32_16x16x32_bf16 v[24:27], v[64:67], v[132:135], v[24:27]
    ds_read_b128 v[44:47], v9 offset:53248
    v_mfma_f32_16x16x32_bf16 v[28:31], v[68:71], v[132:135], v[28:31]
    ds_read_b128 v[48:51], v9 offset:54272
    v_mfma_f32_16x16x32_bf16 v[32:35], v[72:75], v[132:135], v[32:35]
    ds_read_b128 v[52:55], v9 offset:55296
    s_waitcnt vmcnt(9) lgkmcnt(0)
    v_mfma_f32_16x16x32_bf16 v[16:19], v[36:39], v[136:139], v[16:19]
    ds_read_b128 v[56:59], v9 offset:56320
    v_mfma_f32_16x16x32_bf16 v[20:23], v[40:43], v[136:139], v[20:23]
    ds_read_b128 v[60:63], v9 offset:57344
    v_mfma_f32_16x16x32_bf16 v[24:27], v[44:47], v[136:139], v[24:27]
    ds_read_b128 v[64:67], v9 offset:58368
    v_mfma_f32_16x16x32_bf16 v[28:31], v[48:51], v[136:139], v[28:31]
    ds_read_b128 v[68:71], v9 offset:59392
    v_mfma_f32_16x16x32_bf16 v[32:35], v[52:55], v[136:139], v[32:35]
    ds_read_b128 v[72:75], v9 offset:60416
    s_waitcnt vmcnt(8) lgkmcnt(0)
    v_mfma_f32_16x16x32_bf16 v[16:19], v[56:59], v[140:143], v[16:19]
    ds_read_b128 v[36:39], v10 offset:0
    v_mfma_f32_16x16x32_bf16 v[20:23], v[60:63], v[140:143], v[20:23]
    ds_read_b128 v[40:43], v10 offset:1024
    v_mfma_f32_16x16x32_bf16 v[24:27], v[64:67], v[140:143], v[24:27]
    ds_read_b128 v[44:47], v10 offset:2048
    v_mfma_f32_16x16x32_bf16 v[28:31], v[68:71], v[140:143], v[28:31]
    ds_read_b128 v[48:51], v10 offset:3072
    v_mfma_f32_16x16x32_bf16 v[32:35], v[72:75], v[140:143], v[32:35]
    ds_read_b128 v[52:55], v10 offset:4096
    s_waitcnt vmcnt(7) lgkmcnt(0)
    v_mfma_f32_16x16x32_bf16 v[16:19], v[36:39], v[144:147], v[16:19]
    ds_read_b128 v[56:59], v10 offset:5120
    v_mfma_f32_16x16x32_bf16 v[20:23], v[40:43], v[144:147], v[20:23]
    ds_read_b128 v[60:63], v10 offset:6144
    v_mfma_f32_16x16x32_bf16 v[24:27], v[44:47], v[144:147], v[24:27]
    ds_read_b128 v[64:67], v10 offset:7168
    v_mfma_f32_16x16x32_bf16 v[28:31], v[48:51], v[144:147], v[28:31]
    ds_read_b128 v[68:71], v10 offset:8192
    v_mfma_f32_16x16x32_bf16 v[32:35], v[52:55], v[144:147], v[32:35]
    ds_read_b128 v[72:75], v10 offset:9216
    s_waitcnt vmcnt(6) lgkmcnt(0)
    v_mfma_f32_16x16x32_bf16 v[16:19], v[56:59], v[148:151], v[16:19]
    ds_read_b128 v[36:39], v10 offset:10240
    v_mfma_f32_16x16x32_bf16 v[20:23], v[60:63], v[148:151], v[20:23]
    ds_read_b128 v[40:43], v10 offset:11264
    v_mfma_f32_16x16x32_bf16 v[24:27], v[64:67], v[148:151], v[24:27]
    ds_read_b128 v[44:47], v10 offset:12288
    v_mfma_f32_16x16x32_bf16 v[28:31], v[68:71], v[148:151], v[28:31]
    ds_read_b128 v[48:51], v10 offset:13312
    v_mfma_f32_16x16x32_bf16 v[32:35], v[72:75], v[148:151], v[32:35]
    ds_read_b128 v[52:55], v10 offset:14336
    s_waitcnt vmcnt(5) lgkmcnt(0)
    v_mfma_f32_16x16x32_bf16 v[16:19], v[36:39], v[152:155], v[16:19]
    ds_read_b128 v[56:59], v10 offset:15360
    v_mfma_f32_16x16x32_bf16 v[20:23], v[40:43], v[152:155], v[20:23]
    ds_read_b128 v[60:63], v10 offset:16384
    v_mfma_f32_16x16x32_bf16 v[24:27], v[44:47], v[152:155], v[24:27]
    ds_read_b128 v[64:67], v10 offset:17408
    v_mfma_f32_16x16x32_bf16 v[28:31], v[48:51], v[152:155], v[28:31]
    ds_read_b128 v[68:71], v10 offset:18432
    v_mfma_f32_16x16x32_bf16 v[32:35], v[52:55], v[152:155], v[32:35]
    ds_read_b128 v[72:75], v10 offset:19456
    s_waitcnt vmcnt(4) lgkmcnt(0)
    v_mfma_f32_16x16x32_bf16 v[16:19], v[56:59], v[156:159], v[16:19]
    ds_read_b128 v[36:39], v10 offset:20480
    v_mfma_f32_16x16x32_bf16 v[20:23], v[60:63], v[156:159], v[20:23]
    ds_read_b128 v[40:43], v10 offset:21504
    v_mfma_f32_16x16x32_bf16 v[24:27], v[64:67], v[156:159], v[24:27]
    ds_read_b128 v[44:47], v10 offset:22528
    v_mfma_f32_16x16x32_bf16 v[28:31], v[68:71], v[156:159], v[28:31]
    ds_read_b128 v[48:51], v10 offset:23552
    v_mfma_f32_16x16x32_bf16 v[32:35], v[72:75], v[156:159], v[32:35]
    ds_read_b128 v[52:55], v10 offset:24576
    s_waitcnt vmcnt(3) lgkmcnt(0)
    v_mfma_f32_16x16x32_bf16 v[16:19], v[36:39], v[160:163], v[16:19]
    ds_read_b128 v[56:59], v10 offset:25600
    v_mfma_f32_16x16x32_bf16 v[20:23], v[40:43], v[160:163], v[20:23]
    ds_read_b128 v[60:63], v10 offset:26624
    v_mfma_f32_16x16x32_bf16 v[24:27], v[44:47], v[160:163], v[24:27]
    ds_read_b128 v[64:67], v10 offset:27648
    v_mfma_f32_16x16x32_bf16 v[28:31], v[48:51], v[160:163], v[28:31]
    ds_read_b128 v[68:71], v10 offset:28672
    v_mfma_f32_16x16x32_bf16 v[32:35], v[52:55], v[160:163], v[32:35]
    ds_read_b128 v[72:75], v10 offset:29696
    s_waitcnt vmcnt(2) lgkmcnt(0)
    v_mfma_f32_16x16x32_bf16 v[16:19], v[56:59], v[164:167], v[16:19]
    ds_read_b128 v[36:39], v10 offset:30720
    v_mfma_f32_16x16x32_bf16 v[20:23], v[60:63], v[164:167], v[20:23]
    ds_read_b128 v[40:43], v10 offset:31744
    v_mfma_f32_16x16x32_bf16 v[24:27], v[64:67], v[164:167], v[24:27]
    ds_read_b128 v[44:47], v10 offset:32768
    v_mfma_f32_16x16x32_bf16 v[28:31], v[68:71], v[164:167], v[28:31]
    ds_read_b128 v[48:51], v10 offset:33792
    v_mfma_f32_16x16x32_bf16 v[32:35], v[72:75], v[164:167], v[32:35]
    ds_read_b128 v[52:55], v10 offset:34816
    s_waitcnt vmcnt(1) lgkmcnt(0)
    v_mfma_f32_16x16x32_bf16 v[16:19], v[36:39], v[168:171], v[16:19]
    ds_read_b128 v[56:59], v10 offset:35840
    v_mfma_f32_16x16x32_bf16 v[20:23], v[40:43], v[168:171], v[20:23]
    ds_read_b128 v[60:63], v10 offset:36864
    v_mfma_f32_16x16x32_bf16 v[24:27], v[44:47], v[168:171], v[24:27]
    ds_read_b128 v[64:67], v10 offset:37888
    v_mfma_f32_16x16x32_bf16 v[28:31], v[48:51], v[168:171], v[28:31]
    ds_read_b128 v[68:71], v10 offset:38912
    v_mfma_f32_16x16x32_bf16 v[32:35], v[52:55], v[168:171], v[32:35]
    ds_read_b128 v[72:75], v10 offset:39936
    s_waitcnt vmcnt(0) lgkmcnt(0)
    v_mfma_f32_16x16x32_bf16 v[16:19], v[56:59], v[172:175], v[16:19]
    v_mfma_f32_16x16x32_bf16 v[20:23], v[60:63], v[172:175], v[20:23]
    v_mfma_f32_16x16x32_bf16 v[24:27], v[64:67], v[172:175], v[24:27]
    v_mfma_f32_16x16x32_bf16 v[28:31], v[68:71], v[172:175], v[28:31]
    v_mfma_f32_16x16x32_bf16 v[32:35], v[72:75], v[172:175], v[32:35]
    s_nop 7
    v_lshlrev_b32 v2, 16, v224
    v_and_b32 v3, 0xffff0000, v224
    v_fma_f32 v2, v16, v196, v2
    v_fma_f32 v3, v17, v197, v3
    v_cvt_pk_bf16_f32 v224, v2, v3
    v_lshlrev_b32 v2, 16, v225
    v_and_b32 v3, 0xffff0000, v225
    v_fma_f32 v2, v18, v198, v2
    v_fma_f32 v3, v19, v199, v3
    v_cvt_pk_bf16_f32 v225, v2, v3
    buffer_store_dwordx2 v[224:225], v11, s[20:23], s59 offen offset:0
    v_lshlrev_b32 v2, 16, v226
    v_and_b32 v3, 0xffff0000, v226
    v_fma_f32 v2, v20, v200, v2
    v_fma_f32 v3, v21, v201, v3
    v_cvt_pk_bf16_f32 v226, v2, v3
    v_lshlrev_b32 v2, 16, v227
    v_and_b32 v3, 0xffff0000, v227
    v_fma_f32 v2, v22, v202, v2
    v_fma_f32 v3, v23, v203, v3
    v_cvt_pk_bf16_f32 v227, v2, v3
    buffer_store_dwordx2 v[226:227], v11, s[20:23], s59 offen offset:32
    v_lshlrev_b32 v2, 16, v228
    v_and_b32 v3, 0xffff0000, v228
    v_fma_f32 v2, v24, v204, v2
    v_fma_f32 v3, v25, v205, v3
    v_cvt_pk_bf16_f32 v228, v2, v3
    v_lshlrev_b32 v2, 16, v229
    v_and_b32 v3, 0xffff0000, v229
    v_fma_f32 v2, v26, v206, v2
    v_fma_f32 v3, v27, v207, v3
    v_cvt_pk_bf16_f32 v229, v2, v3
    buffer_store_dwordx2 v[228:229], v11, s[20:23], s59 offen offset:64
    v_lshlrev_b32 v2, 16, v230
    v_and_b32 v3, 0xffff0000, v230
    v_fma_f32 v2, v28, v208, v2
    v_fma_f32 v3, v29, v209, v3
    v_cvt_pk_bf16_f32 v230, v2, v3
    v_lshlrev_b32 v2, 16, v231
    v_and_b32 v3, 0xffff0000, v231
    v_fma_f32 v2, v30, v210, v2
    v_fma_f32 v3, v31, v211, v3
    v_cvt_pk_bf16_f32 v231, v2, v3
    buffer_store_dwordx2 v[230:231], v11, s[20:23], s59 offen offset:96
    v_lshlrev_b32 v2, 16, v232
    v_and_b32 v3, 0xffff0000, v232
    v_fma_f32 v2, v32, v212, v2
    v_fma_f32 v3, v33, v213, v3
    v_cvt_pk_bf16_f32 v232, v2, v3
    v_lshlrev_b32 v2, 16, v233
    v_and_b32 v3, 0xffff0000, v233
    v_fma_f32 v2, v34, v214, v2
    v_fma_f32 v3, v35, v215, v3
    v_cvt_pk_bf16_f32 v233, v2, v3
    buffer_store_dwordx2 v[232:233], v11, s[20:23], s59 offen offset:128
recurrent_scan__mha_block__glu_gated_geglu__prompt_kernel_end:
    s_endpgm
.section .rodata,"a"
.p2align 6
.amdhsa_kernel recurrent_scan__mha_block__glu_gated_geglu__prompt_kernel
  .amdhsa_next_free_vgpr 240
  .amdhsa_next_free_sgpr 102
  .amdhsa_accum_offset 240
  .amdhsa_group_segment_fixed_size 0
  .amdhsa_kernarg_size 80
  .amdhsa_user_sgpr_count 2
  .amdhsa_user_sgpr_kernarg_segment_ptr 1
  .amdhsa_system_sgpr_workgroup_id_x 1
.end_amdhsa_kernel
```
